```python
import torch

def _softmax(x, axis=-1):
    return torch.softmax(x, dim=axis)
def _gelu(x):
    return torch.nn.functional.gelu(x, approximate="tanh")
def _silu(x):
    return torch.nn.functional.silu(x)
def _sigmoid(x):
    return torch.sigmoid(x)
def _layernorm(x, axis=-1, eps=1e-5):
    m = x.mean(dim=axis, keepdim=True)
    v = x.var(dim=axis, keepdim=True, unbiased=False)
    return (x - m) / torch.sqrt(v + eps)
def _scatter_add(tgt, idx, src, axis=0):
    return tgt.clone().index_add_(axis, idx, src)
def _segment_sum(src, seg, n):
    out = torch.zeros((n,) + src.shape[1:], dtype=src.dtype)
    return out.index_add_(0, seg, src)
def _pad(x, pw):
    flat = tuple(v for pair in reversed(pw) for v in pair)
    return torch.nn.functional.pad(x, flat)

kernel_name = 'parallel_sum__spectral_gfnet__glu_gated_reglu__prompt'

def setup_inputs():

    _w = (lambda a: (lambda t: t.to(torch.bfloat16) if t.is_floating_point() else t)(torch.as_tensor(a)))
    def _A_setup():
        B, S, D = 1, 2048, 512
        Df = D // 2 + 1
        return {
            "x": _w((lambda *s: torch.randn(*s, dtype=torch.bfloat16) * 0.05)(B, S, D)),
            "w_r": _w((lambda *s: torch.randn(*s, dtype=torch.bfloat16) * 0.4)(S, Df) * 0.02),
            "w_i": _w((lambda *s: torch.randn(*s, dtype=torch.bfloat16) * 0.4)(S, Df) * 0.02),
        }
    _A_in = _A_setup()

    def _B_setup():
        B, S, D, F = 1, 2048, 512, 1376
        return {
            "x": _w((lambda *s: torch.randn(*s, dtype=torch.bfloat16) * 0.05)(B, S, D)),
            "W_gate": _w((lambda *s: torch.randn(*s, dtype=torch.bfloat16) * 0.2)(D, F) * (2.0 / D) ** 0.5),
            "W_up": _w((lambda *s: torch.randn(*s, dtype=torch.bfloat16) * 0.2)(D, F) * (2.0 / D) ** 0.5),
            "W_down": _w((lambda *s: torch.randn(*s, dtype=torch.bfloat16) * 0.2)(F, D) * (1.0 / F) ** 0.5),
        }
    _B_in = _B_setup()

    return {
        "A_x": _A_in["x"],
        "A_w_r": _A_in["w_r"],
        "A_w_i": _A_in["w_i"],
        "B_x": _B_in["x"],
        "B_W_gate": _B_in["W_gate"],
        "B_W_up": _B_in["W_up"],
        "B_W_down": _B_in["W_down"],
    }

def reference(A_x, A_w_r, A_w_i, B_x, B_W_gate, B_W_up, B_W_down):
    def _A_ref(x, w_r, w_i):
        B, S, D = x.shape
        X = (lambda x, axes=(-2,-1): torch.fft.rfft2(x.float(), dim=axes))(x, axes=(-2, -1))
        W = w_r + 1j * w_i
        X = X * W
        y = (lambda x, s, axes=(-2,-1): torch.fft.irfft2(x, s=s, dim=axes).to(torch.bfloat16))(X, (S, D), axes=(-2, -1))
        return y

    def _B_ref(x, W_gate, W_up, W_down):
        gate = torch.einsum("bsd,df->bsf", x, W_gate)
        up = torch.einsum("bsd,df->bsf", x, W_up)
        gate = gate * (lambda x, dt: x.to(dt))(gate > 0, gate.dtype)
        h = gate * up
        return torch.einsum("bsf,fd->bsd", h, W_down)

    x = A_x
    xn = _layernorm(x, axis=-1)
    return x + _A_ref(xn, A_w_r, A_w_i) + _B_ref(xn, B_W_gate, B_W_up, B_W_down)
```

```asm
; @launch grid=(256,1,1) block=(256,1,1) lds=163840
.amdgcn_target "amdgcn-amd-amdhsa--gfx950"
.text
.globl parallel_sum__spectral_gfnet__glu_gated_reglu__prompt_kernel
.p2align 8
.type parallel_sum__spectral_gfnet__glu_gated_reglu__prompt_kernel,@function
parallel_sum__spectral_gfnet__glu_gated_reglu__prompt_kernel:
s_cmp_ge_u32 s2, 256
s_cbranch_scc1 L_parallel_sum__spectral_gfnet__glu_gated_reglu__prompt_kernel_end
s_load_dwordx2 s[4:5], s[0:1], 0
s_load_dwordx2 s[16:17], s[0:1], 72
s_load_dwordx2 s[8:9], s[0:1], 32
s_load_dwordx2 s[12:13], s[0:1], 40
s_load_dwordx2 s[20:21], s[0:1], 8
s_load_dwordx2 s[24:25], s[0:1], 16
s_load_dwordx2 s[64:65], s[0:1], 48
s_load_dwordx2 s[68:69], s[0:1], 56
s_load_dwordx2 s[72:73], s[0:1], 64
s_getpc_b64 s[60:61]
s_lshr_b32 s35, s2, 3
s_and_b32 s35, s35, 7
s_lshl_b32 s35, s35, 13
s_add_u32 s60, s60, s35
s_addc_u32 s61, s61, 0
v_lshrrev_b32 v1, 2, v0
v_lshlrev_b32 v1, 7, v1
global_load_dword a254, v1, s[60:61]
v_and_b32 v224, 63, v0
v_lshrrev_b32 v1, 6, v0
s_and_b32 s34, s2, 7
s_lshr_b32 s35, s2, 3
v_readfirstlane_b32 s28, v1
s_and_b32 s29, s34, 1
s_lshl_b32 s29, s29, 3
s_and_b32 s60, s35, 7
s_add_u32 s29, s29, s60
s_lshr_b32 s30, s34, 1
s_lshr_b32 s60, s35, 3
s_lshl_b32 s60, s60, 2
s_add_u32 s30, s30, s60
s_and_b32 s53, s30, 7
s_lshl_b32 s31, s29, 2
s_add_u32 s31, s31, s28
s_lshl_b32 s32, s28, 15
s_mov_b32 s75, s2
s_movk_i32 s54, 0x400
s_lshl_b32 s50, s53, 7
v_lshrrev_b32 v1, 3, v224
v_lshlrev_b32 v1, 6, v1
v_add_u32 v1, s31, v1
v_lshlrev_b32 v1, 10, v1
v_and_b32 v2, 7, v224
v_lshrrev_b32 v3, 4, v224
v_xor_b32 v2, v2, v3
v_lshlrev_b32 v2, 4, v2
v_add_u32 v225, v1, v2
v_xor_b32 v226, 64, v225
v_add_u32 v227, 0x100000, v225
v_add_u32 v228, 0x180000, v226
v_add_u32 v226, 0x80000, v226
s_mov_b32 m0, s32
s_waitcnt lgkmcnt(0)
s_mov_b32 s6, 0x200000
s_mov_b32 s7, 0x20000
s_mov_b32 s18, 0x10000000
s_mov_b32 s19, 0x20000
s_sub_u32 s74, s30, 11
s_lshl_b32 s74, s74, 4
s_add_u32 s74, s74, s29
s_cmp_lt_u32 s30, 11
s_cselect_b32 s74, 0x200, s74
buffer_load_dwordx4 v225, s[4:7], s50 offen lds
s_add_u32 m0, m0, s54
s_nop 0
buffer_load_dwordx4 v226, s[4:7], s50 offen lds
s_add_u32 m0, m0, s54
s_nop 0
buffer_load_dwordx4 v227, s[4:7], s50 offen lds
s_add_u32 m0, m0, s54
s_nop 0
buffer_load_dwordx4 v228, s[4:7], s50 offen lds
s_add_u32 m0, m0, s54
s_add_u32 s50, s50, 0x80
s_and_b32 s50, s50, 0x3ff
buffer_load_dwordx4 v225, s[4:7], s50 offen lds
s_add_u32 m0, m0, s54
s_nop 0
buffer_load_dwordx4 v226, s[4:7], s50 offen lds
s_add_u32 m0, m0, s54
s_nop 0
buffer_load_dwordx4 v227, s[4:7], s50 offen lds
s_add_u32 m0, m0, s54
s_nop 0
buffer_load_dwordx4 v228, s[4:7], s50 offen lds
s_add_u32 m0, m0, s54
s_add_u32 s50, s50, 0x80
s_and_b32 s50, s50, 0x3ff
buffer_load_dwordx4 v225, s[4:7], s50 offen lds
s_add_u32 m0, m0, s54
s_nop 0
buffer_load_dwordx4 v226, s[4:7], s50 offen lds
s_add_u32 m0, m0, s54
s_nop 0
buffer_load_dwordx4 v227, s[4:7], s50 offen lds
s_add_u32 m0, m0, s54
s_nop 0
buffer_load_dwordx4 v228, s[4:7], s50 offen lds
s_add_u32 m0, m0, s54
s_add_u32 s50, s50, 0x80
s_and_b32 s50, s50, 0x3ff
s_mov_b32 s10, 0x158000
s_mov_b32 s11, 0x20000
s_mov_b32 s14, 0x158000
s_mov_b32 s15, 0x20000
s_mov_b32 s22, 0x101000
s_mov_b32 s23, 0x20000
s_mov_b32 s26, 0x101000
s_mov_b32 s27, 0x20000
s_mul_i32 s33, s30, 3
s_lshl_b32 s60, s30, 1
s_add_u32 s60, s60, 11
s_cmp_lt_u32 s30, 11
s_cselect_b32 s33, s33, s60
s_cmp_gt_u32 s28, 1
s_cbranch_scc1 L_parallel_sum__spectral_gfnet__glu_gated_reglu__prompt_kernel_nowpf_1
v_and_b32 v5, 31, v224
s_lshl_b32 s60, s29, 5
v_add_u32 v5, s60, v5
v_mul_u32_u24 v5, 2752, v5
v_lshrrev_b32 v6, 5, v224
v_lshlrev_b32 v6, 7, v6
s_lshl_b32 s60, s33, 6
v_add3_u32 v5, v5, v6, s60
s_cmp_eq_u32 s28, 1
s_cbranch_scc1 L_parallel_sum__spectral_gfnet__glu_gated_reglu__prompt_kernel_wpfu_2
buffer_load_dword a255, v5, s[8:11], 0 offen
s_branch L_parallel_sum__spectral_gfnet__glu_gated_reglu__prompt_kernel_nowpf_1
L_parallel_sum__spectral_gfnet__glu_gated_reglu__prompt_kernel_wpfu_2:
buffer_load_dword a253, v5, s[12:15], 0 offen
L_parallel_sum__spectral_gfnet__glu_gated_reglu__prompt_kernel_nowpf_1:
s_cmp_lg_u32 s28, 0
s_cbranch_scc1 L_parallel_sum__spectral_gfnet__glu_gated_reglu__prompt_kernel_clear_3
s_lshl_b32 s35, s30, 4
s_add_u32 s35, s35, s29
s_lshl_b32 s35, s35, 2
s_add_u32 s35, s35, 14680064
s_lshl_b32 s37, s29, 4
s_add_u32 s37, s37, s30
s_lshl_b32 s37, s37, 2
s_add_u32 s37, s37, 14684160
s_lshl_b32 s36, s2, 2
s_add_u32 s36, s36, 14692352
s_lshl_b32 s38, s74, 2
s_add_u32 s38, s38, 14683136
v_mov_b32 v4, s35
v_mul_u32_u24 v5, 2048, v224
v_add_u32 v6, s36, v5
v_mul_u32_u24 v7, 512, v224
v_add_u32 v7, s38, v7
v_add_u32 v5, 14660608, v5
v_writelane_b32 v4, s37, 1
s_mov_b64 vcc, 0x3fc
v_cndmask_b32 v4, v4, v6, vcc
s_cmp_lt_u32 s74, 80
s_cselect_b64 vcc, 0x3fc00, 0
v_cndmask_b32 v4, v4, v7, vcc
s_cmp_eq_u32 s2, 0
s_cselect_b64 vcc, 0x3fc0000, 0
v_cndmask_b32 v4, v4, v5, vcc
s_add_u32 s37, s37, 2048
v_writelane_b32 v4, s37, 26
v_mov_b32 v5, 0
s_mov_b64 exec, 0x7ffffff
buffer_store_dword v5, v4, s[16:19], 0 offen sc1
s_mov_b64 exec, -1
L_parallel_sum__spectral_gfnet__glu_gated_reglu__prompt_kernel_clear_3:
s_cmp_ge_u32 s74, 0x100
s_cbranch_scc1 L_parallel_sum__spectral_gfnet__glu_gated_reglu__prompt_kernel_noppf_4
s_lshl_b32 s34, s74, 2
s_add_u32 s34, s34, s28
s_mul_i32 s34, s34, 3328
v_and_b32 v4, 31, v224
v_lshlrev_b32 v4, 7, v4
buffer_load_dword a252, v4, s[20:23], s34 offen
buffer_load_dword a251, v4, s[24:27], s34 offen
s_mov_b32 s34, s74
s_lshr_b32 s35, s34, 2
s_lshl_b32 s35, s35, 7
s_and_b32 s36, s34, 3
s_lshl_b32 s36, s36, 3
s_add_u32 s41, s35, s36
s_mul_i32 s44, s41, 514
s_lshl_b32 s37, s28, 7
s_add_u32 s44, s44, s37
s_lshl_b32 s62, s34, 7
s_add_u32 s62, s62, 2097152
s_lshl_b32 s45, s28, 13
s_add_u32 s45, s45, 131072
s_mov_b32 s38, 0x05040100
s_mov_b32 s39, 0x07060302
s_cmp_lt_u32 s34, 64
s_cselect_b32 s44, s44, 0x7ff00000
s_cselect_b32 s62, s62, 0x7ff00000
s_lshl_b32 s43, s28, 19
s_add_u32 s43, s43, s62
s_sub_u32 s35, s34, 64
s_lshl_b32 s35, s35, 2
s_add_u32 s35, s35, s28
s_lshr_b32 s36, s35, 2
s_lshl_b32 s36, s36, 7
s_and_b32 s37, s35, 3
s_lshl_b32 s37, s37, 3
s_add_u32 s36, s36, s37
s_mul_i32 s42, s36, 514
s_lshl_b32 s40, s35, 7
s_add_u32 s40, s40, 2097152
s_cmp_ge_u32 s34, 64
s_cselect_b32 s42, s42, 0x7ff00000
s_cselect_b32 s40, s40, 0x7ff00000
L_parallel_sum__spectral_gfnet__glu_gated_reglu__prompt_kernel_noppf_4:
s_mov_b32 s66, 0x158000
s_mov_b32 s67, 0x20000
s_mov_b32 s70, 0x200000
s_mov_b32 s71, 0x20000
s_mov_b32 s57, 0xffff0000
s_mov_b32 s58, 0x3f803f80
s_movk_i32 s63, 0x1000
v_and_b32 v5, 31, v224
v_lshrrev_b32 v6, 1, v5
v_and_b32 v7, 1, v5
s_lshl_b32 s60, s30, 4
v_add_u32 v6, s60, v6
v_lshlrev_b32 v8, 1, v6
v_add_u32 v8, v8, v7
v_cmp_eq_u32 vcc, 1, v8
v_mov_b32 v9, 0x100
v_mov_b32 v10, 0
v_cndmask_b32 v6, v6, v9, vcc
v_cndmask_b32 v7, v7, v10, vcc
v_and_b32 v9, 1, v6
v_mul_u32_u24 v9, 0x8000, v9
v_lshl_or_b32 v192, v9, 16, v9
v_cvt_f32_u32 v6, v6
v_cvt_f32_u32 v7, v7
v_mul_f32 v176, 0x3b000000, v6
v_lshrrev_b32 v8, 5, v224
v_lshlrev_b32 v8, 3, v8
s_add_u32 s60, s28, s53
s_lshl_b32 s60, s60, 6
v_add_u32 v8, s60, v8
v_cvt_f32_u32 v8, v8
v_mul_f32 v8, v8, v176
v_fract_f32 v8, v8
v_mul_f32 v7, 0x3e800000, v7
v_add_f32 v177, v7, v8
v_mul_f32 v178, 0x41000000, v176
v_lshlrev_b32 v233, 4, v224
v_add_u32 v233, 131072, v233
s_lshl_b32 s60, s28, 12
v_add_u32 v179, s60, v233
s_mov_b32 s56, 4
L_parallel_sum__spectral_gfnet__glu_gated_reglu__prompt_kernel_loopA_5:
v_cos_f32 v180, v177
v_add_f32 v177, v177, v176
v_cos_f32 v181, v177
v_add_f32 v177, v177, v176
v_cos_f32 v182, v177
v_add_f32 v177, v177, v176
v_cos_f32 v183, v177
v_add_f32 v177, v177, v176
v_cos_f32 v184, v177
v_add_f32 v177, v177, v176
v_cos_f32 v185, v177
v_add_f32 v177, v177, v176
v_cos_f32 v186, v177
v_add_f32 v177, v177, v176
v_cos_f32 v187, v177
v_add_f32 v177, v177, v176
v_cvt_pk_bf16_f32 v188, v180, v181
v_cvt_pk_bf16_f32 v189, v182, v183
v_cvt_pk_bf16_f32 v190, v184, v185
v_cvt_pk_bf16_f32 v191, v186, v187
v_add_f32 v177, v177, v178
v_xor_b32 v180, v188, v192
v_xor_b32 v181, v189, v192
v_xor_b32 v182, v190, v192
v_xor_b32 v183, v191, v192
ds_write_b128 v179, v[188:191]
ds_write_b128 v179, v[180:183] offset:16384
v_add_u32 v179, 0x400, v179
s_sub_u32 s56, s56, 1
s_cmp_lg_u32 s56, 0
s_cbranch_scc1 L_parallel_sum__spectral_gfnet__glu_gated_reglu__prompt_kernel_loopA_5
v_and_b32 v1, 31, v224
v_lshrrev_b32 v2, 5, v224
v_bfe_u32 v3, v1, 1, 3
v_lshlrev_b32 v4, 7, v1
v_add_u32 v4, s32, v4
v_add_u32 v5, 0, v2
v_xor_b32 v5, v5, v3
v_lshl_add_u32 v229, v5, 4, v4
v_add_u32 v5, 2, v2
v_xor_b32 v5, v5, v3
v_lshl_add_u32 v230, v5, 4, v4
v_add_u32 v5, 4, v2
v_xor_b32 v5, v5, v3
v_lshl_add_u32 v231, v5, 4, v4
v_add_u32 v5, 6, v2
v_xor_b32 v5, v5, v3
v_lshl_add_u32 v232, v5, 4, v4
v_bfe_u32 v5, v224, 2, 2
v_lshl_add_u32 v5, v2, 3, v5
v_lshlrev_b32 v5, 6, v5
v_bfe_u32 v6, v224, 4, 1
v_lshlrev_b32 v6, 5, v6
v_and_b32 v7, 3, v224
v_lshlrev_b32 v7, 3, v7
v_add3_u32 v234, v5, v6, v7
v_add_u32 v235, 0x10000, v234
v_lshrrev_b32 v5, 2, v224
s_lshl_b32 s60, s28, 4
v_add_u32 v5, s60, v5
v_mul_u32_u24 v5, 2752, v5
v_and_b32 v6, 3, v224
v_lshlrev_b32 v6, 4, v6
s_lshl_b32 s60, s33, 6
v_add3_u32 v236, v5, v6, s60
s_mul_i32 s60, s31, 88064
s_lshl_b32 s34, s33, 11
s_add_u32 s60, s60, s34
s_add_u32 s60, s60, 5242880
v_lshlrev_b32 v5, 4, v224
v_add_u32 v252, s60, v5
s_lshl_b32 s60, s31, 7
s_lshl_b32 s34, s30, 17
s_add_u32 s60, s60, s34
s_add_u32 s60, s60, 0
v_lshlrev_b32 v5, 14, v2
v_lshlrev_b32 v6, 2, v1
v_add3_u32 v253, v5, v6, s60
v_mov_b32 v237, 0
v_mov_b32 v238, 0
v_mov_b32 v239, 0
v_mov_b32 v240, 0
s_waitcnt lgkmcnt(0)
s_barrier
s_cmp_lt_u32 s30, 11
s_cbranch_scc1 L_parallel_sum__spectral_gfnet__glu_gated_reglu__prompt_kernel_heavy_6
ds_read_b128 a[48:51], v233 offset:0
ds_read_b128 a[52:55], v233 offset:1024
ds_read_b128 a[56:59], v233 offset:2048
ds_read_b128 a[60:63], v233 offset:3072
s_waitcnt vmcnt(8)
ds_read_b128 v[0:3], v229 offset:0
ds_read_b128 v[4:7], v230 offset:0
ds_read_b128 v[8:11], v231 offset:0
ds_read_b128 v[12:15], v232 offset:0
s_waitcnt lgkmcnt(0)
ds_read_b128 a[64:67], v233 offset:4096
v_dot2c_f32_bf16 v237, s58, v0
v_dot2c_f32_bf16 v239, v0, v0
v_dot2c_f32_bf16 v238, s58, v1
v_dot2c_f32_bf16 v240, v1, v1
ds_read_b128 a[68:71], v233 offset:5120
v_dot2c_f32_bf16 v237, s58, v2
v_dot2c_f32_bf16 v239, v2, v2
v_dot2c_f32_bf16 v238, s58, v3
v_dot2c_f32_bf16 v240, v3, v3
ds_read_b128 a[72:75], v233 offset:6144
v_dot2c_f32_bf16 v237, s58, v4
v_dot2c_f32_bf16 v239, v4, v4
buffer_load_dwordx4 v225, s[4:7], s50 offen lds
s_add_u32 m0, m0, s54
v_dot2c_f32_bf16 v238, s58, v5
v_dot2c_f32_bf16 v240, v5, v5
ds_read_b128 a[76:79], v233 offset:7168
v_dot2c_f32_bf16 v237, s58, v6
v_dot2c_f32_bf16 v239, v6, v6
v_dot2c_f32_bf16 v238, s58, v7
v_dot2c_f32_bf16 v240, v7, v7
s_waitcnt vmcnt(5)
ds_read_b128 v[16:19], v229 offset:4096
v_dot2c_f32_bf16 v237, s58, v8
v_dot2c_f32_bf16 v239, v8, v8
v_dot2c_f32_bf16 v238, s58, v9
v_dot2c_f32_bf16 v240, v9, v9
ds_read_b128 v[20:23], v230 offset:4096
buffer_load_dwordx4 v226, s[4:7], s50 offen lds
s_add_u32 m0, m0, s54
v_dot2c_f32_bf16 v237, s58, v10
v_dot2c_f32_bf16 v239, v10, v10
v_dot2c_f32_bf16 v238, s58, v11
v_dot2c_f32_bf16 v240, v11, v11
ds_read_b128 v[24:27], v231 offset:4096
v_dot2c_f32_bf16 v237, s58, v12
v_dot2c_f32_bf16 v239, v12, v12
v_dot2c_f32_bf16 v238, s58, v13
v_dot2c_f32_bf16 v240, v13, v13
ds_read_b128 v[28:31], v232 offset:4096
v_dot2c_f32_bf16 v237, s58, v14
v_dot2c_f32_bf16 v239, v14, v14
v_dot2c_f32_bf16 v238, s58, v15
v_dot2c_f32_bf16 v240, v15, v15
v_mfma_f32_32x32x16_bf16 v[128:143], a[48:51], v[0:3], 0
buffer_load_dwordx4 v227, s[4:7], s50 offen lds
s_add_u32 m0, m0, s54
v_mfma_f32_32x32x16_bf16 v[128:143], a[52:55], v[4:7], v[128:143]
v_mfma_f32_32x32x16_bf16 v[128:143], a[56:59], v[8:11], v[128:143]
buffer_load_dwordx4 v228, s[4:7], s50 offen lds
s_add_u32 m0, m0, s54
s_add_u32 s50, s50, 0x80
s_and_b32 s50, s50, 0x3ff
v_mfma_f32_32x32x16_bf16 v[128:143], a[60:63], v[12:15], v[128:143]
s_waitcnt lgkmcnt(0)
ds_read_b128 a[48:51], v233 offset:8192
v_dot2c_f32_bf16 v237, s58, v16
v_dot2c_f32_bf16 v239, v16, v16
v_dot2c_f32_bf16 v238, s58, v17
v_dot2c_f32_bf16 v240, v17, v17
ds_read_b128 a[52:55], v233 offset:9216
v_dot2c_f32_bf16 v237, s58, v18
v_dot2c_f32_bf16 v239, v18, v18
v_dot2c_f32_bf16 v238, s58, v19
v_dot2c_f32_bf16 v240, v19, v19
ds_read_b128 a[56:59], v233 offset:10240
v_dot2c_f32_bf16 v237, s58, v20
v_dot2c_f32_bf16 v239, v20, v20
buffer_load_dwordx4 v225, s[4:7], s50 offen lds
s_add_u32 m0, m0, s54
v_dot2c_f32_bf16 v238, s58, v21
v_dot2c_f32_bf16 v240, v21, v21
ds_read_b128 a[60:63], v233 offset:11264
v_dot2c_f32_bf16 v237, s58, v22
v_dot2c_f32_bf16 v239, v22, v22
v_dot2c_f32_bf16 v238, s58, v23
v_dot2c_f32_bf16 v240, v23, v23
s_waitcnt vmcnt(5)
ds_read_b128 v[32:35], v229 offset:8192
v_dot2c_f32_bf16 v237, s58, v24
v_dot2c_f32_bf16 v239, v24, v24
v_dot2c_f32_bf16 v238, s58, v25
v_dot2c_f32_bf16 v240, v25, v25
ds_read_b128 v[36:39], v230 offset:8192
buffer_load_dwordx4 v226, s[4:7], s50 offen lds
s_add_u32 m0, m0, s54
v_dot2c_f32_bf16 v237, s58, v26
v_dot2c_f32_bf16 v239, v26, v26
v_dot2c_f32_bf16 v238, s58, v27
v_dot2c_f32_bf16 v240, v27, v27
ds_read_b128 v[40:43], v231 offset:8192
v_dot2c_f32_bf16 v237, s58, v28
v_dot2c_f32_bf16 v239, v28, v28
v_dot2c_f32_bf16 v238, s58, v29
v_dot2c_f32_bf16 v240, v29, v29
ds_read_b128 v[44:47], v232 offset:8192
v_dot2c_f32_bf16 v237, s58, v30
v_dot2c_f32_bf16 v239, v30, v30
v_dot2c_f32_bf16 v238, s58, v31
v_dot2c_f32_bf16 v240, v31, v31
v_mfma_f32_32x32x16_bf16 v[128:143], a[64:67], v[16:19], v[128:143]
buffer_load_dwordx4 v227, s[4:7], s50 offen lds
s_add_u32 m0, m0, s54
v_mfma_f32_32x32x16_bf16 v[128:143], a[68:71], v[20:23], v[128:143]
v_mfma_f32_32x32x16_bf16 v[128:143], a[72:75], v[24:27], v[128:143]
buffer_load_dwordx4 v228, s[4:7], s50 offen lds
s_add_u32 m0, m0, s54
s_add_u32 s50, s50, 0x80
s_and_b32 s50, s50, 0x3ff
v_mfma_f32_32x32x16_bf16 v[128:143], a[76:79], v[28:31], v[128:143]
s_waitcnt lgkmcnt(0)
ds_read_b128 a[64:67], v233 offset:12288
v_dot2c_f32_bf16 v237, s58, v32
v_dot2c_f32_bf16 v239, v32, v32
v_dot2c_f32_bf16 v238, s58, v33
v_dot2c_f32_bf16 v240, v33, v33
ds_read_b128 a[68:71], v233 offset:13312
v_dot2c_f32_bf16 v237, s58, v34
v_dot2c_f32_bf16 v239, v34, v34
v_dot2c_f32_bf16 v238, s58, v35
v_dot2c_f32_bf16 v240, v35, v35
ds_read_b128 a[72:75], v233 offset:14336
v_dot2c_f32_bf16 v237, s58, v36
v_dot2c_f32_bf16 v239, v36, v36
buffer_load_dwordx4 v225, s[4:7], s50 offen lds
s_add_u32 m0, m0, s54
v_dot2c_f32_bf16 v238, s58, v37
v_dot2c_f32_bf16 v240, v37, v37
ds_read_b128 a[76:79], v233 offset:15360
v_dot2c_f32_bf16 v237, s58, v38
v_dot2c_f32_bf16 v239, v38, v38
v_dot2c_f32_bf16 v238, s58, v39
v_dot2c_f32_bf16 v240, v39, v39
s_waitcnt vmcnt(5)
ds_read_b128 v[48:51], v229 offset:12288
v_dot2c_f32_bf16 v237, s58, v40
v_dot2c_f32_bf16 v239, v40, v40
v_dot2c_f32_bf16 v238, s58, v41
v_dot2c_f32_bf16 v240, v41, v41
ds_read_b128 v[52:55], v230 offset:12288
buffer_load_dwordx4 v226, s[4:7], s50 offen lds
s_add_u32 m0, m0, s54
v_dot2c_f32_bf16 v237, s58, v42
v_dot2c_f32_bf16 v239, v42, v42
v_dot2c_f32_bf16 v238, s58, v43
v_dot2c_f32_bf16 v240, v43, v43
ds_read_b128 v[56:59], v231 offset:12288
v_dot2c_f32_bf16 v237, s58, v44
v_dot2c_f32_bf16 v239, v44, v44
v_dot2c_f32_bf16 v238, s58, v45
v_dot2c_f32_bf16 v240, v45, v45
ds_read_b128 v[60:63], v232 offset:12288
v_dot2c_f32_bf16 v237, s58, v46
v_dot2c_f32_bf16 v239, v46, v46
v_dot2c_f32_bf16 v238, s58, v47
v_dot2c_f32_bf16 v240, v47, v47
v_mfma_f32_32x32x16_bf16 v[128:143], a[48:51], v[32:35], v[128:143]
buffer_load_dwordx4 v227, s[4:7], s50 offen lds
s_add_u32 m0, m0, s54
v_mfma_f32_32x32x16_bf16 v[128:143], a[52:55], v[36:39], v[128:143]
v_mfma_f32_32x32x16_bf16 v[128:143], a[56:59], v[40:43], v[128:143]
buffer_load_dwordx4 v228, s[4:7], s50 offen lds
s_add_u32 m0, m0, s54
s_add_u32 s50, s50, 0x80
s_and_b32 s50, s50, 0x3ff
v_mfma_f32_32x32x16_bf16 v[128:143], a[60:63], v[44:47], v[128:143]
s_cmp_lg_u32 s28, 0
s_cbranch_scc1 L_parallel_sum__spectral_gfnet__glu_gated_reglu__prompt_kernel_clr_7
s_and_b32 s60, s2, 3
s_lshl_b32 s60, s60, 6
s_mov_b64 exec, 1
v_mov_b32 v244, s60
v_mov_b32 v245, 1
global_atomic_add v244, v245, s[72:73] sc1
s_mov_b64 exec, -1
L_parallel_sum__spectral_gfnet__glu_gated_reglu__prompt_kernel_clr_7:
s_waitcnt lgkmcnt(0)
ds_read_b128 a[48:51], v233 offset:16384
v_dot2c_f32_bf16 v237, s58, v48
v_dot2c_f32_bf16 v239, v48, v48
v_dot2c_f32_bf16 v238, s58, v49
v_dot2c_f32_bf16 v240, v49, v49
ds_read_b128 a[52:55], v233 offset:17408
v_dot2c_f32_bf16 v237, s58, v50
v_dot2c_f32_bf16 v239, v50, v50
v_dot2c_f32_bf16 v238, s58, v51
v_dot2c_f32_bf16 v240, v51, v51
ds_read_b128 a[56:59], v233 offset:18432
v_dot2c_f32_bf16 v237, s58, v52
v_dot2c_f32_bf16 v239, v52, v52
buffer_load_dwordx4 v225, s[4:7], s50 offen lds
s_add_u32 m0, m0, s54
v_dot2c_f32_bf16 v238, s58, v53
v_dot2c_f32_bf16 v240, v53, v53
ds_read_b128 a[60:63], v233 offset:19456
v_dot2c_f32_bf16 v237, s58, v54
v_dot2c_f32_bf16 v239, v54, v54
v_dot2c_f32_bf16 v238, s58, v55
v_dot2c_f32_bf16 v240, v55, v55
s_waitcnt vmcnt(5)
ds_read_b128 v[64:67], v229 offset:16384
v_dot2c_f32_bf16 v237, s58, v56
v_dot2c_f32_bf16 v239, v56, v56
v_dot2c_f32_bf16 v238, s58, v57
v_dot2c_f32_bf16 v240, v57, v57
ds_read_b128 v[68:71], v230 offset:16384
buffer_load_dwordx4 v226, s[4:7], s50 offen lds
s_add_u32 m0, m0, s54
v_dot2c_f32_bf16 v237, s58, v58
v_dot2c_f32_bf16 v239, v58, v58
v_dot2c_f32_bf16 v238, s58, v59
v_dot2c_f32_bf16 v240, v59, v59
ds_read_b128 v[72:75], v231 offset:16384
v_dot2c_f32_bf16 v237, s58, v60
v_dot2c_f32_bf16 v239, v60, v60
v_dot2c_f32_bf16 v238, s58, v61
v_dot2c_f32_bf16 v240, v61, v61
ds_read_b128 v[76:79], v232 offset:16384
v_dot2c_f32_bf16 v237, s58, v62
v_dot2c_f32_bf16 v239, v62, v62
v_dot2c_f32_bf16 v238, s58, v63
v_dot2c_f32_bf16 v240, v63, v63
v_mfma_f32_32x32x16_bf16 v[128:143], a[64:67], v[48:51], v[128:143]
buffer_load_dwordx4 v227, s[4:7], s50 offen lds
s_add_u32 m0, m0, s54
v_mfma_f32_32x32x16_bf16 v[128:143], a[68:71], v[52:55], v[128:143]
v_mfma_f32_32x32x16_bf16 v[128:143], a[72:75], v[56:59], v[128:143]
buffer_load_dwordx4 v228, s[4:7], s50 offen lds
s_add_u32 m0, m0, s54
s_add_u32 s50, s50, 0x80
s_and_b32 s50, s50, 0x3ff
v_mfma_f32_32x32x16_bf16 v[128:143], a[76:79], v[60:63], v[128:143]
s_waitcnt lgkmcnt(0)
ds_read_b128 a[64:67], v233 offset:20480
v_dot2c_f32_bf16 v237, s58, v64
v_dot2c_f32_bf16 v239, v64, v64
v_dot2c_f32_bf16 v238, s58, v65
v_dot2c_f32_bf16 v240, v65, v65
ds_read_b128 a[68:71], v233 offset:21504
v_dot2c_f32_bf16 v237, s58, v66
v_dot2c_f32_bf16 v239, v66, v66
v_dot2c_f32_bf16 v238, s58, v67
v_dot2c_f32_bf16 v240, v67, v67
ds_read_b128 a[72:75], v233 offset:22528
v_dot2c_f32_bf16 v237, s58, v68
v_dot2c_f32_bf16 v239, v68, v68
buffer_load_dwordx4 v225, s[4:7], s50 offen lds
s_add_u32 m0, m0, s54
v_dot2c_f32_bf16 v238, s58, v69
v_dot2c_f32_bf16 v240, v69, v69
ds_read_b128 a[76:79], v233 offset:23552
v_dot2c_f32_bf16 v237, s58, v70
v_dot2c_f32_bf16 v239, v70, v70
v_dot2c_f32_bf16 v238, s58, v71
v_dot2c_f32_bf16 v240, v71, v71
s_waitcnt vmcnt(5)
ds_read_b128 v[80:83], v229 offset:20480
v_dot2c_f32_bf16 v237, s58, v72
v_dot2c_f32_bf16 v239, v72, v72
v_dot2c_f32_bf16 v238, s58, v73
v_dot2c_f32_bf16 v240, v73, v73
ds_read_b128 v[84:87], v230 offset:20480
buffer_load_dwordx4 v226, s[4:7], s50 offen lds
s_add_u32 m0, m0, s54
v_dot2c_f32_bf16 v237, s58, v74
v_dot2c_f32_bf16 v239, v74, v74
v_dot2c_f32_bf16 v238, s58, v75
v_dot2c_f32_bf16 v240, v75, v75
ds_read_b128 v[88:91], v231 offset:20480
v_dot2c_f32_bf16 v237, s58, v76
v_dot2c_f32_bf16 v239, v76, v76
v_dot2c_f32_bf16 v238, s58, v77
v_dot2c_f32_bf16 v240, v77, v77
ds_read_b128 v[92:95], v232 offset:20480
v_dot2c_f32_bf16 v237, s58, v78
v_dot2c_f32_bf16 v239, v78, v78
v_dot2c_f32_bf16 v238, s58, v79
v_dot2c_f32_bf16 v240, v79, v79
v_mfma_f32_32x32x16_bf16 v[128:143], a[48:51], v[64:67], v[128:143]
buffer_load_dwordx4 v227, s[4:7], s50 offen lds
s_add_u32 m0, m0, s54
v_mfma_f32_32x32x16_bf16 v[128:143], a[52:55], v[68:71], v[128:143]
v_mfma_f32_32x32x16_bf16 v[128:143], a[56:59], v[72:75], v[128:143]
buffer_load_dwordx4 v228, s[4:7], s50 offen lds
s_add_u32 m0, m0, s54
s_add_u32 s50, s50, 0x80
s_and_b32 s50, s50, 0x3ff
v_mfma_f32_32x32x16_bf16 v[128:143], a[60:63], v[76:79], v[128:143]
s_waitcnt lgkmcnt(0)
s_add_u32 s59, s53, 0
s_and_b32 s59, s59, 7
s_add_u32 m0, s32, 0
s_mul_i32 s59, s59, 176128
ds_read_b128 a[48:51], v233 offset:24576
v_dot2c_f32_bf16 v237, s58, v80
v_dot2c_f32_bf16 v239, v80, v80
v_dot2c_f32_bf16 v238, s58, v81
v_dot2c_f32_bf16 v240, v81, v81
ds_read_b128 a[52:55], v233 offset:25600
v_dot2c_f32_bf16 v237, s58, v82
v_dot2c_f32_bf16 v239, v82, v82
v_dot2c_f32_bf16 v238, s58, v83
v_dot2c_f32_bf16 v240, v83, v83
ds_read_b128 a[56:59], v233 offset:26624
v_dot2c_f32_bf16 v237, s58, v84
v_dot2c_f32_bf16 v239, v84, v84
buffer_load_dwordx4 v236, s[8:11], s59 offen offset:0 lds
s_add_u32 m0, s32, 960
v_dot2c_f32_bf16 v238, s58, v85
v_dot2c_f32_bf16 v240, v85, v85
ds_read_b128 a[60:63], v233 offset:27648
v_dot2c_f32_bf16 v237, s58, v86
v_dot2c_f32_bf16 v239, v86, v86
v_dot2c_f32_bf16 v238, s58, v87
v_dot2c_f32_bf16 v240, v87, v87
s_waitcnt vmcnt(5)
ds_read_b128 v[96:99], v229 offset:24576
v_dot2c_f32_bf16 v237, s58, v88
v_dot2c_f32_bf16 v239, v88, v88
v_dot2c_f32_bf16 v238, s58, v89
v_dot2c_f32_bf16 v240, v89, v89
ds_read_b128 v[100:103], v230 offset:24576
buffer_load_dwordx4 v236, s[8:11], s59 offen offset:64 lds
s_add_u32 m0, s32, 2048
v_dot2c_f32_bf16 v237, s58, v90
v_dot2c_f32_bf16 v239, v90, v90
v_dot2c_f32_bf16 v238, s58, v91
v_dot2c_f32_bf16 v240, v91, v91
ds_read_b128 v[104:107], v231 offset:24576
v_dot2c_f32_bf16 v237, s58, v92
v_dot2c_f32_bf16 v239, v92, v92
v_dot2c_f32_bf16 v238, s58, v93
v_dot2c_f32_bf16 v240, v93, v93
ds_read_b128 v[108:111], v232 offset:24576
v_dot2c_f32_bf16 v237, s58, v94
v_dot2c_f32_bf16 v239, v94, v94
v_dot2c_f32_bf16 v238, s58, v95
v_dot2c_f32_bf16 v240, v95, v95
v_mfma_f32_32x32x16_bf16 v[128:143], a[64:67], v[80:83], v[128:143]
buffer_load_dwordx4 v236, s[12:15], s59 offen offset:0 lds
s_add_u32 m0, s32, 3008
v_mfma_f32_32x32x16_bf16 v[128:143], a[68:71], v[84:87], v[128:143]
v_mfma_f32_32x32x16_bf16 v[128:143], a[72:75], v[88:91], v[128:143]
buffer_load_dwordx4 v236, s[12:15], s59 offen offset:64 lds
v_mfma_f32_32x32x16_bf16 v[128:143], a[76:79], v[92:95], v[128:143]
s_waitcnt lgkmcnt(0)
s_add_u32 s59, s53, 1
s_and_b32 s59, s59, 7
s_add_u32 m0, s32, 4096
s_mul_i32 s59, s59, 176128
ds_read_b128 a[64:67], v233 offset:28672
v_dot2c_f32_bf16 v237, s58, v96
v_dot2c_f32_bf16 v239, v96, v96
v_dot2c_f32_bf16 v238, s58, v97
v_dot2c_f32_bf16 v240, v97, v97
ds_read_b128 a[68:71], v233 offset:29696
v_dot2c_f32_bf16 v237, s58, v98
v_dot2c_f32_bf16 v239, v98, v98
v_dot2c_f32_bf16 v238, s58, v99
v_dot2c_f32_bf16 v240, v99, v99
ds_read_b128 a[72:75], v233 offset:30720
v_dot2c_f32_bf16 v237, s58, v100
v_dot2c_f32_bf16 v239, v100, v100
buffer_load_dwordx4 v236, s[8:11], s59 offen offset:0 lds
s_add_u32 m0, s32, 5056
v_dot2c_f32_bf16 v238, s58, v101
v_dot2c_f32_bf16 v240, v101, v101
ds_read_b128 a[76:79], v233 offset:31744
v_dot2c_f32_bf16 v237, s58, v102
v_dot2c_f32_bf16 v239, v102, v102
v_dot2c_f32_bf16 v238, s58, v103
v_dot2c_f32_bf16 v240, v103, v103
s_waitcnt vmcnt(5)
ds_read_b128 v[112:115], v229 offset:28672
v_dot2c_f32_bf16 v237, s58, v104
v_dot2c_f32_bf16 v239, v104, v104
v_dot2c_f32_bf16 v238, s58, v105
v_dot2c_f32_bf16 v240, v105, v105
ds_read_b128 v[116:119], v230 offset:28672
buffer_load_dwordx4 v236, s[8:11], s59 offen offset:64 lds
s_add_u32 m0, s32, 6144
v_dot2c_f32_bf16 v237, s58, v106
v_dot2c_f32_bf16 v239, v106, v106
v_dot2c_f32_bf16 v238, s58, v107
v_dot2c_f32_bf16 v240, v107, v107
ds_read_b128 v[120:123], v231 offset:28672
v_dot2c_f32_bf16 v237, s58, v108
v_dot2c_f32_bf16 v239, v108, v108
v_dot2c_f32_bf16 v238, s58, v109
v_dot2c_f32_bf16 v240, v109, v109
ds_read_b128 v[124:127], v232 offset:28672
v_dot2c_f32_bf16 v237, s58, v110
v_dot2c_f32_bf16 v239, v110, v110
v_dot2c_f32_bf16 v238, s58, v111
v_dot2c_f32_bf16 v240, v111, v111
v_mfma_f32_32x32x16_bf16 v[128:143], a[48:51], v[96:99], v[128:143]
buffer_load_dwordx4 v236, s[12:15], s59 offen offset:0 lds
s_add_u32 m0, s32, 7104
v_mfma_f32_32x32x16_bf16 v[128:143], a[52:55], v[100:103], v[128:143]
v_mfma_f32_32x32x16_bf16 v[128:143], a[56:59], v[104:107], v[128:143]
buffer_load_dwordx4 v236, s[12:15], s59 offen offset:64 lds
v_mfma_f32_32x32x16_bf16 v[128:143], a[60:63], v[108:111], v[128:143]
s_waitcnt lgkmcnt(0)
s_add_u32 s59, s53, 2
s_and_b32 s59, s59, 7
s_add_u32 m0, s32, 8192
s_mul_i32 s59, s59, 176128
v_dot2c_f32_bf16 v237, s58, v112
v_dot2c_f32_bf16 v239, v112, v112
v_dot2c_f32_bf16 v238, s58, v113
v_dot2c_f32_bf16 v240, v113, v113
v_dot2c_f32_bf16 v237, s58, v114
v_dot2c_f32_bf16 v239, v114, v114
v_dot2c_f32_bf16 v238, s58, v115
v_dot2c_f32_bf16 v240, v115, v115
v_dot2c_f32_bf16 v237, s58, v116
v_dot2c_f32_bf16 v239, v116, v116
buffer_load_dwordx4 v236, s[8:11], s59 offen offset:0 lds
s_add_u32 m0, s32, 9152
v_dot2c_f32_bf16 v238, s58, v117
v_dot2c_f32_bf16 v240, v117, v117
v_dot2c_f32_bf16 v237, s58, v118
v_dot2c_f32_bf16 v239, v118, v118
v_dot2c_f32_bf16 v238, s58, v119
v_dot2c_f32_bf16 v240, v119, v119
v_dot2c_f32_bf16 v237, s58, v120
v_dot2c_f32_bf16 v239, v120, v120
v_dot2c_f32_bf16 v238, s58, v121
v_dot2c_f32_bf16 v240, v121, v121
v_dot2c_f32_bf16 v237, s58, v122
buffer_load_dwordx4 v236, s[8:11], s59 offen offset:64 lds
s_add_u32 m0, s32, 10240
v_dot2c_f32_bf16 v239, v122, v122
v_dot2c_f32_bf16 v238, s58, v123
v_dot2c_f32_bf16 v240, v123, v123
v_dot2c_f32_bf16 v237, s58, v124
v_dot2c_f32_bf16 v239, v124, v124
v_dot2c_f32_bf16 v238, s58, v125
v_dot2c_f32_bf16 v240, v125, v125
v_dot2c_f32_bf16 v237, s58, v126
v_dot2c_f32_bf16 v239, v126, v126
v_dot2c_f32_bf16 v238, s58, v127
v_dot2c_f32_bf16 v240, v127, v127
v_mfma_f32_32x32x16_bf16 v[128:143], a[64:67], v[112:115], v[128:143]
buffer_load_dwordx4 v236, s[12:15], s59 offen offset:0 lds
s_add_u32 m0, s32, 11200
v_mfma_f32_32x32x16_bf16 v[128:143], a[68:71], v[116:119], v[128:143]
v_mfma_f32_32x32x16_bf16 v[128:143], a[72:75], v[120:123], v[128:143]
buffer_load_dwordx4 v236, s[12:15], s59 offen offset:64 lds
v_mfma_f32_32x32x16_bf16 v[128:143], a[76:79], v[124:127], v[128:143]
s_add_u32 s59, s53, 3
s_and_b32 s59, s59, 7
s_add_u32 m0, s32, 12288
s_mul_i32 s59, s59, 176128
buffer_load_dwordx4 v236, s[8:11], s59 offen offset:0 lds
s_add_u32 m0, s32, 13248
s_nop 0
buffer_load_dwordx4 v236, s[8:11], s59 offen offset:64 lds
s_add_u32 m0, s32, 14336
s_nop 0
buffer_load_dwordx4 v236, s[12:15], s59 offen offset:0 lds
s_add_u32 m0, s32, 15296
s_nop 0
buffer_load_dwordx4 v236, s[12:15], s59 offen offset:64 lds
s_movk_i32 s60, 0x200
v_lshrrev_b32 v227, 5, v224
v_bfe_u32 v228, v224, 3, 2
v_mul_u32_u24 v228, 16448, v228
v_mul_u32_u24 v227, 514, v227
v_and_b32 v225, 7, v224
v_lshlrev_b32 v225, 4, v225
v_add3_u32 v225, v225, v227, v228
v_bfe_u32 v227, v224, 2, 2
v_lshlrev_b32 v227, 7, v227
v_lshrrev_b32 v228, 4, v224
v_lshlrev_b32 v228, 5, v228
v_add3_u32 v227, v227, v228, s45
v_and_b32 v228, 3, v224
v_lshlrev_b32 v228, 3, v228
v_add_u32 v229, v227, v228
v_bfe_u32 v227, v224, 2, 3
v_and_b32 v228, 3, v224
v_mul_u32_u24 v228, 16448, v228
v_mul_u32_u24 v227, 514, v227
v_add3_u32 v226, v227, v228, s60
v_lshlrev_b32 v228, 2, v224
v_add_u32 v228, 2097152, v228
v_cmp_gt_u32 vcc, 32, v224
v_mov_b32 v227, 0x7ff00000
s_nop 0
v_cndmask_b32 v255, v227, v228, vcc
v_add_f32 v237, v237, v238
v_add_f32 v239, v239, v240
v_mov_b32 v244, v237
v_mov_b32 v245, v239
s_nop 0
v_permlane32_swap_b32 v237, v244
v_permlane32_swap_b32 v239, v245
v_add_f32 v237, v237, v244
v_add_f32 v239, v239, v245
v_mul_f32 v237, 0x3b000000, v237
v_mul_f32 v239, 0x3b000000, v239
v_fma_f32 v239, -v237, v237, v239
v_max_f32 v239, 0, v239
v_cvt_pk_bf16_f32 v244, v237, v239
v_and_b32 v245, s57, v244
v_lshlrev_b32 v243, 16, v244
v_add_f32 v245, 0x3727c5ac, v245
v_cvt_pk_bf16_f32 v245, v245, v245
v_lshlrev_b32 v245, 16, v245
v_sqrt_f32 v245, v245
v_cmp_gt_u32 vcc, 32, v224
v_cvt_pk_bf16_f32 v245, v245, v245
s_cmp_eq_u32 s30, 0
s_cselect_b64 vcc, vcc, 0
v_lshlrev_b32 v245, 16, v245
v_mul_f32 v244, 0x44000000, v243
v_rcp_f32 v241, v245
v_cndmask_b32 v244, 0, v244, vcc
v_mul_f32 v242, v243, v241
v_sub_f32 v128, v128, v244
v_sub_f32 v242, 0, v242
s_waitcnt vmcnt(12)
s_barrier
ds_read_b64_tr_b16 a[0:1], v234 offset:0
ds_read_b64_tr_b16 a[2:3], v234 offset:256
ds_read_b64_tr_b16 a[4:5], v234 offset:2048
ds_read_b64_tr_b16 a[6:7], v234 offset:2304
ds_read_b64_tr_b16 a[8:9], v234 offset:1024
ds_read_b64_tr_b16 a[10:11], v234 offset:1280
ds_read_b64_tr_b16 a[12:13], v234 offset:3072
ds_read_b64_tr_b16 a[14:15], v234 offset:3328
v_mul_f32 v128, v128, v241
v_mul_f32 v129, v129, v241
v_cvt_pk_bf16_f32 v144, v128, v129
v_mul_f32 v130, v130, v241
v_mul_f32 v131, v131, v241
v_cvt_pk_bf16_f32 v145, v130, v131
v_mul_f32 v132, v132, v241
v_mul_f32 v133, v133, v241
v_cvt_pk_bf16_f32 v146, v132, v133
v_mul_f32 v134, v134, v241
v_mul_f32 v135, v135, v241
v_cvt_pk_bf16_f32 v147, v134, v135
v_mul_f32 v136, v136, v241
v_mul_f32 v137, v137, v241
v_cvt_pk_bf16_f32 v148, v136, v137
v_mul_f32 v138, v138, v241
v_mul_f32 v139, v139, v241
v_cvt_pk_bf16_f32 v149, v138, v139
v_mul_f32 v140, v140, v241
v_mul_f32 v141, v141, v241
v_cvt_pk_bf16_f32 v150, v140, v141
v_mul_f32 v142, v142, v241
v_mul_f32 v143, v143, v241
v_cvt_pk_bf16_f32 v151, v142, v143
v_lshlrev_b32 v244, 16, v0
v_and_b32 v245, s57, v0
v_lshlrev_b32 v246, 16, v1
v_and_b32 v247, s57, v1
v_fma_f32 v244, v244, v241, v242
v_fma_f32 v245, v245, v241, v242
v_fma_f32 v246, v246, v241, v242
v_fma_f32 v247, v247, v241, v242
v_cvt_pk_bf16_f32 v0, v244, v245
v_cvt_pk_bf16_f32 v1, v246, v247
v_lshlrev_b32 v248, 16, v2
v_and_b32 v249, s57, v2
v_lshlrev_b32 v250, 16, v3
v_and_b32 v251, s57, v3
v_fma_f32 v248, v248, v241, v242
v_fma_f32 v249, v249, v241, v242
v_fma_f32 v250, v250, v241, v242
v_fma_f32 v251, v251, v241, v242
v_cvt_pk_bf16_f32 v2, v248, v249
v_cvt_pk_bf16_f32 v3, v250, v251
s_mov_b32 s60, 0
buffer_store_dword v144, v253, s[16:19], s60 offen sc1
s_mov_b32 s60, 8192
buffer_store_dword v145, v253, s[16:19], s60 offen sc1
s_mov_b32 s60, 32768
buffer_store_dword v146, v253, s[16:19], s60 offen sc1
s_mov_b32 s60, 40960
buffer_store_dword v147, v253, s[16:19], s60 offen sc1
s_mov_b32 s60, 65536
buffer_store_dword v148, v253, s[16:19], s60 offen sc1
s_mov_b32 s60, 73728
buffer_store_dword v149, v253, s[16:19], s60 offen sc1
s_mov_b32 s60, 98304
buffer_store_dword v150, v253, s[16:19], s60 offen sc1
s_mov_b32 s60, 106496
buffer_store_dword v151, v253, s[16:19], s60 offen sc1
s_waitcnt lgkmcnt(4)
v_mfma_f32_32x32x16_bf16 v[128:143], a[0:3], v[0:3], 0
s_add_u32 m0, s45, 0
s_nop 0
buffer_load_dwordx4 v225, s[20:23], s44 offen offset:0 lds
ds_read_b64_tr_b16 a[24:25], v234 offset:32768
ds_read_b64_tr_b16 a[26:27], v234 offset:33024
v_lshlrev_b32 v244, 16, v4
v_mfma_f32_32x32x16_bf16 v[144:159], a[4:7], v[0:3], 0
ds_read_b64_tr_b16 a[28:29], v234 offset:34816
ds_read_b64_tr_b16 a[30:31], v234 offset:35072
v_and_b32 v245, s57, v4
v_lshlrev_b32 v246, 16, v5
v_and_b32 v247, s57, v5
v_fma_f32 v244, v244, v241, v242
v_fma_f32 v245, v245, v241, v242
v_fma_f32 v246, v246, v241, v242
v_fma_f32 v247, v247, v241, v242
v_cvt_pk_bf16_f32 v4, v244, v245
s_waitcnt lgkmcnt(4)
v_mfma_f32_32x32x16_bf16 v[160:175], a[8:11], v[0:3], 0
s_sub_u32 m0, s45, 4
s_nop 0
buffer_load_dwordx4 v225, s[20:23], s44 offen offset:1028 lds
ds_read_b64_tr_b16 a[32:33], v234 offset:33792
ds_read_b64_tr_b16 a[34:35], v234 offset:34048
v_cvt_pk_bf16_f32 v5, v246, v247
v_mfma_f32_32x32x16_bf16 v[176:191], a[12:15], v[0:3], 0
ds_read_b64_tr_b16 a[36:37], v234 offset:35840
ds_read_b64_tr_b16 a[38:39], v234 offset:36096
v_lshlrev_b32 v248, 16, v6
v_and_b32 v249, s57, v6
v_lshlrev_b32 v250, 16, v7
v_and_b32 v251, s57, v7
v_fma_f32 v248, v248, v241, v242
v_fma_f32 v249, v249, v241, v242
v_fma_f32 v250, v250, v241, v242
v_fma_f32 v251, v251, v241, v242
v_cvt_pk_bf16_f32 v6, v248, v249
v_cvt_pk_bf16_f32 v7, v250, v251
s_waitcnt lgkmcnt(4)
s_nop 0
v_mfma_f32_32x32x16_bf16 v[128:143], a[24:27], v[4:7], v[128:143]
s_sub_u32 m0, s45, 8
s_nop 0
buffer_load_dwordx4 v225, s[20:23], s44 offen offset:2056 lds
ds_read_b64_tr_b16 a[0:1], v235 offset:0
ds_read_b64_tr_b16 a[2:3], v235 offset:256
v_lshlrev_b32 v244, 16, v8
v_and_b32 v245, s57, v8
v_lshlrev_b32 v246, 16, v9
v_and_b32 v247, s57, v9
v_mfma_f32_32x32x16_bf16 v[144:159], a[28:31], v[4:7], v[144:159]
s_sub_u32 m0, s45, 12
s_nop 0
buffer_load_dwordx4 v225, s[20:23], s44 offen offset:3084 lds
ds_read_b64_tr_b16 a[4:5], v235 offset:2048
ds_read_b64_tr_b16 a[6:7], v235 offset:2304
v_fma_f32 v244, v244, v241, v242
v_fma_f32 v245, v245, v241, v242
v_fma_f32 v246, v246, v241, v242
s_waitcnt lgkmcnt(4)
v_mfma_f32_32x32x16_bf16 v[160:175], a[32:35], v[4:7], v[160:175]
buffer_load_ushort v233, v226, s[20:23], s42 offen
ds_read_b64_tr_b16 a[8:9], v235 offset:1024
ds_read_b64_tr_b16 a[10:11], v235 offset:1280
v_fma_f32 v247, v247, v241, v242
v_cvt_pk_bf16_f32 v8, v244, v245
v_cvt_pk_bf16_f32 v9, v246, v247
v_lshlrev_b32 v248, 16, v10
v_and_b32 v249, s57, v10
v_lshlrev_b32 v250, 16, v11
v_mfma_f32_32x32x16_bf16 v[176:191], a[36:39], v[4:7], v[176:191]
buffer_load_ushort v232, v226, s[24:27], s42 offen
ds_read_b64_tr_b16 a[12:13], v235 offset:3072
ds_read_b64_tr_b16 a[14:15], v235 offset:3328
v_and_b32 v251, s57, v11
v_fma_f32 v248, v248, v241, v242
v_fma_f32 v249, v249, v241, v242
v_fma_f32 v250, v250, v241, v242
v_fma_f32 v251, v251, v241, v242
v_cvt_pk_bf16_f32 v10, v248, v249
v_cvt_pk_bf16_f32 v11, v250, v251
s_waitcnt lgkmcnt(4)
s_nop 0
v_mfma_f32_32x32x16_bf16 v[128:143], a[0:3], v[8:11], v[128:143]
s_add_u32 m0, s45, 4096
s_nop 0
buffer_load_dwordx4 v225, s[24:27], s44 offen offset:0 lds
ds_read_b64_tr_b16 a[24:25], v235 offset:32768
ds_read_b64_tr_b16 a[26:27], v235 offset:33024
v_lshlrev_b32 v244, 16, v12
v_mfma_f32_32x32x16_bf16 v[144:159], a[4:7], v[8:11], v[144:159]
ds_read_b64_tr_b16 a[28:29], v235 offset:34816
ds_read_b64_tr_b16 a[30:31], v235 offset:35072
v_and_b32 v245, s57, v12
v_lshlrev_b32 v246, 16, v13
v_and_b32 v247, s57, v13
v_fma_f32 v244, v244, v241, v242
v_fma_f32 v245, v245, v241, v242
v_fma_f32 v246, v246, v241, v242
v_fma_f32 v247, v247, v241, v242
v_cvt_pk_bf16_f32 v12, v244, v245
s_waitcnt lgkmcnt(4)
v_mfma_f32_32x32x16_bf16 v[160:175], a[8:11], v[8:11], v[160:175]
s_add_u32 m0, s45, 4092
s_nop 0
buffer_load_dwordx4 v225, s[24:27], s44 offen offset:1028 lds
ds_read_b64_tr_b16 a[32:33], v235 offset:33792
ds_read_b64_tr_b16 a[34:35], v235 offset:34048
v_cvt_pk_bf16_f32 v13, v246, v247
v_mfma_f32_32x32x16_bf16 v[176:191], a[12:15], v[8:11], v[176:191]
ds_read_b64_tr_b16 a[36:37], v235 offset:35840
ds_read_b64_tr_b16 a[38:39], v235 offset:36096
v_lshlrev_b32 v248, 16, v14
v_and_b32 v249, s57, v14
v_lshlrev_b32 v250, 16, v15
v_and_b32 v251, s57, v15
v_fma_f32 v248, v248, v241, v242
v_fma_f32 v249, v249, v241, v242
v_fma_f32 v250, v250, v241, v242
v_fma_f32 v251, v251, v241, v242
v_cvt_pk_bf16_f32 v14, v248, v249
v_cvt_pk_bf16_f32 v15, v250, v251
s_waitcnt vmcnt(24)
s_barrier
s_waitcnt lgkmcnt(4)
v_mfma_f32_32x32x16_bf16 v[128:143], a[24:27], v[12:15], v[128:143]
s_add_u32 m0, s45, 4088
s_nop 0
buffer_load_dwordx4 v225, s[24:27], s44 offen offset:2056 lds
ds_read_b64_tr_b16 a[0:1], v234 offset:4096
ds_read_b64_tr_b16 a[2:3], v234 offset:4352
v_lshlrev_b32 v244, 16, v16
v_mfma_f32_32x32x16_bf16 v[144:159], a[28:31], v[12:15], v[144:159]
ds_read_b64_tr_b16 a[4:5], v234 offset:6144
ds_read_b64_tr_b16 a[6:7], v234 offset:6400
v_and_b32 v245, s57, v16
v_lshlrev_b32 v246, 16, v17
v_and_b32 v247, s57, v17
v_fma_f32 v244, v244, v241, v242
v_fma_f32 v245, v245, v241, v242
v_fma_f32 v246, v246, v241, v242
v_fma_f32 v247, v247, v241, v242
v_cvt_pk_bf16_f32 v16, v244, v245
s_waitcnt lgkmcnt(4)
v_mfma_f32_32x32x16_bf16 v[160:175], a[32:35], v[12:15], v[160:175]
s_add_u32 m0, s45, 4084
s_nop 0
buffer_load_dwordx4 v225, s[24:27], s44 offen offset:3084 lds
ds_read_b64_tr_b16 a[8:9], v234 offset:5120
ds_read_b64_tr_b16 a[10:11], v234 offset:5376
v_cvt_pk_bf16_f32 v17, v246, v247
v_mfma_f32_32x32x16_bf16 v[176:191], a[36:39], v[12:15], v[176:191]
ds_read_b64_tr_b16 a[12:13], v234 offset:7168
ds_read_b64_tr_b16 a[14:15], v234 offset:7424
v_lshlrev_b32 v248, 16, v18
v_and_b32 v249, s57, v18
v_lshlrev_b32 v250, 16, v19
v_and_b32 v251, s57, v19
v_fma_f32 v248, v248, v241, v242
v_fma_f32 v249, v249, v241, v242
v_fma_f32 v250, v250, v241, v242
v_fma_f32 v251, v251, v241, v242
v_cvt_pk_bf16_f32 v18, v248, v249
v_cvt_pk_bf16_f32 v19, v250, v251
s_waitcnt lgkmcnt(4)
s_nop 0
v_mfma_f32_32x32x16_bf16 v[128:143], a[0:3], v[16:19], v[128:143]
s_add_u32 s59, s53, 4
s_and_b32 s59, s59, 7
s_add_u32 m0, s32, 16384
s_mul_i32 s59, s59, 176128
ds_read_b64_tr_b16 a[24:25], v234 offset:36864
ds_read_b64_tr_b16 a[26:27], v234 offset:37120
v_lshlrev_b32 v244, 16, v20
v_and_b32 v245, s57, v20
v_lshlrev_b32 v246, 16, v21
v_and_b32 v247, s57, v21
v_fma_f32 v244, v244, v241, v242
v_fma_f32 v245, v245, v241, v242
v_mfma_f32_32x32x16_bf16 v[144:159], a[4:7], v[16:19], v[144:159]
buffer_load_dwordx4 v236, s[8:11], s59 offen offset:0 lds
s_add_u32 m0, s32, 17344
ds_read_b64_tr_b16 a[28:29], v234 offset:38912
ds_read_b64_tr_b16 a[30:31], v234 offset:39168
v_fma_f32 v246, v246, v241, v242
s_waitcnt lgkmcnt(4)
v_mfma_f32_32x32x16_bf16 v[160:175], a[8:11], v[16:19], v[160:175]
buffer_load_dwordx4 v236, s[8:11], s59 offen offset:64 lds
s_add_u32 m0, s32, 18432
ds_read_b64_tr_b16 a[32:33], v234 offset:37888
ds_read_b64_tr_b16 a[34:35], v234 offset:38144
v_fma_f32 v247, v247, v241, v242
v_cvt_pk_bf16_f32 v20, v244, v245
v_mfma_f32_32x32x16_bf16 v[176:191], a[12:15], v[16:19], v[176:191]
ds_read_b64_tr_b16 a[36:37], v234 offset:39936
ds_read_b64_tr_b16 a[38:39], v234 offset:40192
v_cvt_pk_bf16_f32 v21, v246, v247
v_lshlrev_b32 v248, 16, v22
v_and_b32 v249, s57, v22
v_lshlrev_b32 v250, 16, v23
v_and_b32 v251, s57, v23
v_fma_f32 v248, v248, v241, v242
v_fma_f32 v249, v249, v241, v242
v_fma_f32 v250, v250, v241, v242
v_fma_f32 v251, v251, v241, v242
v_cvt_pk_bf16_f32 v22, v248, v249
v_cvt_pk_bf16_f32 v23, v250, v251
s_waitcnt lgkmcnt(4)
s_nop 0
v_mfma_f32_32x32x16_bf16 v[128:143], a[24:27], v[20:23], v[128:143]
buffer_load_dwordx4 v236, s[12:15], s59 offen offset:0 lds
s_add_u32 m0, s32, 19392
ds_read_b64_tr_b16 a[0:1], v235 offset:4096
ds_read_b64_tr_b16 a[2:3], v235 offset:4352
v_lshlrev_b32 v244, 16, v24
v_mfma_f32_32x32x16_bf16 v[144:159], a[28:31], v[20:23], v[144:159]
ds_read_b64_tr_b16 a[4:5], v235 offset:6144
ds_read_b64_tr_b16 a[6:7], v235 offset:6400
v_and_b32 v245, s57, v24
v_lshlrev_b32 v246, 16, v25
v_and_b32 v247, s57, v25
v_fma_f32 v244, v244, v241, v242
v_fma_f32 v245, v245, v241, v242
v_fma_f32 v246, v246, v241, v242
v_fma_f32 v247, v247, v241, v242
v_cvt_pk_bf16_f32 v24, v244, v245
s_waitcnt lgkmcnt(4)
v_mfma_f32_32x32x16_bf16 v[160:175], a[32:35], v[20:23], v[160:175]
buffer_load_dwordx4 v236, s[12:15], s59 offen offset:64 lds
ds_read_b64_tr_b16 a[8:9], v235 offset:5120
ds_read_b64_tr_b16 a[10:11], v235 offset:5376
v_cvt_pk_bf16_f32 v25, v246, v247
v_lshlrev_b32 v248, 16, v26
v_mfma_f32_32x32x16_bf16 v[176:191], a[36:39], v[20:23], v[176:191]
ds_read_b64_tr_b16 a[12:13], v235 offset:7168
ds_read_b64_tr_b16 a[14:15], v235 offset:7424
v_and_b32 v249, s57, v26
v_lshlrev_b32 v250, 16, v27
v_and_b32 v251, s57, v27
v_fma_f32 v248, v248, v241, v242
v_fma_f32 v249, v249, v241, v242
v_fma_f32 v250, v250, v241, v242
v_fma_f32 v251, v251, v241, v242
v_cvt_pk_bf16_f32 v26, v248, v249
v_cvt_pk_bf16_f32 v27, v250, v251
s_waitcnt lgkmcnt(4)
s_nop 0
v_mfma_f32_32x32x16_bf16 v[128:143], a[0:3], v[24:27], v[128:143]
s_add_u32 s59, s53, 5
s_and_b32 s59, s59, 7
s_add_u32 m0, s32, 20480
s_mul_i32 s59, s59, 176128
buffer_load_dwordx4 v236, s[8:11], s59 offen offset:0 lds
s_add_u32 m0, s32, 21440
ds_read_b64_tr_b16 a[24:25], v235 offset:36864
ds_read_b64_tr_b16 a[26:27], v235 offset:37120
v_mfma_f32_32x32x16_bf16 v[144:159], a[4:7], v[24:27], v[144:159]
buffer_load_dwordx4 v236, s[8:11], s59 offen offset:64 lds
s_add_u32 m0, s32, 22528
ds_read_b64_tr_b16 a[28:29], v235 offset:38912
ds_read_b64_tr_b16 a[30:31], v235 offset:39168
v_lshlrev_b32 v244, 16, v28
v_and_b32 v245, s57, v28
v_lshlrev_b32 v246, 16, v29
s_waitcnt lgkmcnt(4)
v_mfma_f32_32x32x16_bf16 v[160:175], a[8:11], v[24:27], v[160:175]
s_waitcnt vmcnt(10)
v_lshl_or_b32 v232, v232, 16, v233
ds_read_b64_tr_b16 a[32:33], v235 offset:37888
ds_read_b64_tr_b16 a[34:35], v235 offset:38144
v_and_b32 v247, s57, v29
v_fma_f32 v244, v244, v241, v242
v_fma_f32 v245, v245, v241, v242
v_fma_f32 v246, v246, v241, v242
v_fma_f32 v247, v247, v241, v242
v_cvt_pk_bf16_f32 v28, v244, v245
v_cvt_pk_bf16_f32 v29, v246, v247
v_lshlrev_b32 v248, 16, v30
v_and_b32 v249, s57, v30
v_lshlrev_b32 v250, 16, v31
v_and_b32 v251, s57, v31
v_mfma_f32_32x32x16_bf16 v[176:191], a[12:15], v[24:27], v[176:191]
buffer_store_dword v232, v255, s[16:19], s40 offen sc1
ds_read_b64_tr_b16 a[36:37], v235 offset:39936
ds_read_b64_tr_b16 a[38:39], v235 offset:40192
v_fma_f32 v248, v248, v241, v242
v_fma_f32 v249, v249, v241, v242
v_fma_f32 v250, v250, v241, v242
v_fma_f32 v251, v251, v241, v242
v_cvt_pk_bf16_f32 v30, v248, v249
v_cvt_pk_bf16_f32 v31, v250, v251
s_barrier
s_waitcnt lgkmcnt(4)
v_mfma_f32_32x32x16_bf16 v[128:143], a[24:27], v[28:31], v[128:143]
buffer_load_dwordx4 v236, s[12:15], s59 offen offset:0 lds
s_add_u32 m0, s32, 23488
ds_read_b64_tr_b16 a[0:1], v234 offset:8192
ds_read_b64_tr_b16 a[2:3], v234 offset:8448
v_lshlrev_b32 v244, 16, v32
v_mfma_f32_32x32x16_bf16 v[144:159], a[28:31], v[28:31], v[144:159]
ds_read_b64_tr_b16 a[4:5], v234 offset:10240
ds_read_b64_tr_b16 a[6:7], v234 offset:10496
v_and_b32 v245, s57, v32
v_lshlrev_b32 v246, 16, v33
v_and_b32 v247, s57, v33
v_fma_f32 v244, v244, v241, v242
v_fma_f32 v245, v245, v241, v242
v_fma_f32 v246, v246, v241, v242
v_fma_f32 v247, v247, v241, v242
v_cvt_pk_bf16_f32 v32, v244, v245
s_waitcnt lgkmcnt(4)
v_mfma_f32_32x32x16_bf16 v[160:175], a[32:35], v[28:31], v[160:175]
buffer_load_dwordx4 v236, s[12:15], s59 offen offset:64 lds
ds_read_b64_tr_b16 a[8:9], v234 offset:9216
ds_read_b64_tr_b16 a[10:11], v234 offset:9472
v_cvt_pk_bf16_f32 v33, v246, v247
v_lshlrev_b32 v248, 16, v34
v_mfma_f32_32x32x16_bf16 v[176:191], a[36:39], v[28:31], v[176:191]
ds_read_b64_tr_b16 a[12:13], v234 offset:11264
ds_read_b64_tr_b16 a[14:15], v234 offset:11520
v_and_b32 v249, s57, v34
v_lshlrev_b32 v250, 16, v35
v_and_b32 v251, s57, v35
v_fma_f32 v248, v248, v241, v242
v_fma_f32 v249, v249, v241, v242
v_fma_f32 v250, v250, v241, v242
v_fma_f32 v251, v251, v241, v242
v_cvt_pk_bf16_f32 v34, v248, v249
v_cvt_pk_bf16_f32 v35, v250, v251
s_waitcnt lgkmcnt(4)
s_nop 0
v_mfma_f32_32x32x16_bf16 v[128:143], a[0:3], v[32:35], v[128:143]
s_and_b32 s34, s2, 7
s_lshr_b32 s35, s2, 3
s_lshl_b32 s36, s34, 2
s_and_b32 s37, s35, 3
ds_read_b64_tr_b16 a[24:25], v234 offset:40960
ds_read_b64_tr_b16 a[26:27], v234 offset:41216
v_lshlrev_b32 v244, 16, v36
v_and_b32 v245, s57, v36
v_lshlrev_b32 v246, 16, v37
v_and_b32 v247, s57, v37
v_fma_f32 v244, v244, v241, v242
v_fma_f32 v245, v245, v241, v242
v_mfma_f32_32x32x16_bf16 v[144:159], a[4:7], v[32:35], v[144:159]
s_add_u32 s36, s36, s37
s_lshr_b32 s35, s35, 2
s_mul_i32 s36, s36, 44032
ds_read_b64_tr_b16 a[28:29], v234 offset:43008
ds_read_b64_tr_b16 a[30:31], v234 offset:43264
v_fma_f32 v246, v246, v241, v242
v_fma_f32 v247, v247, v241, v242
v_cvt_pk_bf16_f32 v36, v244, v245
v_cvt_pk_bf16_f32 v37, v246, v247
v_lshlrev_b32 v248, 16, v38
v_and_b32 v249, s57, v38
s_waitcnt lgkmcnt(4)
v_mfma_f32_32x32x16_bf16 v[160:175], a[8:11], v[32:35], v[160:175]
s_lshl_b32 s35, s35, 7
s_add_u32 s36, s36, s35
s_cmp_eq_u32 s28, 3
ds_read_b64_tr_b16 a[32:33], v234 offset:41984
ds_read_b64_tr_b16 a[34:35], v234 offset:42240
v_lshlrev_b32 v250, 16, v39
v_and_b32 v251, s57, v39
v_fma_f32 v248, v248, v241, v242
v_fma_f32 v249, v249, v241, v242
v_fma_f32 v250, v250, v241, v242
v_fma_f32 v251, v251, v241, v242
v_cvt_pk_bf16_f32 v38, v248, v249
v_mfma_f32_32x32x16_bf16 v[176:191], a[12:15], v[32:35], v[176:191]
s_cselect_b32 s36, s36, 0x7ff00000
v_lshlrev_b32 v243, 10, v224
buffer_load_dword a250, v243, s[64:67], s36 offen
ds_read_b64_tr_b16 a[36:37], v234 offset:44032
ds_read_b64_tr_b16 a[38:39], v234 offset:44288
v_cvt_pk_bf16_f32 v39, v250, v251
s_waitcnt lgkmcnt(4)
s_nop 0
v_mfma_f32_32x32x16_bf16 v[128:143], a[24:27], v[36:39], v[128:143]
s_waitcnt vmcnt(10)
ds_read_b64_tr_b16 v[192:193], v229 offset:0
ds_read_b64_tr_b16 v[194:195], v229 offset:4096
ds_read_b64_tr_b16 a[0:1], v235 offset:8192
ds_read_b64_tr_b16 a[2:3], v235 offset:8448
v_lshlrev_b32 v244, 16, v40
v_and_b32 v245, s57, v40
v_lshlrev_b32 v246, 16, v41
v_and_b32 v247, s57, v41
v_mfma_f32_32x32x16_bf16 v[144:159], a[28:31], v[36:39], v[144:159]
ds_read_b64_tr_b16 v[196:197], v229 offset:512
ds_read_b64_tr_b16 v[198:199], v229 offset:4608
ds_read_b64_tr_b16 a[4:5], v235 offset:10240
ds_read_b64_tr_b16 a[6:7], v235 offset:10496
v_fma_f32 v244, v244, v241, v242
v_fma_f32 v245, v245, v241, v242
v_fma_f32 v246, v246, v241, v242
v_fma_f32 v247, v247, v241, v242
s_waitcnt lgkmcnt(8)
v_mfma_f32_32x32x16_bf16 v[160:175], a[32:35], v[36:39], v[160:175]
ds_read_b64_tr_b16 v[200:201], v229 offset:1024
ds_read_b64_tr_b16 v[202:203], v229 offset:5120
ds_read_b64_tr_b16 a[8:9], v235 offset:9216
ds_read_b64_tr_b16 a[10:11], v235 offset:9472
v_cvt_pk_bf16_f32 v40, v244, v245
v_cvt_pk_bf16_f32 v41, v246, v247
v_lshlrev_b32 v248, 16, v42
v_and_b32 v249, s57, v42
v_lshlrev_b32 v250, 16, v43
v_mfma_f32_32x32x16_bf16 v[176:191], a[36:39], v[36:39], v[176:191]
ds_read_b64_tr_b16 v[204:205], v229 offset:1536
ds_read_b64_tr_b16 v[206:207], v229 offset:5632
ds_read_b64_tr_b16 a[12:13], v235 offset:11264
ds_read_b64_tr_b16 a[14:15], v235 offset:11520
v_and_b32 v251, s57, v43
v_fma_f32 v248, v248, v241, v242
v_fma_f32 v249, v249, v241, v242
v_fma_f32 v250, v250, v241, v242
v_fma_f32 v251, v251, v241, v242
v_cvt_pk_bf16_f32 v42, v248, v249
v_cvt_pk_bf16_f32 v43, v250, v251
s_waitcnt lgkmcnt(8)
s_nop 0
v_mfma_f32_32x32x16_bf16 v[128:143], a[0:3], v[40:43], v[128:143]
ds_read_b64_tr_b16 v[208:209], v229 offset:2048
ds_read_b64_tr_b16 v[210:211], v229 offset:6144
ds_read_b64_tr_b16 a[24:25], v235 offset:40960
ds_read_b64_tr_b16 a[26:27], v235 offset:41216
v_lshlrev_b32 v244, 16, v44
v_and_b32 v245, s57, v44
v_lshlrev_b32 v246, 16, v45
v_and_b32 v247, s57, v45
v_fma_f32 v244, v244, v241, v242
v_mfma_f32_32x32x16_bf16 v[144:159], a[4:7], v[40:43], v[144:159]
ds_read_b64_tr_b16 v[212:213], v229 offset:2560
ds_read_b64_tr_b16 v[214:215], v229 offset:6656
ds_read_b64_tr_b16 a[28:29], v235 offset:43008
ds_read_b64_tr_b16 a[30:31], v235 offset:43264
v_fma_f32 v245, v245, v241, v242
v_fma_f32 v246, v246, v241, v242
v_fma_f32 v247, v247, v241, v242
v_cvt_pk_bf16_f32 v44, v244, v245
s_waitcnt lgkmcnt(8)
v_mfma_f32_32x32x16_bf16 v[160:175], a[8:11], v[40:43], v[160:175]
ds_read_b64_tr_b16 v[216:217], v229 offset:3072
ds_read_b64_tr_b16 v[218:219], v229 offset:7168
ds_read_b64_tr_b16 a[32:33], v235 offset:41984
ds_read_b64_tr_b16 a[34:35], v235 offset:42240
v_cvt_pk_bf16_f32 v45, v246, v247
v_lshlrev_b32 v248, 16, v46
v_and_b32 v249, s57, v46
v_lshlrev_b32 v250, 16, v47
v_and_b32 v251, s57, v47
v_mfma_f32_32x32x16_bf16 v[176:191], a[12:15], v[40:43], v[176:191]
ds_read_b64_tr_b16 v[220:221], v229 offset:3584
ds_read_b64_tr_b16 v[222:223], v229 offset:7680
ds_read_b64_tr_b16 a[36:37], v235 offset:44032
ds_read_b64_tr_b16 a[38:39], v235 offset:44288
v_fma_f32 v248, v248, v241, v242
v_fma_f32 v249, v249, v241, v242
v_fma_f32 v250, v250, v241, v242
v_fma_f32 v251, v251, v241, v242
v_cvt_pk_bf16_f32 v46, v248, v249
v_cvt_pk_bf16_f32 v47, v250, v251
s_barrier
s_lshl_b32 s60, s30, 4
s_add_u32 s60, s60, s29
s_lshl_b32 s60, s60, 2
s_add_u32 s60, s60, 14680064
s_cmp_lg_u32 s28, 0
s_cbranch_scc1 L_parallel_sum__spectral_gfnet__glu_gated_reglu__prompt_kernel_flag_8
s_mov_b64 exec, 1
v_mov_b32 v237, 1
v_mov_b32 v238, 0
buffer_store_dword v237, v238, s[16:19], s60 offen sc1
s_mov_b64 exec, -1
L_parallel_sum__spectral_gfnet__glu_gated_reglu__prompt_kernel_flag_8:
s_waitcnt lgkmcnt(8)
v_mfma_f32_32x32x16_bf16 v[128:143], a[24:27], v[44:47], v[128:143]
v_perm_b32 v238, v194, v192, s39
v_perm_b32 v192, v194, v192, s38
v_perm_b32 v194, v195, v193, s38
v_perm_b32 v195, v195, v193, s39
v_mov_b32 v193, v238
ds_read_b64_tr_b16 a[0:1], v234 offset:12288
ds_read_b64_tr_b16 a[2:3], v234 offset:12544
v_lshlrev_b32 v244, 16, v48
v_and_b32 v245, s57, v48
v_lshlrev_b32 v246, 16, v49
v_and_b32 v247, s57, v49
v_fma_f32 v244, v244, v241, v242
v_mfma_f32_32x32x16_bf16 v[144:159], a[28:31], v[44:47], v[144:159]
v_perm_b32 v239, v198, v196, s39
v_perm_b32 v196, v198, v196, s38
v_perm_b32 v198, v199, v197, s38
v_perm_b32 v199, v199, v197, s39
v_mov_b32 v197, v239
ds_read_b64_tr_b16 a[4:5], v234 offset:14336
ds_read_b64_tr_b16 a[6:7], v234 offset:14592
v_fma_f32 v245, v245, v241, v242
v_fma_f32 v246, v246, v241, v242
v_fma_f32 v247, v247, v241, v242
v_cvt_pk_bf16_f32 v48, v244, v245
s_waitcnt lgkmcnt(4)
v_mfma_f32_32x32x16_bf16 v[160:175], a[32:35], v[44:47], v[160:175]
v_perm_b32 v238, v202, v200, s39
v_perm_b32 v200, v202, v200, s38
v_perm_b32 v202, v203, v201, s38
v_perm_b32 v203, v203, v201, s39
v_mov_b32 v201, v238
ds_read_b64_tr_b16 a[8:9], v234 offset:13312
ds_read_b64_tr_b16 a[10:11], v234 offset:13568
v_cvt_pk_bf16_f32 v49, v246, v247
v_lshlrev_b32 v248, 16, v50
v_and_b32 v249, s57, v50
v_lshlrev_b32 v250, 16, v51
v_and_b32 v251, s57, v51
v_mfma_f32_32x32x16_bf16 v[176:191], a[36:39], v[44:47], v[176:191]
v_perm_b32 v239, v206, v204, s39
v_perm_b32 v204, v206, v204, s38
v_perm_b32 v206, v207, v205, s38
v_perm_b32 v207, v207, v205, s39
v_mov_b32 v205, v239
ds_read_b64_tr_b16 a[12:13], v234 offset:15360
ds_read_b64_tr_b16 a[14:15], v234 offset:15616
v_fma_f32 v248, v248, v241, v242
v_fma_f32 v249, v249, v241, v242
v_fma_f32 v250, v250, v241, v242
v_fma_f32 v251, v251, v241, v242
v_cvt_pk_bf16_f32 v50, v248, v249
v_cvt_pk_bf16_f32 v51, v250, v251
s_waitcnt lgkmcnt(4)
s_nop 0
v_mfma_f32_32x32x16_bf16 v[128:143], a[0:3], v[48:51], v[128:143]
v_perm_b32 v238, v210, v208, s39
v_perm_b32 v208, v210, v208, s38
v_perm_b32 v210, v211, v209, s38
v_perm_b32 v211, v211, v209, s39
v_mov_b32 v209, v238
ds_read_b64_tr_b16 a[24:25], v234 offset:45056
ds_read_b64_tr_b16 a[26:27], v234 offset:45312
v_lshlrev_b32 v244, 16, v52
v_and_b32 v245, s57, v52
v_lshlrev_b32 v246, 16, v53
v_and_b32 v247, s57, v53
v_fma_f32 v244, v244, v241, v242
v_mfma_f32_32x32x16_bf16 v[144:159], a[4:7], v[48:51], v[144:159]
v_perm_b32 v239, v214, v212, s39
v_perm_b32 v212, v214, v212, s38
v_perm_b32 v214, v215, v213, s38
v_perm_b32 v215, v215, v213, s39
v_mov_b32 v213, v239
ds_read_b64_tr_b16 a[28:29], v234 offset:47104
ds_read_b64_tr_b16 a[30:31], v234 offset:47360
v_fma_f32 v245, v245, v241, v242
v_fma_f32 v246, v246, v241, v242
v_fma_f32 v247, v247, v241, v242
v_cvt_pk_bf16_f32 v52, v244, v245
s_waitcnt lgkmcnt(4)
v_mfma_f32_32x32x16_bf16 v[160:175], a[8:11], v[48:51], v[160:175]
v_perm_b32 v238, v218, v216, s39
v_perm_b32 v216, v218, v216, s38
v_perm_b32 v218, v219, v217, s38
v_perm_b32 v219, v219, v217, s39
v_mov_b32 v217, v238
ds_read_b64_tr_b16 a[32:33], v234 offset:46080
ds_read_b64_tr_b16 a[34:35], v234 offset:46336
v_cvt_pk_bf16_f32 v53, v246, v247
v_lshlrev_b32 v248, 16, v54
v_and_b32 v249, s57, v54
v_lshlrev_b32 v250, 16, v55
v_and_b32 v251, s57, v55
v_mfma_f32_32x32x16_bf16 v[176:191], a[12:15], v[48:51], v[176:191]
v_perm_b32 v239, v222, v220, s39
v_perm_b32 v220, v222, v220, s38
v_perm_b32 v222, v223, v221, s38
v_perm_b32 v223, v223, v221, s39
v_mov_b32 v221, v239
ds_read_b64_tr_b16 a[36:37], v234 offset:48128
ds_read_b64_tr_b16 a[38:39], v234 offset:48384
v_fma_f32 v248, v248, v241, v242
v_fma_f32 v249, v249, v241, v242
v_fma_f32 v250, v250, v241, v242
v_fma_f32 v251, v251, v241, v242
v_cvt_pk_bf16_f32 v54, v248, v249
v_cvt_pk_bf16_f32 v55, v250, v251
s_waitcnt lgkmcnt(4)
s_nop 0
v_mfma_f32_32x32x16_bf16 v[128:143], a[24:27], v[52:55], v[128:143]
v_lshlrev_b32 v227, 7, v224
v_add_u32 v227, s45, v227
v_and_b32 v228, 7, v224
v_lshlrev_b32 v228, 4, v228
v_xor_b32 v225, 0, v228
v_add_u32 v225, v225, v227
ds_write_b128 v225, v[192:195]
ds_read_b64_tr_b16 a[0:1], v235 offset:12288
ds_read_b64_tr_b16 a[2:3], v235 offset:12544
v_lshlrev_b32 v244, 16, v56
v_and_b32 v245, s57, v56
v_lshlrev_b32 v246, 16, v57
v_and_b32 v247, s57, v57
v_fma_f32 v244, v244, v241, v242
v_mfma_f32_32x32x16_bf16 v[144:159], a[28:31], v[52:55], v[144:159]
v_xor_b32 v225, 16, v228
v_add_u32 v225, v225, v227
ds_write_b128 v225, v[196:199]
v_xor_b32 v225, 32, v228
v_add_u32 v225, v225, v227
ds_write_b128 v225, v[200:203]
v_xor_b32 v225, 48, v228
ds_read_b64_tr_b16 a[4:5], v235 offset:14336
ds_read_b64_tr_b16 a[6:7], v235 offset:14592
v_fma_f32 v245, v245, v241, v242
v_fma_f32 v246, v246, v241, v242
v_fma_f32 v247, v247, v241, v242
v_cvt_pk_bf16_f32 v56, v244, v245
s_waitcnt lgkmcnt(7)
v_mfma_f32_32x32x16_bf16 v[160:175], a[32:35], v[52:55], v[160:175]
v_add_u32 v225, v225, v227
ds_write_b128 v225, v[204:207]
v_xor_b32 v225, 64, v228
v_add_u32 v225, v225, v227
ds_write_b128 v225, v[208:211]
v_xor_b32 v225, 80, v228
v_add_u32 v225, v225, v227
ds_read_b64_tr_b16 a[8:9], v235 offset:13312
ds_read_b64_tr_b16 a[10:11], v235 offset:13568
v_cvt_pk_bf16_f32 v57, v246, v247
v_lshlrev_b32 v248, 16, v58
v_and_b32 v249, s57, v58
v_lshlrev_b32 v250, 16, v59
v_and_b32 v251, s57, v59
v_mfma_f32_32x32x16_bf16 v[176:191], a[36:39], v[52:55], v[176:191]
ds_write_b128 v225, v[212:215]
v_xor_b32 v225, 96, v228
v_add_u32 v225, v225, v227
ds_write_b128 v225, v[216:219]
v_xor_b32 v225, 112, v228
v_add_u32 v225, v225, v227
ds_write_b128 v225, v[220:223]
ds_read_b64_tr_b16 a[12:13], v235 offset:15360
ds_read_b64_tr_b16 a[14:15], v235 offset:15616
v_fma_f32 v248, v248, v241, v242
v_fma_f32 v249, v249, v241, v242
v_fma_f32 v250, v250, v241, v242
v_fma_f32 v251, v251, v241, v242
v_cvt_pk_bf16_f32 v58, v248, v249
v_cvt_pk_bf16_f32 v59, v250, v251
s_waitcnt lgkmcnt(9)
s_nop 0
v_mfma_f32_32x32x16_bf16 v[128:143], a[0:3], v[56:59], v[128:143]
v_lshrrev_b32 v227, 3, v224
v_and_b32 v228, 7, v224
v_xor_b32 v228, v228, v227
v_lshlrev_b32 v228, 4, v228
v_lshl_add_u32 v228, v227, 7, v228
ds_read_b64_tr_b16 a[24:25], v235 offset:45056
ds_read_b64_tr_b16 a[26:27], v235 offset:45312
v_lshlrev_b32 v244, 16, v60
v_and_b32 v245, s57, v60
v_lshlrev_b32 v246, 16, v61
v_and_b32 v247, s57, v61
v_mfma_f32_32x32x16_bf16 v[144:159], a[4:7], v[56:59], v[144:159]
v_add_u32 v228, s45, v228
v_lshlrev_b32 v227, 13, v227
v_and_b32 v225, 7, v224
v_lshl_add_u32 v254, v225, 4, v227
ds_read_b64_tr_b16 a[28:29], v235 offset:47104
ds_read_b64_tr_b16 a[30:31], v235 offset:47360
v_fma_f32 v244, v244, v241, v242
v_fma_f32 v245, v245, v241, v242
v_fma_f32 v246, v246, v241, v242
v_fma_f32 v247, v247, v241, v242
s_waitcnt lgkmcnt(4)
v_mfma_f32_32x32x16_bf16 v[160:175], a[8:11], v[56:59], v[160:175]
ds_read_b128 v[192:195], v228 offset:0
ds_read_b128 v[196:199], v228 offset:1024
ds_read_b128 v[200:203], v228 offset:2048
ds_read_b128 v[204:207], v228 offset:3072
ds_read_b64_tr_b16 a[32:33], v235 offset:46080
ds_read_b64_tr_b16 a[34:35], v235 offset:46336
v_cvt_pk_bf16_f32 v60, v244, v245
v_cvt_pk_bf16_f32 v61, v246, v247
v_lshlrev_b32 v248, 16, v62
v_and_b32 v249, s57, v62
v_lshlrev_b32 v250, 16, v63
v_mfma_f32_32x32x16_bf16 v[176:191], a[12:15], v[56:59], v[176:191]
ds_read_b128 v[208:211], v228 offset:4096
ds_read_b128 v[212:215], v228 offset:5120
ds_read_b128 v[216:219], v228 offset:6144
ds_read_b128 v[220:223], v228 offset:7168
ds_read_b64_tr_b16 a[36:37], v235 offset:48128
ds_read_b64_tr_b16 a[38:39], v235 offset:48384
v_and_b32 v251, s57, v63
v_fma_f32 v248, v248, v241, v242
v_fma_f32 v249, v249, v241, v242
v_fma_f32 v250, v250, v241, v242
v_fma_f32 v251, v251, v241, v242
v_cvt_pk_bf16_f32 v62, v248, v249
v_cvt_pk_bf16_f32 v63, v250, v251
s_waitcnt vmcnt(6)
s_barrier
s_waitcnt lgkmcnt(12)
v_mfma_f32_32x32x16_bf16 v[128:143], a[24:27], v[60:63], v[128:143]
s_add_u32 s37, s43, 0
s_waitcnt lgkmcnt(11)
buffer_store_dwordx4 v[192:195], v254, s[16:19], s37 offen sc1
ds_read_b64_tr_b16 a[0:1], v234 offset:16384
ds_read_b64_tr_b16 a[2:3], v234 offset:16640
v_lshlrev_b32 v244, 16, v64
v_and_b32 v245, s57, v64
v_lshlrev_b32 v246, 16, v65
v_and_b32 v247, s57, v65
v_fma_f32 v244, v244, v241, v242
v_mfma_f32_32x32x16_bf16 v[144:159], a[28:31], v[60:63], v[144:159]
s_add_u32 s37, s43, 65536
s_waitcnt lgkmcnt(12)
buffer_store_dwordx4 v[196:199], v254, s[16:19], s37 offen sc1
ds_read_b64_tr_b16 a[4:5], v234 offset:18432
ds_read_b64_tr_b16 a[6:7], v234 offset:18688
v_fma_f32 v245, v245, v241, v242
v_fma_f32 v246, v246, v241, v242
v_fma_f32 v247, v247, v241, v242
v_cvt_pk_bf16_f32 v64, v244, v245
s_waitcnt lgkmcnt(4)
v_mfma_f32_32x32x16_bf16 v[160:175], a[32:35], v[60:63], v[160:175]
s_add_u32 s37, s43, 131072
buffer_store_dwordx4 v[200:203], v254, s[16:19], s37 offen sc1
ds_read_b64_tr_b16 a[8:9], v234 offset:17408
ds_read_b64_tr_b16 a[10:11], v234 offset:17664
v_cvt_pk_bf16_f32 v65, v246, v247
v_lshlrev_b32 v248, 16, v66
v_and_b32 v249, s57, v66
v_lshlrev_b32 v250, 16, v67
v_and_b32 v251, s57, v67
v_mfma_f32_32x32x16_bf16 v[176:191], a[36:39], v[60:63], v[176:191]
s_add_u32 s37, s43, 196608
buffer_store_dwordx4 v[204:207], v254, s[16:19], s37 offen sc1
ds_read_b64_tr_b16 a[12:13], v234 offset:19456
ds_read_b64_tr_b16 a[14:15], v234 offset:19712
v_fma_f32 v248, v248, v241, v242
v_fma_f32 v249, v249, v241, v242
v_fma_f32 v250, v250, v241, v242
v_fma_f32 v251, v251, v241, v242
v_cvt_pk_bf16_f32 v66, v248, v249
v_cvt_pk_bf16_f32 v67, v250, v251
s_waitcnt lgkmcnt(4)
s_nop 0
v_mfma_f32_32x32x16_bf16 v[128:143], a[0:3], v[64:67], v[128:143]
s_add_u32 s37, s43, 262144
buffer_store_dwordx4 v[208:211], v254, s[16:19], s37 offen sc1
ds_read_b64_tr_b16 a[24:25], v234 offset:49152
ds_read_b64_tr_b16 a[26:27], v234 offset:49408
v_lshlrev_b32 v244, 16, v68
v_and_b32 v245, s57, v68
v_lshlrev_b32 v246, 16, v69
v_and_b32 v247, s57, v69
v_fma_f32 v244, v244, v241, v242
v_mfma_f32_32x32x16_bf16 v[144:159], a[4:7], v[64:67], v[144:159]
s_add_u32 s37, s43, 327680
buffer_store_dwordx4 v[212:215], v254, s[16:19], s37 offen sc1
ds_read_b64_tr_b16 a[28:29], v234 offset:51200
ds_read_b64_tr_b16 a[30:31], v234 offset:51456
v_fma_f32 v245, v245, v241, v242
v_fma_f32 v246, v246, v241, v242
v_fma_f32 v247, v247, v241, v242
v_cvt_pk_bf16_f32 v68, v244, v245
s_waitcnt lgkmcnt(4)
v_mfma_f32_32x32x16_bf16 v[160:175], a[8:11], v[64:67], v[160:175]
s_add_u32 s37, s43, 393216
buffer_store_dwordx4 v[216:219], v254, s[16:19], s37 offen sc1
ds_read_b64_tr_b16 a[32:33], v234 offset:50176
ds_read_b64_tr_b16 a[34:35], v234 offset:50432
v_cvt_pk_bf16_f32 v69, v246, v247
v_lshlrev_b32 v248, 16, v70
v_and_b32 v249, s57, v70
v_lshlrev_b32 v250, 16, v71
v_and_b32 v251, s57, v71
v_mfma_f32_32x32x16_bf16 v[176:191], a[12:15], v[64:67], v[176:191]
s_add_u32 s37, s43, 458752
buffer_store_dwordx4 v[220:223], v254, s[16:19], s37 offen sc1
ds_read_b64_tr_b16 a[36:37], v234 offset:52224
ds_read_b64_tr_b16 a[38:39], v234 offset:52480
v_fma_f32 v248, v248, v241, v242
v_fma_f32 v249, v249, v241, v242
v_fma_f32 v250, v250, v241, v242
v_fma_f32 v251, v251, v241, v242
v_cvt_pk_bf16_f32 v70, v248, v249
v_cvt_pk_bf16_f32 v71, v250, v251
s_waitcnt lgkmcnt(4)
s_nop 0
v_mfma_f32_32x32x16_bf16 v[128:143], a[24:27], v[68:71], v[128:143]
ds_read_b64_tr_b16 a[0:1], v235 offset:16384
ds_read_b64_tr_b16 a[2:3], v235 offset:16640
v_lshlrev_b32 v244, 16, v72
v_and_b32 v245, s57, v72
v_lshlrev_b32 v246, 16, v73
v_and_b32 v247, s57, v73
v_fma_f32 v244, v244, v241, v242
v_mfma_f32_32x32x16_bf16 v[144:159], a[28:31], v[68:71], v[144:159]
ds_read_b64_tr_b16 a[4:5], v235 offset:18432
ds_read_b64_tr_b16 a[6:7], v235 offset:18688
v_fma_f32 v245, v245, v241, v242
v_fma_f32 v246, v246, v241, v242
v_fma_f32 v247, v247, v241, v242
v_cvt_pk_bf16_f32 v72, v244, v245
s_waitcnt lgkmcnt(4)
v_mfma_f32_32x32x16_bf16 v[160:175], a[32:35], v[68:71], v[160:175]
ds_read_b64_tr_b16 a[8:9], v235 offset:17408
ds_read_b64_tr_b16 a[10:11], v235 offset:17664
v_cvt_pk_bf16_f32 v73, v246, v247
v_lshlrev_b32 v248, 16, v74
v_and_b32 v249, s57, v74
v_lshlrev_b32 v250, 16, v75
v_and_b32 v251, s57, v75
v_mfma_f32_32x32x16_bf16 v[176:191], a[36:39], v[68:71], v[176:191]
ds_read_b64_tr_b16 a[12:13], v235 offset:19456
ds_read_b64_tr_b16 a[14:15], v235 offset:19712
v_fma_f32 v248, v248, v241, v242
v_fma_f32 v249, v249, v241, v242
v_fma_f32 v250, v250, v241, v242
v_fma_f32 v251, v251, v241, v242
v_cvt_pk_bf16_f32 v74, v248, v249
v_cvt_pk_bf16_f32 v75, v250, v251
s_waitcnt lgkmcnt(4)
s_nop 0
v_mfma_f32_32x32x16_bf16 v[128:143], a[0:3], v[72:75], v[128:143]
ds_read_b64_tr_b16 a[24:25], v235 offset:49152
ds_read_b64_tr_b16 a[26:27], v235 offset:49408
v_lshlrev_b32 v244, 16, v76
v_and_b32 v245, s57, v76
v_lshlrev_b32 v246, 16, v77
v_and_b32 v247, s57, v77
v_fma_f32 v244, v244, v241, v242
v_mfma_f32_32x32x16_bf16 v[144:159], a[4:7], v[72:75], v[144:159]
ds_read_b64_tr_b16 a[28:29], v235 offset:51200
ds_read_b64_tr_b16 a[30:31], v235 offset:51456
v_fma_f32 v245, v245, v241, v242
v_fma_f32 v246, v246, v241, v242
v_fma_f32 v247, v247, v241, v242
v_cvt_pk_bf16_f32 v76, v244, v245
s_waitcnt lgkmcnt(4)
v_mfma_f32_32x32x16_bf16 v[160:175], a[8:11], v[72:75], v[160:175]
ds_read_b64_tr_b16 a[32:33], v235 offset:50176
ds_read_b64_tr_b16 a[34:35], v235 offset:50432
v_cvt_pk_bf16_f32 v77, v246, v247
v_lshlrev_b32 v248, 16, v78
v_and_b32 v249, s57, v78
v_lshlrev_b32 v250, 16, v79
v_and_b32 v251, s57, v79
v_mfma_f32_32x32x16_bf16 v[176:191], a[12:15], v[72:75], v[176:191]
ds_read_b64_tr_b16 a[36:37], v235 offset:52224
ds_read_b64_tr_b16 a[38:39], v235 offset:52480
v_fma_f32 v248, v248, v241, v242
v_fma_f32 v249, v249, v241, v242
v_fma_f32 v250, v250, v241, v242
v_fma_f32 v251, v251, v241, v242
v_cvt_pk_bf16_f32 v78, v248, v249
v_cvt_pk_bf16_f32 v79, v250, v251
s_waitcnt vmcnt(9)
s_waitcnt vmcnt(0)
s_barrier
s_lshl_b32 s60, s74, 2
s_add_u32 s60, s60, 14688256
s_cmp_lg_u32 s28, 0
s_cbranch_scc1 L_parallel_sum__spectral_gfnet__glu_gated_reglu__prompt_kernel_flag_9
v_mul_u32_u24 v238, 512, v224
s_mov_b64 exec, 255
v_mov_b32 v237, 1
buffer_store_dword v237, v238, s[16:19], s60 offen sc1
s_mov_b64 exec, -1
L_parallel_sum__spectral_gfnet__glu_gated_reglu__prompt_kernel_flag_9:
v_and_b32 v243, 3, v224
v_lshlrev_b32 v243, 6, v243
s_cmp_lg_u32 s28, 0
s_cbranch_scc1 L_parallel_sum__spectral_gfnet__glu_gated_reglu__prompt_kernel_w0i_10
global_load_dword v253, v243, s[72:73] sc1
L_parallel_sum__spectral_gfnet__glu_gated_reglu__prompt_kernel_w0i_10:
s_waitcnt lgkmcnt(4)
v_mfma_f32_32x32x16_bf16 v[128:143], a[24:27], v[76:79], v[128:143]
s_add_u32 s59, s53, 6
s_and_b32 s59, s59, 7
s_add_u32 m0, s32, 24576
s_mul_i32 s59, s59, 176128
buffer_load_dwordx4 v236, s[8:11], s59 offen offset:0 lds
s_add_u32 m0, s32, 25536
s_nop 0
buffer_load_dwordx4 v236, s[8:11], s59 offen offset:64 lds
s_add_u32 m0, s32, 26624
ds_read_b64_tr_b16 a[0:1], v234 offset:20480
ds_read_b64_tr_b16 a[2:3], v234 offset:20736
v_mfma_f32_32x32x16_bf16 v[144:159], a[28:31], v[76:79], v[144:159]
s_and_b32 s34, s2, 7
s_lshr_b32 s35, s2, 3
s_lshl_b32 s76, s34, 2
ds_read_b64_tr_b16 a[4:5], v234 offset:22528
ds_read_b64_tr_b16 a[6:7], v234 offset:22784
v_lshlrev_b32 v244, 16, v80
v_and_b32 v245, s57, v80
v_lshlrev_b32 v246, 16, v81
v_and_b32 v247, s57, v81
v_fma_f32 v244, v244, v241, v242
v_fma_f32 v245, v245, v241, v242
v_fma_f32 v246, v246, v241, v242
v_fma_f32 v247, v247, v241, v242
s_waitcnt lgkmcnt(4)
v_mfma_f32_32x32x16_bf16 v[160:175], a[32:35], v[76:79], v[160:175]
s_and_b32 s34, s35, 3
s_add_u32 s76, s76, s34
s_lshr_b32 s77, s35, 2
ds_read_b64_tr_b16 a[8:9], v234 offset:21504
ds_read_b64_tr_b16 a[10:11], v234 offset:21760
v_cvt_pk_bf16_f32 v80, v244, v245
v_cvt_pk_bf16_f32 v81, v246, v247
v_lshlrev_b32 v248, 16, v82
v_and_b32 v249, s57, v82
v_lshlrev_b32 v250, 16, v83
v_and_b32 v251, s57, v83
v_fma_f32 v248, v248, v241, v242
v_fma_f32 v249, v249, v241, v242
v_fma_f32 v250, v250, v241, v242
v_mfma_f32_32x32x16_bf16 v[176:191], a[36:39], v[76:79], v[176:191]
s_lshl_b32 s51, s28, 13
s_add_u32 s51, s51, 131072
s_mul_i32 s52, s28, 360448
ds_read_b64_tr_b16 a[12:13], v234 offset:23552
ds_read_b64_tr_b16 a[14:15], v234 offset:23808
v_fma_f32 v251, v251, v241, v242
v_cvt_pk_bf16_f32 v82, v248, v249
v_cvt_pk_bf16_f32 v83, v250, v251
s_waitcnt lgkmcnt(4)
s_nop 0
v_mfma_f32_32x32x16_bf16 v[128:143], a[0:3], v[80:83], v[128:143]
buffer_load_dwordx4 v236, s[12:15], s59 offen offset:0 lds
s_add_u32 m0, s32, 27584
s_nop 0
buffer_load_dwordx4 v236, s[12:15], s59 offen offset:64 lds
v_lshrrev_b32 v225, 3, v224
ds_read_b64_tr_b16 a[24:25], v234 offset:53248
ds_read_b64_tr_b16 a[26:27], v234 offset:53504
v_mfma_f32_32x32x16_bf16 v[144:159], a[4:7], v[80:83], v[144:159]
v_and_b32 v226, 7, v224
v_bfe_u32 v227, v224, 4, 1
v_lshlrev_b32 v227, 2, v227
ds_read_b64_tr_b16 a[28:29], v234 offset:55296
ds_read_b64_tr_b16 a[30:31], v234 offset:55552
v_lshlrev_b32 v244, 16, v84
v_and_b32 v245, s57, v84
v_lshlrev_b32 v246, 16, v85
v_and_b32 v247, s57, v85
v_fma_f32 v244, v244, v241, v242
v_fma_f32 v245, v245, v241, v242
v_fma_f32 v246, v246, v241, v242
s_waitcnt lgkmcnt(4)
v_mfma_f32_32x32x16_bf16 v[160:175], a[8:11], v[80:83], v[160:175]
v_xor_b32 v226, v226, v227
v_lshlrev_b32 v226, 4, v226
s_lshl_b32 s34, s77, 7
ds_read_b64_tr_b16 a[32:33], v234 offset:54272
ds_read_b64_tr_b16 a[34:35], v234 offset:54528
v_fma_f32 v247, v247, v241, v242
v_cvt_pk_bf16_f32 v84, v244, v245
v_cvt_pk_bf16_f32 v85, v246, v247
v_lshlrev_b32 v248, 16, v86
v_and_b32 v249, s57, v86
v_lshlrev_b32 v250, 16, v87
v_and_b32 v251, s57, v87
v_fma_f32 v248, v248, v241, v242
v_mfma_f32_32x32x16_bf16 v[176:191], a[12:15], v[80:83], v[176:191]
v_lshlrev_b32 v225, 10, v225
v_add3_u32 v230, v225, v226, s34
v_add_u32 v231, 7168, v230
ds_read_b64_tr_b16 a[36:37], v234 offset:56320
ds_read_b64_tr_b16 a[38:39], v234 offset:56576
v_fma_f32 v249, v249, v241, v242
v_fma_f32 v250, v250, v241, v242
v_fma_f32 v251, v251, v241, v242
v_cvt_pk_bf16_f32 v86, v248, v249
v_cvt_pk_bf16_f32 v87, v250, v251
s_waitcnt lgkmcnt(4)
s_nop 0
v_mfma_f32_32x32x16_bf16 v[128:143], a[24:27], v[84:87], v[128:143]
s_add_u32 s59, s53, 7
s_and_b32 s59, s59, 7
s_add_u32 m0, s32, 28672
s_mul_i32 s59, s59, 176128
ds_read_b64_tr_b16 a[0:1], v235 offset:20480
ds_read_b64_tr_b16 a[2:3], v235 offset:20736
v_lshlrev_b32 v244, 16, v88
v_and_b32 v245, s57, v88
v_lshlrev_b32 v246, 16, v89
v_and_b32 v247, s57, v89
v_fma_f32 v244, v244, v241, v242
v_fma_f32 v245, v245, v241, v242
v_mfma_f32_32x32x16_bf16 v[144:159], a[28:31], v[84:87], v[144:159]
buffer_load_dwordx4 v236, s[8:11], s59 offen offset:0 lds
s_add_u32 m0, s32, 29632
ds_read_b64_tr_b16 a[4:5], v235 offset:22528
ds_read_b64_tr_b16 a[6:7], v235 offset:22784
v_fma_f32 v246, v246, v241, v242
s_waitcnt lgkmcnt(4)
v_mfma_f32_32x32x16_bf16 v[160:175], a[32:35], v[84:87], v[160:175]
buffer_load_dwordx4 v236, s[8:11], s59 offen offset:64 lds
s_add_u32 m0, s32, 30720
ds_read_b64_tr_b16 a[8:9], v235 offset:21504
ds_read_b64_tr_b16 a[10:11], v235 offset:21760
v_fma_f32 v247, v247, v241, v242
v_cvt_pk_bf16_f32 v88, v244, v245
v_mfma_f32_32x32x16_bf16 v[176:191], a[36:39], v[84:87], v[176:191]
ds_read_b64_tr_b16 a[12:13], v235 offset:23552
ds_read_b64_tr_b16 a[14:15], v235 offset:23808
v_cvt_pk_bf16_f32 v89, v246, v247
v_lshlrev_b32 v248, 16, v90
v_and_b32 v249, s57, v90
v_lshlrev_b32 v250, 16, v91
v_and_b32 v251, s57, v91
v_fma_f32 v248, v248, v241, v242
v_fma_f32 v249, v249, v241, v242
v_fma_f32 v250, v250, v241, v242
v_fma_f32 v251, v251, v241, v242
v_cvt_pk_bf16_f32 v90, v248, v249
v_cvt_pk_bf16_f32 v91, v250, v251
s_waitcnt lgkmcnt(4)
s_nop 0
v_mfma_f32_32x32x16_bf16 v[128:143], a[0:3], v[88:91], v[128:143]
buffer_load_dwordx4 v236, s[12:15], s59 offen offset:0 lds
s_add_u32 m0, s32, 31680
ds_read_b64_tr_b16 a[24:25], v235 offset:53248
ds_read_b64_tr_b16 a[26:27], v235 offset:53504
v_lshlrev_b32 v244, 16, v92
v_and_b32 v245, s57, v92
v_lshlrev_b32 v246, 16, v93
v_mfma_f32_32x32x16_bf16 v[144:159], a[4:7], v[88:91], v[144:159]
buffer_load_dwordx4 v236, s[12:15], s59 offen offset:64 lds
ds_read_b64_tr_b16 a[28:29], v235 offset:55296
ds_read_b64_tr_b16 a[30:31], v235 offset:55552
v_and_b32 v247, s57, v93
v_fma_f32 v244, v244, v241, v242
v_fma_f32 v245, v245, v241, v242
s_waitcnt lgkmcnt(4)
v_mfma_f32_32x32x16_bf16 v[160:175], a[8:11], v[88:91], v[160:175]
s_add_u32 m0, s51, 0
s_add_u32 s49, s52, 0
buffer_load_dwordx4 v230, s[64:67], s49 offen lds
ds_read_b64_tr_b16 a[32:33], v235 offset:54272
ds_read_b64_tr_b16 a[34:35], v235 offset:54528
v_fma_f32 v246, v246, v241, v242
v_fma_f32 v247, v247, v241, v242
v_mfma_f32_32x32x16_bf16 v[176:191], a[12:15], v[88:91], v[176:191]
ds_read_b64_tr_b16 a[36:37], v235 offset:56320
ds_read_b64_tr_b16 a[38:39], v235 offset:56576
v_cvt_pk_bf16_f32 v92, v244, v245
v_cvt_pk_bf16_f32 v93, v246, v247
v_lshlrev_b32 v248, 16, v94
v_and_b32 v249, s57, v94
v_lshlrev_b32 v250, 16, v95
v_and_b32 v251, s57, v95
v_fma_f32 v248, v248, v241, v242
v_fma_f32 v249, v249, v241, v242
v_fma_f32 v250, v250, v241, v242
v_fma_f32 v251, v251, v241, v242
v_cvt_pk_bf16_f32 v94, v248, v249
v_cvt_pk_bf16_f32 v95, v250, v251
s_waitcnt vmcnt(5)
s_cmp_lg_u32 s28, 0
s_cbranch_scc1 L_parallel_sum__spectral_gfnet__glu_gated_reglu__prompt_kernel_w0c_11
s_waitcnt vmcnt(9)
v_cmp_eq_u32 vcc, 64, v253
s_nop 4
s_cmp_eq_u64 vcc, exec
s_cbranch_scc1 L_parallel_sum__spectral_gfnet__glu_gated_reglu__prompt_kernel_clrok_12
s_mov_b32 s56, 0
L_parallel_sum__spectral_gfnet__glu_gated_reglu__prompt_kernel_clr_13:
global_load_dword v253, v243, s[72:73] sc1
s_waitcnt vmcnt(0)
v_cmp_eq_u32 vcc, 64, v253
s_nop 4
s_cmp_eq_u64 vcc, exec
s_cbranch_scc1 L_parallel_sum__spectral_gfnet__glu_gated_reglu__prompt_kernel_clrd_14
s_add_u32 s56, s56, 1
s_cmp_gt_u32 s56, 40000
s_cbranch_scc1 L_parallel_sum__spectral_gfnet__glu_gated_reglu__prompt_kernel_clrd_14
s_sleep 4
s_branch L_parallel_sum__spectral_gfnet__glu_gated_reglu__prompt_kernel_clr_13
L_parallel_sum__spectral_gfnet__glu_gated_reglu__prompt_kernel_clrd_14:
L_parallel_sum__spectral_gfnet__glu_gated_reglu__prompt_kernel_clrok_12:
L_parallel_sum__spectral_gfnet__glu_gated_reglu__prompt_kernel_w0c_11:
s_barrier
s_waitcnt lgkmcnt(4)
v_mfma_f32_32x32x16_bf16 v[128:143], a[24:27], v[92:95], v[128:143]
buffer_load_dwordx4 v231, s[64:67], s49 offen offset:1024 lds
ds_read_b64_tr_b16 a[0:1], v234 offset:24576
ds_read_b64_tr_b16 a[2:3], v234 offset:24832
v_mfma_f32_32x32x16_bf16 v[144:159], a[28:31], v[92:95], v[144:159]
ds_read_b64_tr_b16 a[4:5], v234 offset:26624
ds_read_b64_tr_b16 a[6:7], v234 offset:26880
v_lshlrev_b32 v244, 16, v96
v_and_b32 v245, s57, v96
v_lshlrev_b32 v246, 16, v97
v_and_b32 v247, s57, v97
v_fma_f32 v244, v244, v241, v242
v_fma_f32 v245, v245, v241, v242
s_waitcnt lgkmcnt(4)
v_mfma_f32_32x32x16_bf16 v[160:175], a[32:35], v[92:95], v[160:175]
ds_read_b64_tr_b16 a[8:9], v234 offset:25600
ds_read_b64_tr_b16 a[10:11], v234 offset:25856
v_fma_f32 v246, v246, v241, v242
v_fma_f32 v247, v247, v241, v242
v_cvt_pk_bf16_f32 v96, v244, v245
v_cvt_pk_bf16_f32 v97, v246, v247
v_lshlrev_b32 v248, 16, v98
v_and_b32 v249, s57, v98
v_lshlrev_b32 v250, 16, v99
v_mfma_f32_32x32x16_bf16 v[176:191], a[36:39], v[92:95], v[176:191]
ds_read_b64_tr_b16 a[12:13], v234 offset:27648
ds_read_b64_tr_b16 a[14:15], v234 offset:27904
v_and_b32 v251, s57, v99
v_fma_f32 v248, v248, v241, v242
v_fma_f32 v249, v249, v241, v242
v_fma_f32 v250, v250, v241, v242
v_fma_f32 v251, v251, v241, v242
v_cvt_pk_bf16_f32 v98, v248, v249
v_cvt_pk_bf16_f32 v99, v250, v251
s_waitcnt lgkmcnt(4)
s_nop 0
v_mfma_f32_32x32x16_bf16 v[128:143], a[0:3], v[96:99], v[128:143]
s_add_u32 m0, s51, 2048
s_add_u32 s49, s52, 16384
buffer_load_dwordx4 v230, s[64:67], s49 offen lds
ds_read_b64_tr_b16 a[24:25], v234 offset:57344
ds_read_b64_tr_b16 a[26:27], v234 offset:57600
v_mfma_f32_32x32x16_bf16 v[144:159], a[4:7], v[96:99], v[144:159]
ds_read_b64_tr_b16 a[28:29], v234 offset:59392
ds_read_b64_tr_b16 a[30:31], v234 offset:59648
v_lshlrev_b32 v244, 16, v100
v_and_b32 v245, s57, v100
v_lshlrev_b32 v246, 16, v101
v_and_b32 v247, s57, v101
v_fma_f32 v244, v244, v241, v242
v_fma_f32 v245, v245, v241, v242
s_waitcnt lgkmcnt(4)
v_mfma_f32_32x32x16_bf16 v[160:175], a[8:11], v[96:99], v[160:175]
ds_read_b64_tr_b16 a[32:33], v234 offset:58368
ds_read_b64_tr_b16 a[34:35], v234 offset:58624
v_fma_f32 v246, v246, v241, v242
v_fma_f32 v247, v247, v241, v242
v_cvt_pk_bf16_f32 v100, v244, v245
v_cvt_pk_bf16_f32 v101, v246, v247
v_lshlrev_b32 v248, 16, v102
v_and_b32 v249, s57, v102
v_lshlrev_b32 v250, 16, v103
v_mfma_f32_32x32x16_bf16 v[176:191], a[12:15], v[96:99], v[176:191]
ds_read_b64_tr_b16 a[36:37], v234 offset:60416
ds_read_b64_tr_b16 a[38:39], v234 offset:60672
v_and_b32 v251, s57, v103
v_fma_f32 v248, v248, v241, v242
v_fma_f32 v249, v249, v241, v242
v_fma_f32 v250, v250, v241, v242
v_fma_f32 v251, v251, v241, v242
v_cvt_pk_bf16_f32 v102, v248, v249
v_cvt_pk_bf16_f32 v103, v250, v251
s_waitcnt lgkmcnt(4)
s_nop 0
v_mfma_f32_32x32x16_bf16 v[128:143], a[24:27], v[100:103], v[128:143]
buffer_load_dwordx4 v231, s[64:67], s49 offen offset:1024 lds
ds_read_b64_tr_b16 a[0:1], v235 offset:24576
ds_read_b64_tr_b16 a[2:3], v235 offset:24832
v_mfma_f32_32x32x16_bf16 v[144:159], a[28:31], v[100:103], v[144:159]
ds_read_b64_tr_b16 a[4:5], v235 offset:26624
ds_read_b64_tr_b16 a[6:7], v235 offset:26880
v_lshlrev_b32 v244, 16, v104
v_and_b32 v245, s57, v104
v_lshlrev_b32 v246, 16, v105
v_and_b32 v247, s57, v105
v_fma_f32 v244, v244, v241, v242
v_fma_f32 v245, v245, v241, v242
s_waitcnt lgkmcnt(4)
v_mfma_f32_32x32x16_bf16 v[160:175], a[32:35], v[100:103], v[160:175]
ds_read_b64_tr_b16 a[8:9], v235 offset:25600
ds_read_b64_tr_b16 a[10:11], v235 offset:25856
v_fma_f32 v246, v246, v241, v242
v_fma_f32 v247, v247, v241, v242
v_cvt_pk_bf16_f32 v104, v244, v245
v_cvt_pk_bf16_f32 v105, v246, v247
v_lshlrev_b32 v248, 16, v106
v_and_b32 v249, s57, v106
v_lshlrev_b32 v250, 16, v107
v_mfma_f32_32x32x16_bf16 v[176:191], a[36:39], v[100:103], v[176:191]
ds_read_b64_tr_b16 a[12:13], v235 offset:27648
ds_read_b64_tr_b16 a[14:15], v235 offset:27904
v_and_b32 v251, s57, v107
v_fma_f32 v248, v248, v241, v242
v_fma_f32 v249, v249, v241, v242
v_fma_f32 v250, v250, v241, v242
v_fma_f32 v251, v251, v241, v242
v_cvt_pk_bf16_f32 v106, v248, v249
v_cvt_pk_bf16_f32 v107, v250, v251
s_waitcnt lgkmcnt(4)
s_nop 0
v_mfma_f32_32x32x16_bf16 v[128:143], a[0:3], v[104:107], v[128:143]
s_add_u32 m0, s51, 4096
s_add_u32 s49, s52, 32768
buffer_load_dwordx4 v230, s[64:67], s49 offen lds
ds_read_b64_tr_b16 a[24:25], v235 offset:57344
ds_read_b64_tr_b16 a[26:27], v235 offset:57600
v_mfma_f32_32x32x16_bf16 v[144:159], a[4:7], v[104:107], v[144:159]
ds_read_b64_tr_b16 a[28:29], v235 offset:59392
ds_read_b64_tr_b16 a[30:31], v235 offset:59648
v_lshlrev_b32 v244, 16, v108
v_and_b32 v245, s57, v108
v_lshlrev_b32 v246, 16, v109
v_and_b32 v247, s57, v109
v_fma_f32 v244, v244, v241, v242
v_fma_f32 v245, v245, v241, v242
s_waitcnt lgkmcnt(4)
v_mfma_f32_32x32x16_bf16 v[160:175], a[8:11], v[104:107], v[160:175]
ds_read_b64_tr_b16 a[32:33], v235 offset:58368
ds_read_b64_tr_b16 a[34:35], v235 offset:58624
v_fma_f32 v246, v246, v241, v242
v_fma_f32 v247, v247, v241, v242
v_cvt_pk_bf16_f32 v108, v244, v245
v_cvt_pk_bf16_f32 v109, v246, v247
v_lshlrev_b32 v248, 16, v110
v_and_b32 v249, s57, v110
v_lshlrev_b32 v250, 16, v111
v_mfma_f32_32x32x16_bf16 v[176:191], a[12:15], v[104:107], v[176:191]
ds_read_b64_tr_b16 a[36:37], v235 offset:60416
ds_read_b64_tr_b16 a[38:39], v235 offset:60672
v_and_b32 v251, s57, v111
v_fma_f32 v248, v248, v241, v242
v_fma_f32 v249, v249, v241, v242
v_fma_f32 v250, v250, v241, v242
v_fma_f32 v251, v251, v241, v242
v_cvt_pk_bf16_f32 v110, v248, v249
v_cvt_pk_bf16_f32 v111, v250, v251
s_waitcnt vmcnt(5)
s_barrier
s_waitcnt lgkmcnt(4)
v_mfma_f32_32x32x16_bf16 v[128:143], a[24:27], v[108:111], v[128:143]
buffer_load_dwordx4 v231, s[64:67], s49 offen offset:1024 lds
ds_read_b64_tr_b16 a[0:1], v234 offset:28672
ds_read_b64_tr_b16 a[2:3], v234 offset:28928
v_mfma_f32_32x32x16_bf16 v[144:159], a[28:31], v[108:111], v[144:159]
ds_read_b64_tr_b16 a[4:5], v234 offset:30720
ds_read_b64_tr_b16 a[6:7], v234 offset:30976
v_lshlrev_b32 v244, 16, v112
v_and_b32 v245, s57, v112
v_lshlrev_b32 v246, 16, v113
v_and_b32 v247, s57, v113
v_fma_f32 v244, v244, v241, v242
v_fma_f32 v245, v245, v241, v242
s_waitcnt lgkmcnt(4)
v_mfma_f32_32x32x16_bf16 v[160:175], a[32:35], v[108:111], v[160:175]
ds_read_b64_tr_b16 a[8:9], v234 offset:29696
ds_read_b64_tr_b16 a[10:11], v234 offset:29952
v_fma_f32 v246, v246, v241, v242
v_fma_f32 v247, v247, v241, v242
v_cvt_pk_bf16_f32 v112, v244, v245
v_cvt_pk_bf16_f32 v113, v246, v247
v_lshlrev_b32 v248, 16, v114
v_and_b32 v249, s57, v114
v_lshlrev_b32 v250, 16, v115
v_mfma_f32_32x32x16_bf16 v[176:191], a[36:39], v[108:111], v[176:191]
ds_read_b64_tr_b16 a[12:13], v234 offset:31744
ds_read_b64_tr_b16 a[14:15], v234 offset:32000
v_and_b32 v251, s57, v115
v_fma_f32 v248, v248, v241, v242
v_fma_f32 v249, v249, v241, v242
v_fma_f32 v250, v250, v241, v242
v_fma_f32 v251, v251, v241, v242
v_cvt_pk_bf16_f32 v114, v248, v249
v_cvt_pk_bf16_f32 v115, v250, v251
s_lshr_b32 s42, s75, 4
s_cmp_eq_u32 s75, 256
s_cselect_b32 s42, 0, s42
s_lshl_b32 s42, s42, 6
s_add_u32 s42, s42, 14680064
v_and_b32 v25, 15, v224
v_lshlrev_b32 v25, 2, v25
s_cmp_lg_u32 s28, 0
s_cbranch_scc1 L_parallel_sum__spectral_gfnet__glu_gated_reglu__prompt_kernel_w0i_15
buffer_load_dword v24, v25, s[16:19], s42 offen sc1
L_parallel_sum__spectral_gfnet__glu_gated_reglu__prompt_kernel_w0i_15:
s_waitcnt lgkmcnt(4)
v_mfma_f32_32x32x16_bf16 v[128:143], a[0:3], v[112:115], v[128:143]
s_add_u32 m0, s51, 6144
s_add_u32 s49, s52, 49152
buffer_load_dwordx4 v230, s[64:67], s49 offen lds
ds_read_b64_tr_b16 a[24:25], v234 offset:61440
ds_read_b64_tr_b16 a[26:27], v234 offset:61696
v_mfma_f32_32x32x16_bf16 v[144:159], a[4:7], v[112:115], v[144:159]
ds_read_b64_tr_b16 a[28:29], v234 offset:63488
ds_read_b64_tr_b16 a[30:31], v234 offset:63744
v_lshlrev_b32 v244, 16, v116
v_and_b32 v245, s57, v116
v_lshlrev_b32 v246, 16, v117
v_and_b32 v247, s57, v117
v_fma_f32 v244, v244, v241, v242
v_fma_f32 v245, v245, v241, v242
s_waitcnt lgkmcnt(4)
v_mfma_f32_32x32x16_bf16 v[160:175], a[8:11], v[112:115], v[160:175]
ds_read_b64_tr_b16 a[32:33], v234 offset:62464
ds_read_b64_tr_b16 a[34:35], v234 offset:62720
v_fma_f32 v246, v246, v241, v242
v_fma_f32 v247, v247, v241, v242
v_cvt_pk_bf16_f32 v116, v244, v245
v_cvt_pk_bf16_f32 v117, v246, v247
v_lshlrev_b32 v248, 16, v118
v_and_b32 v249, s57, v118
v_lshlrev_b32 v250, 16, v119
v_mfma_f32_32x32x16_bf16 v[176:191], a[12:15], v[112:115], v[176:191]
ds_read_b64_tr_b16 a[36:37], v234 offset:64512
ds_read_b64_tr_b16 a[38:39], v234 offset:64768
v_and_b32 v251, s57, v119
v_fma_f32 v248, v248, v241, v242
v_fma_f32 v249, v249, v241, v242
v_fma_f32 v250, v250, v241, v242
v_fma_f32 v251, v251, v241, v242
v_cvt_pk_bf16_f32 v118, v248, v249
v_cvt_pk_bf16_f32 v119, v250, v251
s_waitcnt lgkmcnt(4)
s_nop 0
v_mfma_f32_32x32x16_bf16 v[128:143], a[24:27], v[116:119], v[128:143]
buffer_load_dwordx4 v231, s[64:67], s49 offen offset:1024 lds
ds_read_b64_tr_b16 a[0:1], v235 offset:28672
ds_read_b64_tr_b16 a[2:3], v235 offset:28928
v_mfma_f32_32x32x16_bf16 v[144:159], a[28:31], v[116:119], v[144:159]
ds_read_b64_tr_b16 a[4:5], v235 offset:30720
ds_read_b64_tr_b16 a[6:7], v235 offset:30976
v_lshlrev_b32 v244, 16, v120
v_and_b32 v245, s57, v120
v_lshlrev_b32 v246, 16, v121
v_and_b32 v247, s57, v121
v_fma_f32 v244, v244, v241, v242
v_fma_f32 v245, v245, v241, v242
s_waitcnt lgkmcnt(4)
v_mfma_f32_32x32x16_bf16 v[160:175], a[32:35], v[116:119], v[160:175]
ds_read_b64_tr_b16 a[8:9], v235 offset:29696
ds_read_b64_tr_b16 a[10:11], v235 offset:29952
v_fma_f32 v246, v246, v241, v242
v_fma_f32 v247, v247, v241, v242
v_cvt_pk_bf16_f32 v120, v244, v245
v_cvt_pk_bf16_f32 v121, v246, v247
v_lshlrev_b32 v248, 16, v122
v_and_b32 v249, s57, v122
v_lshlrev_b32 v250, 16, v123
v_mfma_f32_32x32x16_bf16 v[176:191], a[36:39], v[116:119], v[176:191]
ds_read_b64_tr_b16 a[12:13], v235 offset:31744
ds_read_b64_tr_b16 a[14:15], v235 offset:32000
v_and_b32 v251, s57, v123
v_fma_f32 v248, v248, v241, v242
v_fma_f32 v249, v249, v241, v242
v_fma_f32 v250, v250, v241, v242
v_fma_f32 v251, v251, v241, v242
v_cvt_pk_bf16_f32 v122, v248, v249
v_cvt_pk_bf16_f32 v123, v250, v251
s_waitcnt lgkmcnt(4)
s_nop 0
v_mfma_f32_32x32x16_bf16 v[128:143], a[0:3], v[120:123], v[128:143]
ds_read_b64_tr_b16 a[24:25], v235 offset:61440
ds_read_b64_tr_b16 a[26:27], v235 offset:61696
v_lshlrev_b32 v244, 16, v124
v_and_b32 v245, s57, v124
v_lshlrev_b32 v246, 16, v125
v_and_b32 v247, s57, v125
v_fma_f32 v244, v244, v241, v242
v_mfma_f32_32x32x16_bf16 v[144:159], a[4:7], v[120:123], v[144:159]
ds_read_b64_tr_b16 a[28:29], v235 offset:63488
ds_read_b64_tr_b16 a[30:31], v235 offset:63744
v_fma_f32 v245, v245, v241, v242
v_fma_f32 v246, v246, v241, v242
v_fma_f32 v247, v247, v241, v242
v_cvt_pk_bf16_f32 v124, v244, v245
s_waitcnt lgkmcnt(4)
v_mfma_f32_32x32x16_bf16 v[160:175], a[8:11], v[120:123], v[160:175]
ds_read_b64_tr_b16 a[32:33], v235 offset:62464
ds_read_b64_tr_b16 a[34:35], v235 offset:62720
v_cvt_pk_bf16_f32 v125, v246, v247
v_lshlrev_b32 v248, 16, v126
v_and_b32 v249, s57, v126
v_lshlrev_b32 v250, 16, v127
v_and_b32 v251, s57, v127
v_mfma_f32_32x32x16_bf16 v[176:191], a[12:15], v[120:123], v[176:191]
ds_read_b64_tr_b16 a[36:37], v235 offset:64512
ds_read_b64_tr_b16 a[38:39], v235 offset:64768
v_fma_f32 v248, v248, v241, v242
v_fma_f32 v249, v249, v241, v242
v_fma_f32 v250, v250, v241, v242
v_fma_f32 v251, v251, v241, v242
v_cvt_pk_bf16_f32 v126, v248, v249
v_cvt_pk_bf16_f32 v127, v250, v251
s_waitcnt lgkmcnt(4)
s_nop 0
v_mfma_f32_32x32x16_bf16 v[128:143], a[24:27], v[124:127], v[128:143]
v_mfma_f32_32x32x16_bf16 v[144:159], a[28:31], v[124:127], v[144:159]
s_waitcnt lgkmcnt(0)
v_mfma_f32_32x32x16_bf16 v[160:175], a[32:35], v[124:127], v[160:175]
v_mfma_f32_32x32x16_bf16 v[176:191], a[36:39], v[124:127], v[176:191]
s_cmp_lg_u32 s28, 0
s_cbranch_scc1 L_parallel_sum__spectral_gfnet__glu_gated_reglu__prompt_kernel_w0c_16
s_waitcnt vmcnt(2)
v_cmp_eq_u32 vcc, 1, v24
s_nop 4
s_cmp_eq_u64 vcc, exec
s_cbranch_scc1 L_parallel_sum__spectral_gfnet__glu_gated_reglu__prompt_kernel_zpok_17
s_mov_b32 s56, 0
L_parallel_sum__spectral_gfnet__glu_gated_reglu__prompt_kernel_zp_18:
buffer_load_dword v24, v25, s[16:19], s42 offen sc1
s_waitcnt vmcnt(0)
v_cmp_eq_u32 vcc, 1, v24
s_nop 4
s_cmp_eq_u64 vcc, exec
s_cbranch_scc1 L_parallel_sum__spectral_gfnet__glu_gated_reglu__prompt_kernel_zpd_19
s_add_u32 s56, s56, 1
s_cmp_gt_u32 s56, 40000
s_cbranch_scc1 L_parallel_sum__spectral_gfnet__glu_gated_reglu__prompt_kernel_zpd_19
s_sleep 4
s_branch L_parallel_sum__spectral_gfnet__glu_gated_reglu__prompt_kernel_zp_18
L_parallel_sum__spectral_gfnet__glu_gated_reglu__prompt_kernel_zpd_19:
L_parallel_sum__spectral_gfnet__glu_gated_reglu__prompt_kernel_zpok_17:
L_parallel_sum__spectral_gfnet__glu_gated_reglu__prompt_kernel_w0c_16:
s_cmp_lg_u32 s74, 64
s_cbranch_scc1 L_parallel_sum__spectral_gfnet__glu_gated_reglu__prompt_kernel_only1_20
s_mov_b32 s42, 14680064
v_and_b32 v25, 15, v224
v_lshlrev_b32 v25, 2, v25
s_cmp_lg_u32 s28, 0
s_cbranch_scc1 L_parallel_sum__spectral_gfnet__glu_gated_reglu__prompt_kernel_w0s_21
s_mov_b32 s56, 0
L_parallel_sum__spectral_gfnet__glu_gated_reglu__prompt_kernel_zp0_22:
buffer_load_dword v24, v25, s[16:19], s42 offen sc1
s_waitcnt vmcnt(0)
v_cmp_eq_u32 vcc, 1, v24
s_nop 4
s_cmp_eq_u64 vcc, exec
s_cbranch_scc1 L_parallel_sum__spectral_gfnet__glu_gated_reglu__prompt_kernel_zp0d_23
s_add_u32 s56, s56, 1
s_cmp_gt_u32 s56, 40000
s_cbranch_scc1 L_parallel_sum__spectral_gfnet__glu_gated_reglu__prompt_kernel_zp0d_23
s_sleep 4
s_branch L_parallel_sum__spectral_gfnet__glu_gated_reglu__prompt_kernel_zp0_22
L_parallel_sum__spectral_gfnet__glu_gated_reglu__prompt_kernel_zp0d_23:
L_parallel_sum__spectral_gfnet__glu_gated_reglu__prompt_kernel_w0s_21:
s_movk_i32 s75, 0x100
L_parallel_sum__spectral_gfnet__glu_gated_reglu__prompt_kernel_only1_20:
s_barrier
v_and_b32 v8, 15, v224
v_lshrrev_b32 v9, 4, v224
s_cmp_eq_u32 s75, 256
s_cselect_b32 s35, 0, s75
s_lshl_b32 s35, s35, 13
s_add_u32 s35, s35, 0
s_lshl_b32 s36, s28, 4
v_add_u32 v10, s36, v8
v_lshlrev_b32 v10, 7, v10
v_lshl_add_u32 v10, v9, 4, v10
buffer_load_dwordx4 v[32:35], v10, s[16:19], s35 offen sc1
buffer_load_dwordx4 v[36:39], v10, s[16:19], s35 offen offset:64 sc1
s_and_b32 s43, s2, 7
s_lshl_b32 s43, s43, 9
s_add_u32 s43, s43, 14688256
v_lshlrev_b32 v27, 2, v224
s_cmp_lg_u32 s28, 0
s_cbranch_scc1 L_parallel_sum__spectral_gfnet__glu_gated_reglu__prompt_kernel_w0i_24
buffer_load_dword v26, v27, s[16:19], s43 offen sc1
L_parallel_sum__spectral_gfnet__glu_gated_reglu__prompt_kernel_w0i_24:
v_max_f32 v128, 0, v128
v_max_f32 v129, 0, v129
v_max_f32 v130, 0, v130
v_max_f32 v131, 0, v131
v_max_f32 v132, 0, v132
v_max_f32 v133, 0, v133
v_max_f32 v134, 0, v134
v_max_f32 v135, 0, v135
v_max_f32 v136, 0, v136
v_max_f32 v137, 0, v137
v_max_f32 v138, 0, v138
v_max_f32 v139, 0, v139
v_max_f32 v140, 0, v140
v_max_f32 v141, 0, v141
v_max_f32 v142, 0, v142
v_max_f32 v143, 0, v143
v_pk_mul_f32 v[128:129], v[128:129], v[144:145]
v_pk_mul_f32 v[130:131], v[130:131], v[146:147]
v_pk_mul_f32 v[132:133], v[132:133], v[148:149]
v_pk_mul_f32 v[134:135], v[134:135], v[150:151]
v_pk_mul_f32 v[136:137], v[136:137], v[152:153]
v_pk_mul_f32 v[138:139], v[138:139], v[154:155]
v_pk_mul_f32 v[140:141], v[140:141], v[156:157]
v_pk_mul_f32 v[142:143], v[142:143], v[158:159]
v_cvt_pk_bf16_f32 v144, v128, v129
v_cvt_pk_bf16_f32 v145, v130, v131
v_cvt_pk_bf16_f32 v146, v132, v133
v_cvt_pk_bf16_f32 v147, v134, v135
v_cvt_pk_bf16_f32 v148, v136, v137
v_cvt_pk_bf16_f32 v149, v138, v139
v_cvt_pk_bf16_f32 v150, v140, v141
v_cvt_pk_bf16_f32 v151, v142, v143
buffer_store_dwordx4 v[144:147], v252, s[16:19], 0 offen offset:0 sc1
buffer_store_dwordx4 v[148:151], v252, s[16:19], 0 offen offset:1024 sc1
v_max_f32 v160, 0, v160
v_max_f32 v161, 0, v161
v_max_f32 v162, 0, v162
v_max_f32 v163, 0, v163
v_max_f32 v164, 0, v164
v_max_f32 v165, 0, v165
v_max_f32 v166, 0, v166
v_max_f32 v167, 0, v167
v_max_f32 v168, 0, v168
v_max_f32 v169, 0, v169
v_max_f32 v170, 0, v170
v_max_f32 v171, 0, v171
v_max_f32 v172, 0, v172
v_max_f32 v173, 0, v173
v_max_f32 v174, 0, v174
v_max_f32 v175, 0, v175
v_pk_mul_f32 v[160:161], v[160:161], v[176:177]
v_pk_mul_f32 v[162:163], v[162:163], v[178:179]
v_pk_mul_f32 v[164:165], v[164:165], v[180:181]
v_pk_mul_f32 v[166:167], v[166:167], v[182:183]
v_pk_mul_f32 v[168:169], v[168:169], v[184:185]
v_pk_mul_f32 v[170:171], v[170:171], v[186:187]
v_pk_mul_f32 v[172:173], v[172:173], v[188:189]
v_pk_mul_f32 v[174:175], v[174:175], v[190:191]
v_cvt_pk_bf16_f32 v176, v160, v161
v_cvt_pk_bf16_f32 v177, v162, v163
v_cvt_pk_bf16_f32 v178, v164, v165
v_cvt_pk_bf16_f32 v179, v166, v167
v_cvt_pk_bf16_f32 v180, v168, v169
v_cvt_pk_bf16_f32 v181, v170, v171
v_cvt_pk_bf16_f32 v182, v172, v173
v_cvt_pk_bf16_f32 v183, v174, v175
buffer_store_dwordx4 v[176:179], v252, s[16:19], 0 offen offset:2048 sc1
buffer_store_dwordx4 v[180:183], v252, s[16:19], 0 offen offset:3072 sc1
v_and_b32 v1, 15, v224
v_lshrrev_b32 v2, 4, v224
s_lshl_b32 s36, s28, 4
v_add_u32 v4, s36, v1
v_lshlrev_b32 v5, 4, v224
v_add_u32 v216, 28672, v5
v_add_u32 v217, 0x10000, v216
v_add_u32 v218, s32, v216
v_lshlrev_b32 v219, 6, v4
v_and_b32 v5, 1, v2
v_lshl_add_u32 v219, v5, 5, v219
v_lshrrev_b32 v5, 1, v2
v_lshl_add_u32 v219, v5, 4, v219
v_cvt_f32_u32 v7, v1
s_add_u32 m0, s32, 0
s_add_u32 s49, s52, 65536
buffer_load_dwordx4 v230, s[64:67], s49 offen lds
v_lshlrev_b32 v6, 2, v2
v_cvt_f32_u32 v6, v6
v_and_b32 v220, 1, v1
v_mul_u32_u24 v220, 0x8000, v220
v_lshl_or_b32 v220, v220, 16, v220
s_mov_b32 s34, 0x80008000
v_mul_f32 v208, 0x3d000000, v7
v_mul_f32 v209, v6, v208
v_cos_f32 v200, v209
v_sin_f32 v201, v209
v_add_f32 v209, v209, v208
v_cos_f32 v202, v209
v_sin_f32 v203, v209
v_add_f32 v209, v209, v208
buffer_load_dwordx4 v231, s[64:67], s49 offen offset:1024 lds
v_cos_f32 v204, v209
v_sin_f32 v205, v209
v_add_f32 v209, v209, v208
v_cos_f32 v206, v209
v_sin_f32 v207, v209
v_cvt_pk_bf16_f32 v48, v200, v201
v_cvt_pk_bf16_f32 v64, -v201, v200
v_cvt_pk_bf16_f32 v49, v202, v203
v_cvt_pk_bf16_f32 v65, -v203, v202
v_cvt_pk_bf16_f32 v50, v204, v205
v_cvt_pk_bf16_f32 v66, -v205, v204
v_cvt_pk_bf16_f32 v51, v206, v207
v_cvt_pk_bf16_f32 v67, -v207, v206
v_xor_b32 v52, v48, v220
s_add_u32 m0, s32, 2048
s_add_u32 s49, s52, 81920
buffer_load_dwordx4 v230, s[64:67], s49 offen lds
v_xor_b32 v53, v49, v220
v_xor_b32 v54, v50, v220
v_xor_b32 v55, v51, v220
v_mov_b32 v56, v48
v_xor_b32 v57, s34, v49
v_mov_b32 v58, v50
v_xor_b32 v59, s34, v51
v_mov_b32 v60, v52
v_xor_b32 v61, s34, v53
v_mov_b32 v62, v54
v_xor_b32 v63, s34, v55
v_xor_b32 v68, v64, v220
v_xor_b32 v69, v65, v220
v_xor_b32 v70, v66, v220
buffer_load_dwordx4 v231, s[64:67], s49 offen offset:1024 lds
v_xor_b32 v71, v67, v220
v_mov_b32 v72, v64
v_xor_b32 v73, s34, v65
v_mov_b32 v74, v66
v_xor_b32 v75, s34, v67
v_mov_b32 v76, v68
v_xor_b32 v77, s34, v69
v_mov_b32 v78, v70
v_xor_b32 v79, s34, v71
v_cvt_f32_u32 v4, v4
v_mul_f32 v208, 0x3c800000, v4
v_mov_b32 v210, v6
v_mul_f32 v209, v210, v208
v_cos_f32 v200, v209
s_add_u32 m0, s32, 4096
s_add_u32 s49, s52, 98304
buffer_load_dwordx4 v230, s[64:67], s49 offen lds
v_sin_f32 v201, v209
v_add_f32 v209, v209, v208
v_cos_f32 v202, v209
v_sin_f32 v203, v209
v_add_f32 v209, v209, v208
v_cos_f32 v204, v209
v_sin_f32 v205, v209
v_add_f32 v209, v209, v208
v_cos_f32 v206, v209
v_sin_f32 v207, v209
v_cvt_pk_bf16_f32 v80, v200, v201
v_cvt_pk_bf16_f32 v96, -v201, v200
v_cvt_pk_bf16_f32 v81, v202, v203
v_cvt_pk_bf16_f32 v97, -v203, v202
buffer_load_dwordx4 v231, s[64:67], s49 offen offset:1024 lds
v_cvt_pk_bf16_f32 v82, v204, v205
v_cvt_pk_bf16_f32 v98, -v205, v204
v_cvt_pk_bf16_f32 v83, v206, v207
v_cvt_pk_bf16_f32 v99, -v207, v206
v_add_f32 v210, 16.0, v6
v_mul_f32 v209, v210, v208
v_cos_f32 v200, v209
v_sin_f32 v201, v209
v_add_f32 v209, v209, v208
v_cos_f32 v202, v209
v_sin_f32 v203, v209
v_add_f32 v209, v209, v208
v_cos_f32 v204, v209
v_sin_f32 v205, v209
s_add_u32 m0, s32, 6144
s_add_u32 s49, s52, 114688
buffer_load_dwordx4 v230, s[64:67], s49 offen lds
v_add_f32 v209, v209, v208
v_cos_f32 v206, v209
v_sin_f32 v207, v209
v_cvt_pk_bf16_f32 v84, v200, v201
v_cvt_pk_bf16_f32 v100, -v201, v200
v_cvt_pk_bf16_f32 v85, v202, v203
v_cvt_pk_bf16_f32 v101, -v203, v202
v_cvt_pk_bf16_f32 v86, v204, v205
v_cvt_pk_bf16_f32 v102, -v205, v204
v_cvt_pk_bf16_f32 v87, v206, v207
v_cvt_pk_bf16_f32 v103, -v207, v206
v_xor_b32 v88, v80, v220
v_xor_b32 v89, v81, v220
v_xor_b32 v90, v82, v220
buffer_load_dwordx4 v231, s[64:67], s49 offen offset:1024 lds
v_xor_b32 v91, v83, v220
v_xor_b32 v92, v84, v220
v_xor_b32 v93, v85, v220
v_xor_b32 v94, v86, v220
v_xor_b32 v95, v87, v220
v_xor_b32 v104, v96, v220
v_xor_b32 v105, v97, v220
v_xor_b32 v106, v98, v220
v_xor_b32 v107, v99, v220
v_xor_b32 v108, v100, v220
v_xor_b32 v109, v101, v220
v_xor_b32 v110, v102, v220
v_xor_b32 v111, v103, v220
v_cvt_f32_u32 v5, s36
s_add_u32 m0, s32, 8192
s_add_u32 s49, s52, 131072
buffer_load_dwordx4 v230, s[64:67], s49 offen lds
v_add_f32 v5, v5, v6
v_mov_b32 v208, v7
v_mul_f32 v208, 0x3a000000, v208
v_mul_f32 v209, v5, v208
v_cos_f32 v112, v209
v_sin_f32 v113, v209
v_add_f32 v209, v209, v208
v_cos_f32 v114, v209
v_sin_f32 v115, v209
v_add_f32 v209, v209, v208
v_cos_f32 v116, v209
v_sin_f32 v117, v209
v_add_f32 v209, v209, v208
v_cos_f32 v118, v209
buffer_load_dwordx4 v231, s[64:67], s49 offen offset:1024 lds
v_sin_f32 v119, v209
v_add_f32 v208, 16.0, v7
v_mul_f32 v208, 0x3a000000, v208
v_mul_f32 v209, v5, v208
v_cos_f32 v120, v209
v_sin_f32 v121, v209
v_add_f32 v209, v209, v208
v_cos_f32 v122, v209
v_sin_f32 v123, v209
v_add_f32 v209, v209, v208
v_cos_f32 v124, v209
v_sin_f32 v125, v209
v_add_f32 v209, v209, v208
v_cos_f32 v126, v209
s_add_u32 m0, s32, 10240
s_add_u32 s49, s52, 147456
buffer_load_dwordx4 v230, s[64:67], s49 offen lds
v_sin_f32 v127, v209
v_mul_f32 v208, 0x3a000000, v4
v_mov_b32 v210, v6
v_mul_f32 v209, v210, v208
v_cos_f32 v128, v209
v_sin_f32 v129, v209
v_add_f32 v209, v209, v208
v_cos_f32 v130, v209
v_sin_f32 v131, v209
v_add_f32 v209, v209, v208
v_cos_f32 v132, v209
v_sin_f32 v133, v209
v_add_f32 v209, v209, v208
v_cos_f32 v134, v209
buffer_load_dwordx4 v231, s[64:67], s49 offen offset:1024 lds
v_sin_f32 v135, v209
v_add_f32 v210, 16.0, v6
v_mul_f32 v209, v210, v208
v_cos_f32 v136, v209
v_sin_f32 v137, v209
v_add_f32 v209, v209, v208
v_cos_f32 v138, v209
v_sin_f32 v139, v209
v_add_f32 v209, v209, v208
v_cos_f32 v140, v209
v_sin_f32 v141, v209
v_add_f32 v209, v209, v208
v_cos_f32 v142, v209
v_sin_f32 v143, v209
s_cmp_lg_u32 s28, 0
s_cbranch_scc1 L_parallel_sum__spectral_gfnet__glu_gated_reglu__prompt_kernel_w0c_25
s_waitcnt vmcnt(16)
v_cmp_eq_u32 vcc, 1, v26
s_nop 4
s_cmp_eq_u64 vcc, exec
s_cbranch_scc1 L_parallel_sum__spectral_gfnet__glu_gated_reglu__prompt_kernel_ppok_26
s_mov_b32 s56, 0
L_parallel_sum__spectral_gfnet__glu_gated_reglu__prompt_kernel_pp_27:
buffer_load_dword v26, v27, s[16:19], s43 offen sc1
s_waitcnt vmcnt(0)
v_cmp_eq_u32 vcc, 1, v26
s_nop 4
s_cmp_eq_u64 vcc, exec
s_cbranch_scc1 L_parallel_sum__spectral_gfnet__glu_gated_reglu__prompt_kernel_ppd_28
s_add_u32 s56, s56, 1
s_cmp_gt_u32 s56, 40000
s_cbranch_scc1 L_parallel_sum__spectral_gfnet__glu_gated_reglu__prompt_kernel_ppd_28
s_sleep 4
s_branch L_parallel_sum__spectral_gfnet__glu_gated_reglu__prompt_kernel_pp_27
L_parallel_sum__spectral_gfnet__glu_gated_reglu__prompt_kernel_ppd_28:
L_parallel_sum__spectral_gfnet__glu_gated_reglu__prompt_kernel_ppok_26:
L_parallel_sum__spectral_gfnet__glu_gated_reglu__prompt_kernel_w0c_25:
s_cmp_lg_u32 s74, 64
s_cbranch_scc1 L_parallel_sum__spectral_gfnet__glu_gated_reglu__prompt_kernel_p256_29
s_and_b32 s43, s2, 7
s_lshl_b32 s43, s43, 9
s_add_u32 s43, s43, 14688512
v_and_b32 v27, 15, v224
v_lshlrev_b32 v27, 2, v27
s_cmp_lg_u32 s28, 0
s_cbranch_scc1 L_parallel_sum__spectral_gfnet__glu_gated_reglu__prompt_kernel_w0s_30
s_mov_b32 s56, 0
L_parallel_sum__spectral_gfnet__glu_gated_reglu__prompt_kernel_pp2_31:
buffer_load_dword v26, v27, s[16:19], s43 offen sc1
s_waitcnt vmcnt(0)
v_cmp_eq_u32 vcc, 1, v26
s_nop 4
s_cmp_eq_u64 vcc, exec
s_cbranch_scc1 L_parallel_sum__spectral_gfnet__glu_gated_reglu__prompt_kernel_pp2d_32
s_add_u32 s56, s56, 1
s_cmp_gt_u32 s56, 40000
s_cbranch_scc1 L_parallel_sum__spectral_gfnet__glu_gated_reglu__prompt_kernel_pp2d_32
s_sleep 4
s_branch L_parallel_sum__spectral_gfnet__glu_gated_reglu__prompt_kernel_pp2_31
L_parallel_sum__spectral_gfnet__glu_gated_reglu__prompt_kernel_pp2d_32:
L_parallel_sum__spectral_gfnet__glu_gated_reglu__prompt_kernel_w0s_30:
L_parallel_sum__spectral_gfnet__glu_gated_reglu__prompt_kernel_p256_29:
s_waitcnt vmcnt(12)
s_barrier
s_lshl_b32 s60, s29, 4
s_add_u32 s60, s60, s30
s_lshl_b32 s60, s60, 2
s_add_u32 s60, s60, 14684160
s_cmp_lg_u32 s28, 0
s_cbranch_scc1 L_parallel_sum__spectral_gfnet__glu_gated_reglu__prompt_kernel_flag_33
s_mov_b64 exec, 1
v_mov_b32 v212, 1
v_mov_b32 v213, 0
buffer_store_dword v212, v213, s[16:19], s60 offen sc1
s_mov_b64 exec, -1
L_parallel_sum__spectral_gfnet__glu_gated_reglu__prompt_kernel_flag_33:
v_and_b32 v8, 15, v224
v_lshrrev_b32 v9, 4, v224
s_lshl_b32 s35, s75, 13
s_lshl_b32 s37, s28, 11
s_add_u32 s35, s35, s37
s_add_u32 s35, s35, 2097152
v_lshlrev_b32 v10, 9, v9
v_lshl_add_u32 v10, v8, 4, v10
buffer_load_dwordx4 v[40:43], v10, s[16:19], s35 offen sc1
buffer_load_dwordx4 v[44:47], v10, s[16:19], s35 offen offset:256 sc1
s_cmp_eq_u32 s75, 256
s_cselect_b32 s35, 16, 0
s_and_b32 s37, s75, 255
s_cmp_lg_u32 s37, 0
s_cbranch_scc1 L_parallel_sum__spectral_gfnet__glu_gated_reglu__prompt_kernel_normal_34
v_lshrrev_b32 v32, s35, v32
v_and_b32 v32, 0xffff, v32
v_lshrrev_b32 v33, s35, v33
v_and_b32 v33, 0xffff, v33
v_lshrrev_b32 v34, s35, v34
v_and_b32 v34, 0xffff, v34
v_lshrrev_b32 v35, s35, v35
v_and_b32 v35, 0xffff, v35
v_lshrrev_b32 v36, s35, v36
v_and_b32 v36, 0xffff, v36
v_lshrrev_b32 v37, s35, v37
v_and_b32 v37, 0xffff, v37
v_lshrrev_b32 v38, s35, v38
v_and_b32 v38, 0xffff, v38
v_lshrrev_b32 v39, s35, v39
v_and_b32 v39, 0xffff, v39
L_parallel_sum__spectral_gfnet__glu_gated_reglu__prompt_kernel_normal_34:
v_mfma_f32_16x16x32_bf16 v[144:147], v[32:35], v[48:51], 0
v_mfma_f32_16x16x32_bf16 v[152:155], v[32:35], v[64:67], 0
v_mfma_f32_16x16x32_bf16 v[144:147], v[36:39], v[52:55], v[144:147]
v_mfma_f32_16x16x32_bf16 v[152:155], v[36:39], v[68:71], v[152:155]
v_mfma_f32_16x16x32_bf16 v[148:151], v[32:35], v[56:59], 0
v_mfma_f32_16x16x32_bf16 v[156:159], v[32:35], v[72:75], 0
v_mfma_f32_16x16x32_bf16 v[148:151], v[36:39], v[60:63], v[148:151]
v_mfma_f32_16x16x32_bf16 v[156:159], v[36:39], v[76:79], v[156:159]
s_cmp_lg_u32 s74, 64
s_cbranch_scc1 L_parallel_sum__spectral_gfnet__glu_gated_reglu__prompt_kernel_c64_35
v_and_b32 v8, 15, v224
v_lshrrev_b32 v9, 4, v224
s_cmp_eq_u32 s2, 256
s_cselect_b32 s35, 0, s2
s_lshl_b32 s35, s35, 13
s_add_u32 s35, s35, 0
s_lshl_b32 s36, s28, 4
v_add_u32 v10, s36, v8
v_lshlrev_b32 v10, 7, v10
v_lshl_add_u32 v10, v9, 4, v10
buffer_load_dwordx4 v[32:35], v10, s[16:19], s35 offen sc1
buffer_load_dwordx4 v[36:39], v10, s[16:19], s35 offen offset:64 sc1
L_parallel_sum__spectral_gfnet__glu_gated_reglu__prompt_kernel_c64_35:
s_add_u32 m0, s32, 12288
s_add_u32 s49, s52, 163840
buffer_load_dwordx4 v230, s[64:67], s49 offen lds
v_mul_f32 v200, v144, v112
v_mul_f32 v201, v152, v112
v_fma_f32 v200, v152, v113, v200
v_fma_f32 v201, -v144, v113, v201
v_mul_f32 v202, v145, v114
v_mul_f32 v203, v153, v114
v_fma_f32 v202, v153, v115, v202
v_fma_f32 v203, -v145, v115, v203
v_mul_f32 v204, v146, v116
v_mul_f32 v205, v154, v116
v_fma_f32 v204, v154, v117, v204
v_fma_f32 v205, -v146, v117, v205
v_mul_f32 v206, v147, v118
v_mul_f32 v207, v155, v118
v_fma_f32 v206, v155, v119, v206
v_fma_f32 v207, -v147, v119, v207
v_cvt_pk_bf16_f32 v160, v200, v201
v_cvt_pk_bf16_f32 v161, v202, v203
v_cvt_pk_bf16_f32 v162, v204, v205
v_cvt_pk_bf16_f32 v163, v206, v207
v_mul_f32 v200, v148, v120
v_mul_f32 v201, v156, v120
v_fma_f32 v200, v156, v121, v200
v_fma_f32 v201, -v148, v121, v201
v_mul_f32 v202, v149, v122
v_mul_f32 v203, v157, v122
v_fma_f32 v202, v157, v123, v202
v_fma_f32 v203, -v149, v123, v203
v_mul_f32 v204, v150, v124
v_mul_f32 v205, v158, v124
v_fma_f32 v204, v158, v125, v204
v_fma_f32 v205, -v150, v125, v205
v_mul_f32 v206, v151, v126
v_mul_f32 v207, v159, v126
v_fma_f32 v206, v159, v127, v206
v_fma_f32 v207, -v151, v127, v207
v_cvt_pk_bf16_f32 v164, v200, v201
v_cvt_pk_bf16_f32 v165, v202, v203
v_cvt_pk_bf16_f32 v166, v204, v205
v_cvt_pk_bf16_f32 v167, v206, v207
buffer_load_dwordx4 v231, s[64:67], s49 offen offset:1024 lds
s_add_u32 m0, s32, 14336
s_add_u32 s49, s52, 180224
buffer_load_dwordx4 v230, s[64:67], s49 offen lds
ds_write_b128 v218, v[160:163] offset:0
ds_write_b128 v218, v[164:167] offset:1024
buffer_load_dwordx4 v231, s[64:67], s49 offen offset:1024 lds
s_waitcnt lgkmcnt(0)
s_barrier
s_add_u32 m0, s32, 16384
s_add_u32 s49, s52, 196608
buffer_load_dwordx4 v230, s[64:67], s49 offen lds
buffer_load_dwordx4 v231, s[64:67], s49 offen offset:1024 lds
ds_read_b128 v[168:171], v216 offset:0
ds_read_b128 v[172:175], v216 offset:1024
ds_read_b128 v[176:179], v216 offset:32768
ds_read_b128 v[180:183], v216 offset:33792
ds_read_b128 v[184:187], v217 offset:0
ds_read_b128 v[188:191], v217 offset:1024
ds_read_b128 v[192:195], v217 offset:32768
ds_read_b128 v[196:199], v217 offset:33792
s_add_u32 m0, s32, 18432
s_add_u32 s49, s52, 212992
buffer_load_dwordx4 v230, s[64:67], s49 offen lds
s_waitcnt lgkmcnt(7)
v_mfma_f32_16x16x32_bf16 v[144:147], v[80:83], v[168:171], 0
v_mfma_f32_16x16x32_bf16 v[152:155], v[96:99], v[168:171], 0
s_waitcnt lgkmcnt(5)
v_mfma_f32_16x16x32_bf16 v[144:147], v[84:87], v[176:179], v[144:147]
v_mfma_f32_16x16x32_bf16 v[152:155], v[100:103], v[176:179], v[152:155]
s_waitcnt lgkmcnt(3)
v_mfma_f32_16x16x32_bf16 v[144:147], v[88:91], v[184:187], v[144:147]
v_mfma_f32_16x16x32_bf16 v[152:155], v[104:107], v[184:187], v[152:155]
s_waitcnt lgkmcnt(1)
v_mfma_f32_16x16x32_bf16 v[144:147], v[92:95], v[192:195], v[144:147]
v_mfma_f32_16x16x32_bf16 v[152:155], v[108:111], v[192:195], v[152:155]
v_mfma_f32_16x16x32_bf16 v[148:151], v[80:83], v[172:175], 0
v_mfma_f32_16x16x32_bf16 v[156:159], v[96:99], v[172:175], 0
v_mfma_f32_16x16x32_bf16 v[148:151], v[84:87], v[180:183], v[148:151]
v_mfma_f32_16x16x32_bf16 v[156:159], v[100:103], v[180:183], v[156:159]
v_mfma_f32_16x16x32_bf16 v[148:151], v[88:91], v[188:191], v[148:151]
v_mfma_f32_16x16x32_bf16 v[156:159], v[104:107], v[188:191], v[156:159]
s_waitcnt lgkmcnt(0)
v_mfma_f32_16x16x32_bf16 v[148:151], v[92:95], v[196:199], v[148:151]
v_mfma_f32_16x16x32_bf16 v[156:159], v[108:111], v[196:199], v[156:159]
buffer_load_dwordx4 v231, s[64:67], s49 offen offset:1024 lds
s_waitcnt vmcnt(9)
v_lshlrev_b32 v208, 16, v40
v_and_b32 v209, s57, v40
v_mul_f32 v200, v144, v208
v_mul_f32 v201, -v144, v209
v_fma_f32 v200, -v152, v209, v200
v_fma_f32 v201, -v152, v208, v201
v_lshlrev_b32 v208, 16, v41
v_and_b32 v209, s57, v41
v_mul_f32 v202, v145, v208
v_mul_f32 v203, -v145, v209
v_fma_f32 v202, -v153, v209, v202
v_fma_f32 v203, -v153, v208, v203
v_lshlrev_b32 v208, 16, v42
v_and_b32 v209, s57, v42
v_mul_f32 v204, v146, v208
v_mul_f32 v205, -v146, v209
v_fma_f32 v204, -v154, v209, v204
v_fma_f32 v205, -v154, v208, v205
v_lshlrev_b32 v208, 16, v43
v_and_b32 v209, s57, v43
v_mul_f32 v206, v147, v208
v_mul_f32 v207, -v147, v209
v_fma_f32 v206, -v155, v209, v206
v_fma_f32 v207, -v155, v208, v207
v_cvt_pk_bf16_f32 v160, v200, v201
v_cvt_pk_bf16_f32 v161, v202, v203
v_cvt_pk_bf16_f32 v162, v204, v205
v_cvt_pk_bf16_f32 v163, v206, v207
s_waitcnt vmcnt(8)
v_lshlrev_b32 v208, 16, v44
v_and_b32 v209, s57, v44
v_mul_f32 v200, v148, v208
v_mul_f32 v201, -v148, v209
v_fma_f32 v200, -v156, v209, v200
v_fma_f32 v201, -v156, v208, v201
v_lshlrev_b32 v208, 16, v45
v_and_b32 v209, s57, v45
v_mul_f32 v202, v149, v208
v_mul_f32 v203, -v149, v209
v_fma_f32 v202, -v157, v209, v202
v_fma_f32 v203, -v157, v208, v203
v_lshlrev_b32 v208, 16, v46
v_and_b32 v209, s57, v46
v_mul_f32 v204, v150, v208
v_mul_f32 v205, -v150, v209
v_fma_f32 v204, -v158, v209, v204
v_fma_f32 v205, -v158, v208, v205
v_lshlrev_b32 v208, 16, v47
v_and_b32 v209, s57, v47
v_mul_f32 v206, v151, v208
v_mul_f32 v207, -v151, v209
v_fma_f32 v206, -v159, v209, v206
v_fma_f32 v207, -v159, v208, v207
v_cvt_pk_bf16_f32 v164, v200, v201
v_cvt_pk_bf16_f32 v165, v202, v203
v_cvt_pk_bf16_f32 v166, v204, v205
v_cvt_pk_bf16_f32 v167, v206, v207
ds_write_b128 v218, v[160:163] offset:2048
ds_write_b128 v218, v[164:167] offset:3072
s_cmp_lg_u32 s74, 64
s_cbranch_scc1 L_parallel_sum__spectral_gfnet__glu_gated_reglu__prompt_kernel_c64_36
v_and_b32 v8, 15, v224
v_lshrrev_b32 v9, 4, v224
s_lshl_b32 s35, s2, 13
s_lshl_b32 s37, s28, 11
s_add_u32 s35, s35, s37
s_add_u32 s35, s35, 2097152
v_lshlrev_b32 v10, 9, v9
v_lshl_add_u32 v10, v8, 4, v10
buffer_load_dwordx4 v[40:43], v10, s[16:19], s35 offen sc1
buffer_load_dwordx4 v[44:47], v10, s[16:19], s35 offen offset:256 sc1
L_parallel_sum__spectral_gfnet__glu_gated_reglu__prompt_kernel_c64_36:
s_add_u32 m0, s32, 20480
s_add_u32 s49, s52, 229376
buffer_load_dwordx4 v230, s[64:67], s49 offen lds
s_waitcnt lgkmcnt(0)
s_barrier
s_lshr_b32 s44, s76, 1
s_lshl_b32 s44, s44, 6
s_add_u32 s44, s44, 14684160
v_and_b32 v221, 15, v224
v_lshlrev_b32 v221, 2, v221
s_cmp_lg_u32 s28, 0
s_cbranch_scc1 L_parallel_sum__spectral_gfnet__glu_gated_reglu__prompt_kernel_w0i_37
buffer_load_dword v222, v221, s[16:19], s44 offen sc1
L_parallel_sum__spectral_gfnet__glu_gated_reglu__prompt_kernel_w0i_37:
buffer_load_dwordx4 v231, s[64:67], s49 offen offset:1024 lds
s_add_u32 m0, s32, 22528
s_add_u32 s49, s52, 245760
buffer_load_dwordx4 v230, s[64:67], s49 offen lds
ds_read_b128 v[168:171], v216 offset:2048
ds_read_b128 v[172:175], v216 offset:3072
ds_read_b128 v[176:179], v216 offset:34816
ds_read_b128 v[180:183], v216 offset:35840
ds_read_b128 v[184:187], v217 offset:2048
ds_read_b128 v[188:191], v217 offset:3072
ds_read_b128 v[192:195], v217 offset:34816
ds_read_b128 v[196:199], v217 offset:35840
buffer_load_dwordx4 v231, s[64:67], s49 offen offset:1024 lds
s_waitcnt lgkmcnt(7)
v_mfma_f32_16x16x32_bf16 v[144:147], v[168:171], v[80:83], 0
v_mfma_f32_16x16x32_bf16 v[152:155], v[168:171], v[96:99], 0
s_waitcnt lgkmcnt(5)
v_mfma_f32_16x16x32_bf16 v[144:147], v[176:179], v[84:87], v[144:147]
v_mfma_f32_16x16x32_bf16 v[152:155], v[176:179], v[100:103], v[152:155]
s_waitcnt lgkmcnt(3)
v_mfma_f32_16x16x32_bf16 v[144:147], v[184:187], v[88:91], v[144:147]
v_mfma_f32_16x16x32_bf16 v[152:155], v[184:187], v[104:107], v[152:155]
s_waitcnt lgkmcnt(1)
v_mfma_f32_16x16x32_bf16 v[144:147], v[192:195], v[92:95], v[144:147]
v_mfma_f32_16x16x32_bf16 v[152:155], v[192:195], v[108:111], v[152:155]
v_mfma_f32_16x16x32_bf16 v[148:151], v[172:175], v[80:83], 0
v_mfma_f32_16x16x32_bf16 v[156:159], v[172:175], v[96:99], 0
v_mfma_f32_16x16x32_bf16 v[148:151], v[180:183], v[84:87], v[148:151]
v_mfma_f32_16x16x32_bf16 v[156:159], v[180:183], v[100:103], v[156:159]
v_mfma_f32_16x16x32_bf16 v[148:151], v[188:191], v[88:91], v[148:151]
v_mfma_f32_16x16x32_bf16 v[156:159], v[188:191], v[104:107], v[156:159]
s_waitcnt lgkmcnt(0)
v_mfma_f32_16x16x32_bf16 v[148:151], v[196:199], v[92:95], v[148:151]
v_mfma_f32_16x16x32_bf16 v[156:159], v[196:199], v[108:111], v[156:159]
s_add_u32 m0, s32, 24576
s_add_u32 s49, s52, 262144
buffer_load_dwordx4 v230, s[64:67], s49 offen lds
buffer_load_dwordx4 v231, s[64:67], s49 offen offset:1024 lds
v_mul_f32 v200, v144, v128
v_mul_f32 v201, v152, v128
v_fma_f32 v200, v152, v129, v200
v_fma_f32 v201, -v144, v129, v201
v_mul_f32 v202, v145, v130
v_mul_f32 v203, v153, v130
v_fma_f32 v202, v153, v131, v202
v_fma_f32 v203, -v145, v131, v203
v_mul_f32 v204, v146, v132
v_mul_f32 v205, v154, v132
v_fma_f32 v204, v154, v133, v204
v_fma_f32 v205, -v146, v133, v205
v_mul_f32 v206, v147, v134
v_mul_f32 v207, v155, v134
v_fma_f32 v206, v155, v135, v206
v_fma_f32 v207, -v147, v135, v207
v_cvt_pk_bf16_f32 v160, v200, v201
v_cvt_pk_bf16_f32 v161, v202, v203
v_cvt_pk_bf16_f32 v162, v204, v205
v_cvt_pk_bf16_f32 v163, v206, v207
v_mul_f32 v200, v148, v136
v_mul_f32 v201, v156, v136
v_fma_f32 v200, v156, v137, v200
v_fma_f32 v201, -v148, v137, v201
v_mul_f32 v202, v149, v138
v_mul_f32 v203, v157, v138
v_fma_f32 v202, v157, v139, v202
v_fma_f32 v203, -v149, v139, v203
v_mul_f32 v204, v150, v140
v_mul_f32 v205, v158, v140
v_fma_f32 v204, v158, v141, v204
v_fma_f32 v205, -v150, v141, v205
v_mul_f32 v206, v151, v142
v_mul_f32 v207, v159, v142
v_fma_f32 v206, v159, v143, v206
v_fma_f32 v207, -v151, v143, v207
v_cvt_pk_bf16_f32 v164, v200, v201
v_cvt_pk_bf16_f32 v165, v202, v203
v_cvt_pk_bf16_f32 v166, v204, v205
v_cvt_pk_bf16_f32 v167, v206, v207
s_add_u32 m0, s32, 26624
s_add_u32 s49, s52, 278528
buffer_load_dwordx4 v230, s[64:67], s49 offen lds
v_mfma_f32_16x16x32_bf16 v[144:147], v[48:51], v[160:163], 0
v_mfma_f32_16x16x32_bf16 v[152:155], v[64:67], v[160:163], 0
v_mfma_f32_16x16x32_bf16 v[144:147], v[52:55], v[164:167], v[144:147]
v_mfma_f32_16x16x32_bf16 v[152:155], v[68:71], v[164:167], v[152:155]
v_mfma_f32_16x16x32_bf16 v[148:151], v[56:59], v[160:163], 0
v_mfma_f32_16x16x32_bf16 v[156:159], v[72:75], v[160:163], 0
v_mfma_f32_16x16x32_bf16 v[148:151], v[60:63], v[164:167], v[148:151]
v_mfma_f32_16x16x32_bf16 v[156:159], v[76:79], v[164:167], v[156:159]
buffer_load_dwordx4 v231, s[64:67], s49 offen offset:1024 lds
s_lshl_b32 s35, s75, 1
s_cmp_eq_u32 s75, 256
s_cselect_b32 s35, 1, s35
s_lshl_b32 s35, s35, 12
s_add_u32 s35, s35, 11534336
v_mul_f32 v144, 0x36000000, v144
v_mul_f32 v145, 0x36000000, v145
v_mul_f32 v146, 0x36000000, v146
v_mul_f32 v147, 0x36000000, v147
v_mul_f32 v148, 0x36000000, v148
v_mul_f32 v149, 0x36000000, v149
v_mul_f32 v150, 0x36000000, v150
v_mul_f32 v151, 0x36000000, v151
v_cvt_pk_bf16_f32 v200, v144, v145
v_cvt_pk_bf16_f32 v201, v146, v147
v_cvt_pk_bf16_f32 v202, v148, v149
v_cvt_pk_bf16_f32 v203, v150, v151
s_nop 0
v_permlane16_swap_b32 v200, v202
v_permlane16_swap_b32 v201, v203
buffer_store_dwordx4 v[200:203], v219, s[16:19], s35 offen sc1
s_and_b32 s37, s75, 255
s_cmp_eq_u32 s37, 0
s_cbranch_scc1 L_parallel_sum__spectral_gfnet__glu_gated_reglu__prompt_kernel_noim_38
s_add_u32 s35, s35, 4096
v_mul_f32 v152, 0x36000000, v152
v_mul_f32 v153, 0x36000000, v153
v_mul_f32 v154, 0x36000000, v154
v_mul_f32 v155, 0x36000000, v155
v_mul_f32 v156, 0x36000000, v156
v_mul_f32 v157, 0x36000000, v157
v_mul_f32 v158, 0x36000000, v158
v_mul_f32 v159, 0x36000000, v159
v_cvt_pk_bf16_f32 v204, v152, v153
v_cvt_pk_bf16_f32 v205, v154, v155
v_cvt_pk_bf16_f32 v206, v156, v157
v_cvt_pk_bf16_f32 v207, v158, v159
s_nop 0
v_permlane16_swap_b32 v204, v206
v_permlane16_swap_b32 v205, v207
buffer_store_dwordx4 v[204:207], v219, s[16:19], s35 offen sc1
L_parallel_sum__spectral_gfnet__glu_gated_reglu__prompt_kernel_noim_38:
s_cmp_lg_u32 s74, 64
s_cbranch_scc1 L_parallel_sum__spectral_gfnet__glu_gated_reglu__prompt_kernel_no256_39
s_barrier
s_mov_b32 s75, s2
s_waitcnt vmcnt(17)
s_cmp_eq_u32 s75, 256
s_cselect_b32 s35, 16, 0
s_and_b32 s37, s75, 255
s_cmp_lg_u32 s37, 0
s_cbranch_scc1 L_parallel_sum__spectral_gfnet__glu_gated_reglu__prompt_kernel_normal_40
v_lshrrev_b32 v32, s35, v32
v_and_b32 v32, 0xffff, v32
v_lshrrev_b32 v33, s35, v33
v_and_b32 v33, 0xffff, v33
v_lshrrev_b32 v34, s35, v34
v_and_b32 v34, 0xffff, v34
v_lshrrev_b32 v35, s35, v35
v_and_b32 v35, 0xffff, v35
v_lshrrev_b32 v36, s35, v36
v_and_b32 v36, 0xffff, v36
v_lshrrev_b32 v37, s35, v37
v_and_b32 v37, 0xffff, v37
v_lshrrev_b32 v38, s35, v38
v_and_b32 v38, 0xffff, v38
v_lshrrev_b32 v39, s35, v39
v_and_b32 v39, 0xffff, v39
L_parallel_sum__spectral_gfnet__glu_gated_reglu__prompt_kernel_normal_40:
v_mfma_f32_16x16x32_bf16 v[144:147], v[32:35], v[48:51], 0
v_mfma_f32_16x16x32_bf16 v[152:155], v[32:35], v[64:67], 0
v_mfma_f32_16x16x32_bf16 v[144:147], v[36:39], v[52:55], v[144:147]
v_mfma_f32_16x16x32_bf16 v[152:155], v[36:39], v[68:71], v[152:155]
v_mfma_f32_16x16x32_bf16 v[148:151], v[32:35], v[56:59], 0
v_mfma_f32_16x16x32_bf16 v[156:159], v[32:35], v[72:75], 0
v_mfma_f32_16x16x32_bf16 v[148:151], v[36:39], v[60:63], v[148:151]
v_mfma_f32_16x16x32_bf16 v[156:159], v[36:39], v[76:79], v[156:159]
s_nop 2
v_mul_f32 v200, v144, v112
v_mul_f32 v201, v152, v112
v_fma_f32 v200, v152, v113, v200
v_fma_f32 v201, -v144, v113, v201
v_mul_f32 v202, v145, v114
v_mul_f32 v203, v153, v114
v_fma_f32 v202, v153, v115, v202
v_fma_f32 v203, -v145, v115, v203
v_mul_f32 v204, v146, v116
v_mul_f32 v205, v154, v116
v_fma_f32 v204, v154, v117, v204
v_fma_f32 v205, -v146, v117, v205
v_mul_f32 v206, v147, v118
v_mul_f32 v207, v155, v118
v_fma_f32 v206, v155, v119, v206
v_fma_f32 v207, -v147, v119, v207
v_cvt_pk_bf16_f32 v160, v200, v201
v_cvt_pk_bf16_f32 v161, v202, v203
v_cvt_pk_bf16_f32 v162, v204, v205
v_cvt_pk_bf16_f32 v163, v206, v207
v_mul_f32 v200, v148, v120
v_mul_f32 v201, v156, v120
v_fma_f32 v200, v156, v121, v200
v_fma_f32 v201, -v148, v121, v201
v_mul_f32 v202, v149, v122
v_mul_f32 v203, v157, v122
v_fma_f32 v202, v157, v123, v202
v_fma_f32 v203, -v149, v123, v203
v_mul_f32 v204, v150, v124
v_mul_f32 v205, v158, v124
v_fma_f32 v204, v158, v125, v204
v_fma_f32 v205, -v150, v125, v205
v_mul_f32 v206, v151, v126
v_mul_f32 v207, v159, v126
v_fma_f32 v206, v159, v127, v206
v_fma_f32 v207, -v151, v127, v207
v_cvt_pk_bf16_f32 v164, v200, v201
v_cvt_pk_bf16_f32 v165, v202, v203
v_cvt_pk_bf16_f32 v166, v204, v205
v_cvt_pk_bf16_f32 v167, v206, v207
ds_write_b128 v218, v[160:163] offset:0
ds_write_b128 v218, v[164:167] offset:1024
s_waitcnt lgkmcnt(0)
s_barrier
ds_read_b128 v[168:171], v216 offset:0
ds_read_b128 v[172:175], v216 offset:1024
ds_read_b128 v[176:179], v216 offset:32768
ds_read_b128 v[180:183], v216 offset:33792
ds_read_b128 v[184:187], v217 offset:0
ds_read_b128 v[188:191], v217 offset:1024
ds_read_b128 v[192:195], v217 offset:32768
ds_read_b128 v[196:199], v217 offset:33792
s_waitcnt lgkmcnt(7)
v_mfma_f32_16x16x32_bf16 v[144:147], v[80:83], v[168:171], 0
v_mfma_f32_16x16x32_bf16 v[152:155], v[96:99], v[168:171], 0
s_waitcnt lgkmcnt(5)
v_mfma_f32_16x16x32_bf16 v[144:147], v[84:87], v[176:179], v[144:147]
v_mfma_f32_16x16x32_bf16 v[152:155], v[100:103], v[176:179], v[152:155]
s_waitcnt lgkmcnt(3)
v_mfma_f32_16x16x32_bf16 v[144:147], v[88:91], v[184:187], v[144:147]
v_mfma_f32_16x16x32_bf16 v[152:155], v[104:107], v[184:187], v[152:155]
s_waitcnt lgkmcnt(1)
v_mfma_f32_16x16x32_bf16 v[144:147], v[92:95], v[192:195], v[144:147]
v_mfma_f32_16x16x32_bf16 v[152:155], v[108:111], v[192:195], v[152:155]
v_mfma_f32_16x16x32_bf16 v[148:151], v[80:83], v[172:175], 0
v_mfma_f32_16x16x32_bf16 v[156:159], v[96:99], v[172:175], 0
v_mfma_f32_16x16x32_bf16 v[148:151], v[84:87], v[180:183], v[148:151]
v_mfma_f32_16x16x32_bf16 v[156:159], v[100:103], v[180:183], v[156:159]
v_mfma_f32_16x16x32_bf16 v[148:151], v[88:91], v[188:191], v[148:151]
v_mfma_f32_16x16x32_bf16 v[156:159], v[104:107], v[188:191], v[156:159]
s_waitcnt lgkmcnt(0)
v_mfma_f32_16x16x32_bf16 v[148:151], v[92:95], v[196:199], v[148:151]
v_mfma_f32_16x16x32_bf16 v[156:159], v[108:111], v[196:199], v[156:159]
s_waitcnt vmcnt(9)
v_lshlrev_b32 v208, 16, v40
v_and_b32 v209, s57, v40
v_mul_f32 v200, v144, v208
v_mul_f32 v201, -v144, v209
v_fma_f32 v200, -v152, v209, v200
v_fma_f32 v201, -v152, v208, v201
v_lshlrev_b32 v208, 16, v41
v_and_b32 v209, s57, v41
v_mul_f32 v202, v145, v208
v_mul_f32 v203, -v145, v209
v_fma_f32 v202, -v153, v209, v202
v_fma_f32 v203, -v153, v208, v203
v_lshlrev_b32 v208, 16, v42
v_and_b32 v209, s57, v42
v_mul_f32 v204, v146, v208
v_mul_f32 v205, -v146, v209
v_fma_f32 v204, -v154, v209, v204
v_fma_f32 v205, -v154, v208, v205
v_lshlrev_b32 v208, 16, v43
v_and_b32 v209, s57, v43
v_mul_f32 v206, v147, v208
v_mul_f32 v207, -v147, v209
v_fma_f32 v206, -v155, v209, v206
v_fma_f32 v207, -v155, v208, v207
v_cvt_pk_bf16_f32 v160, v200, v201
v_cvt_pk_bf16_f32 v161, v202, v203
v_cvt_pk_bf16_f32 v162, v204, v205
v_cvt_pk_bf16_f32 v163, v206, v207
v_lshlrev_b32 v208, 16, v44
v_and_b32 v209, s57, v44
v_mul_f32 v200, v148, v208
v_mul_f32 v201, -v148, v209
v_fma_f32 v200, -v156, v209, v200
v_fma_f32 v201, -v156, v208, v201
v_lshlrev_b32 v208, 16, v45
v_and_b32 v209, s57, v45
v_mul_f32 v202, v149, v208
v_mul_f32 v203, -v149, v209
v_fma_f32 v202, -v157, v209, v202
v_fma_f32 v203, -v157, v208, v203
v_lshlrev_b32 v208, 16, v46
v_and_b32 v209, s57, v46
v_mul_f32 v204, v150, v208
v_mul_f32 v205, -v150, v209
v_fma_f32 v204, -v158, v209, v204
v_fma_f32 v205, -v158, v208, v205
v_lshlrev_b32 v208, 16, v47
v_and_b32 v209, s57, v47
v_mul_f32 v206, v151, v208
v_mul_f32 v207, -v151, v209
v_fma_f32 v206, -v159, v209, v206
v_fma_f32 v207, -v159, v208, v207
v_cvt_pk_bf16_f32 v164, v200, v201
v_cvt_pk_bf16_f32 v165, v202, v203
v_cvt_pk_bf16_f32 v166, v204, v205
v_cvt_pk_bf16_f32 v167, v206, v207
ds_write_b128 v218, v[160:163] offset:2048
ds_write_b128 v218, v[164:167] offset:3072
s_waitcnt lgkmcnt(0)
s_barrier
ds_read_b128 v[168:171], v216 offset:2048
ds_read_b128 v[172:175], v216 offset:3072
ds_read_b128 v[176:179], v216 offset:34816
ds_read_b128 v[180:183], v216 offset:35840
ds_read_b128 v[184:187], v217 offset:2048
ds_read_b128 v[188:191], v217 offset:3072
ds_read_b128 v[192:195], v217 offset:34816
ds_read_b128 v[196:199], v217 offset:35840
s_waitcnt lgkmcnt(7)
v_mfma_f32_16x16x32_bf16 v[144:147], v[168:171], v[80:83], 0
v_mfma_f32_16x16x32_bf16 v[152:155], v[168:171], v[96:99], 0
s_waitcnt lgkmcnt(5)
v_mfma_f32_16x16x32_bf16 v[144:147], v[176:179], v[84:87], v[144:147]
v_mfma_f32_16x16x32_bf16 v[152:155], v[176:179], v[100:103], v[152:155]
s_waitcnt lgkmcnt(3)
v_mfma_f32_16x16x32_bf16 v[144:147], v[184:187], v[88:91], v[144:147]
v_mfma_f32_16x16x32_bf16 v[152:155], v[184:187], v[104:107], v[152:155]
s_waitcnt lgkmcnt(1)
v_mfma_f32_16x16x32_bf16 v[144:147], v[192:195], v[92:95], v[144:147]
v_mfma_f32_16x16x32_bf16 v[152:155], v[192:195], v[108:111], v[152:155]
v_mfma_f32_16x16x32_bf16 v[148:151], v[172:175], v[80:83], 0
v_mfma_f32_16x16x32_bf16 v[156:159], v[172:175], v[96:99], 0
v_mfma_f32_16x16x32_bf16 v[148:151], v[180:183], v[84:87], v[148:151]
v_mfma_f32_16x16x32_bf16 v[156:159], v[180:183], v[100:103], v[156:159]
v_mfma_f32_16x16x32_bf16 v[148:151], v[188:191], v[88:91], v[148:151]
v_mfma_f32_16x16x32_bf16 v[156:159], v[188:191], v[104:107], v[156:159]
s_waitcnt lgkmcnt(0)
v_mfma_f32_16x16x32_bf16 v[148:151], v[196:199], v[92:95], v[148:151]
v_mfma_f32_16x16x32_bf16 v[156:159], v[196:199], v[108:111], v[156:159]
v_mul_f32 v200, v144, v128
v_mul_f32 v201, v152, v128
v_fma_f32 v200, v152, v129, v200
v_fma_f32 v201, -v144, v129, v201
v_mul_f32 v202, v145, v130
v_mul_f32 v203, v153, v130
v_fma_f32 v202, v153, v131, v202
v_fma_f32 v203, -v145, v131, v203
v_mul_f32 v204, v146, v132
v_mul_f32 v205, v154, v132
v_fma_f32 v204, v154, v133, v204
v_fma_f32 v205, -v146, v133, v205
v_mul_f32 v206, v147, v134
v_mul_f32 v207, v155, v134
v_fma_f32 v206, v155, v135, v206
v_fma_f32 v207, -v147, v135, v207
v_cvt_pk_bf16_f32 v160, v200, v201
v_cvt_pk_bf16_f32 v161, v202, v203
v_cvt_pk_bf16_f32 v162, v204, v205
v_cvt_pk_bf16_f32 v163, v206, v207
v_mul_f32 v200, v148, v136
v_mul_f32 v201, v156, v136
v_fma_f32 v200, v156, v137, v200
v_fma_f32 v201, -v148, v137, v201
v_mul_f32 v202, v149, v138
v_mul_f32 v203, v157, v138
v_fma_f32 v202, v157, v139, v202
v_fma_f32 v203, -v149, v139, v203
v_mul_f32 v204, v150, v140
v_mul_f32 v205, v158, v140
v_fma_f32 v204, v158, v141, v204
v_fma_f32 v205, -v150, v141, v205
v_mul_f32 v206, v151, v142
v_mul_f32 v207, v159, v142
v_fma_f32 v206, v159, v143, v206
v_fma_f32 v207, -v151, v143, v207
v_cvt_pk_bf16_f32 v164, v200, v201
v_cvt_pk_bf16_f32 v165, v202, v203
v_cvt_pk_bf16_f32 v166, v204, v205
v_cvt_pk_bf16_f32 v167, v206, v207
v_mfma_f32_16x16x32_bf16 v[144:147], v[48:51], v[160:163], 0
v_mfma_f32_16x16x32_bf16 v[152:155], v[64:67], v[160:163], 0
v_mfma_f32_16x16x32_bf16 v[144:147], v[52:55], v[164:167], v[144:147]
v_mfma_f32_16x16x32_bf16 v[152:155], v[68:71], v[164:167], v[152:155]
v_mfma_f32_16x16x32_bf16 v[148:151], v[56:59], v[160:163], 0
v_mfma_f32_16x16x32_bf16 v[156:159], v[72:75], v[160:163], 0
v_mfma_f32_16x16x32_bf16 v[148:151], v[60:63], v[164:167], v[148:151]
v_mfma_f32_16x16x32_bf16 v[156:159], v[76:79], v[164:167], v[156:159]
s_lshl_b32 s35, s75, 1
s_cmp_eq_u32 s75, 256
s_cselect_b32 s35, 1, s35
s_lshl_b32 s35, s35, 12
s_add_u32 s35, s35, 11534336
v_mul_f32 v144, 0x36000000, v144
v_mul_f32 v145, 0x36000000, v145
v_mul_f32 v146, 0x36000000, v146
v_mul_f32 v147, 0x36000000, v147
v_mul_f32 v148, 0x36000000, v148
v_mul_f32 v149, 0x36000000, v149
v_mul_f32 v150, 0x36000000, v150
v_mul_f32 v151, 0x36000000, v151
v_cvt_pk_bf16_f32 v200, v144, v145
v_cvt_pk_bf16_f32 v201, v146, v147
v_cvt_pk_bf16_f32 v202, v148, v149
v_cvt_pk_bf16_f32 v203, v150, v151
s_nop 0
v_permlane16_swap_b32 v200, v202
v_permlane16_swap_b32 v201, v203
buffer_store_dwordx4 v[200:203], v219, s[16:19], s35 offen sc1
s_and_b32 s37, s75, 255
s_cmp_eq_u32 s37, 0
s_cbranch_scc1 L_parallel_sum__spectral_gfnet__glu_gated_reglu__prompt_kernel_noim_41
s_add_u32 s35, s35, 4096
v_mul_f32 v152, 0x36000000, v152
v_mul_f32 v153, 0x36000000, v153
v_mul_f32 v154, 0x36000000, v154
v_mul_f32 v155, 0x36000000, v155
v_mul_f32 v156, 0x36000000, v156
v_mul_f32 v157, 0x36000000, v157
v_mul_f32 v158, 0x36000000, v158
v_mul_f32 v159, 0x36000000, v159
v_cvt_pk_bf16_f32 v204, v152, v153
v_cvt_pk_bf16_f32 v205, v154, v155
v_cvt_pk_bf16_f32 v206, v156, v157
v_cvt_pk_bf16_f32 v207, v158, v159
s_nop 0
v_permlane16_swap_b32 v204, v206
v_permlane16_swap_b32 v205, v207
buffer_store_dwordx4 v[204:207], v219, s[16:19], s35 offen sc1
L_parallel_sum__spectral_gfnet__glu_gated_reglu__prompt_kernel_noim_41:
s_waitcnt vmcnt(1)
s_barrier
s_mov_b32 s60, 14697472
s_cmp_lg_u32 s28, 0
s_cbranch_scc1 L_parallel_sum__spectral_gfnet__glu_gated_reglu__prompt_kernel_flag_42
v_mul_u32_u24 v13, 2048, v224
s_mov_b64 exec, 255
v_mov_b32 v12, 1
buffer_store_dword v12, v13, s[16:19], s60 offen sc1
s_mov_b64 exec, -1
L_parallel_sum__spectral_gfnet__glu_gated_reglu__prompt_kernel_flag_42:
L_parallel_sum__spectral_gfnet__glu_gated_reglu__prompt_kernel_no256_39:
s_lshr_b32 s40, s28, 1
s_lshl_b32 s41, s76, 1
s_add_u32 s42, s41, s40
s_xor_b32 s43, s40, 1
s_add_u32 s43, s41, s43
s_mul_i32 s36, s42, 88064
s_mul_i32 s37, s43, 88064
s_add_u32 s36, s36, 5242880
s_add_u32 s37, s37, 5242880
s_mul_i32 s40, s28, 22528
s_add_u32 s34, s36, s40
s_add_u32 s35, s37, s40
s_add_u32 s36, s36, 87040
s_add_u32 s37, s37, 87040
s_lshl_b32 s38, s28, 19
s_add_u32 s38, s38, 11534336
v_lshlrev_b32 v88, 4, v224
s_cmp_lg_u32 s28, 0
s_cbranch_scc1 L_parallel_sum__spectral_gfnet__glu_gated_reglu__prompt_kernel_w0c_43
s_waitcnt vmcnt(8)
v_cmp_eq_u32 vcc, 1, v222
s_nop 4
s_cmp_eq_u64 vcc, exec
s_cbranch_scc1 L_parallel_sum__spectral_gfnet__glu_gated_reglu__prompt_kernel_haok_44
s_mov_b32 s56, 0
L_parallel_sum__spectral_gfnet__glu_gated_reglu__prompt_kernel_ha_45:
buffer_load_dword v222, v221, s[16:19], s44 offen sc1
s_waitcnt vmcnt(0)
v_cmp_eq_u32 vcc, 1, v222
s_nop 4
s_cmp_eq_u64 vcc, exec
s_cbranch_scc1 L_parallel_sum__spectral_gfnet__glu_gated_reglu__prompt_kernel_had_46
s_add_u32 s56, s56, 1
s_cmp_gt_u32 s56, 40000
s_cbranch_scc1 L_parallel_sum__spectral_gfnet__glu_gated_reglu__prompt_kernel_had_46
s_sleep 4
s_branch L_parallel_sum__spectral_gfnet__glu_gated_reglu__prompt_kernel_ha_45
L_parallel_sum__spectral_gfnet__glu_gated_reglu__prompt_kernel_had_46:
L_parallel_sum__spectral_gfnet__glu_gated_reglu__prompt_kernel_haok_44:
L_parallel_sum__spectral_gfnet__glu_gated_reglu__prompt_kernel_w0c_43:
s_barrier
buffer_load_dwordx4 a[0:3], v88, s[16:19], s34 offen sc1
s_lshr_b32 s40, s28, 1
s_lshl_b32 s41, s76, 1
s_add_u32 s42, s41, s40
v_lshrrev_b32 v2, 3, v224
v_and_b32 v3, 7, v224
v_bfe_u32 v4, v224, 4, 1
v_lshlrev_b32 v4, 2, v4
v_xor_b32 v3, v3, v4
v_lshlrev_b32 v3, 4, v3
s_lshl_b32 s40, s76, 7
v_lshlrev_b32 v4, 12, v2
v_add3_u32 v89, v4, v3, s40
buffer_load_dwordx4 a[4:7], v88, s[16:19], s35 offen sc1
s_add_u32 s34, s34, s54
s_add_u32 s35, s35, s54
v_add_u32 v90, 31744, v89
v_and_b32 v2, 31, v224
v_lshrrev_b32 v3, 5, v224
v_lshlrev_b32 v4, 6, v2
v_add_u32 v4, s42, v4
v_lshlrev_b32 v4, 10, v4
s_and_b32 s40, s28, 1
s_lshl_b32 s40, s40, 6
s_lshl_b32 s41, s77, 7
s_add_u32 s40, s40, s41
v_add_u32 v4, s40, v4
v_lshlrev_b32 v5, 3, v3
v_add_u32 v5, v4, v5
buffer_load_dwordx4 a[8:11], v88, s[16:19], s34 offen sc1
buffer_load_dwordx2 v[80:81], v5, s[4:7], 0 offen offset:0
buffer_load_dwordx2 v[82:83], v5, s[4:7], 0 offen offset:16
buffer_load_dwordx2 v[84:85], v5, s[4:7], 0 offen offset:32
buffer_load_dwordx2 v[86:87], v5, s[4:7], 0 offen offset:48
v_lshlrev_b32 v5, 4, v3
v_add_u32 v100, v4, v5
v_bfe_u32 v4, v224, 2, 2
v_bfe_u32 v5, v224, 4, 1
v_lshlrev_b32 v5, 5, v5
v_and_b32 v6, 3, v224
v_lshlrev_b32 v6, 3, v6
v_add_u32 v5, v5, v6
v_lshrrev_b32 v6, 1, v4
buffer_load_dwordx4 a[12:15], v88, s[16:19], s35 offen sc1
s_add_u32 s34, s34, s54
s_add_u32 s35, s35, s54
s_and_b32 s40, s28, 1
s_lshr_b32 s41, s28, 1
v_lshl_add_u32 v7, v3, 2, v4
v_lshl_add_u32 v7, v7, 7, v5
v_xor_b32 v8, s40, v6
v_lshl_add_u32 v9, v8, 6, v7
v_xor_b32 v8, 1, v8
v_lshl_add_u32 v10, v8, 6, v7
v_add_u32 v92, s32, v9
v_add_u32 v93, s32, v10
v_add_u32 v94, s51, v9
v_add_u32 v95, s51, v10
buffer_load_dwordx4 a[16:19], v88, s[16:19], s34 offen sc1
v_lshl_add_u32 v7, v3, 3, v4
v_lshl_add_u32 v7, v7, 7, v5
v_xor_b32 v8, s41, v6
v_lshl_add_u32 v9, v8, 6, v7
v_xor_b32 v8, 1, v8
v_lshl_add_u32 v10, v8, 6, v7
v_add_u32 v96, s32, v9
v_add_u32 v97, s32, v10
v_add_u32 v98, s51, v9
v_add_u32 v99, s51, v10
v_add_u32 v101, s32, v88
s_xor_b32 s42, s28, 1
s_lshl_b32 s42, s42, 15
buffer_load_dwordx4 a[20:23], v88, s[16:19], s35 offen sc1
s_add_u32 s34, s34, s54
s_add_u32 s35, s35, s54
s_add_u32 s42, s42, 0
v_add_u32 v102, s42, v88
s_xor_b32 s42, s28, 2
s_lshl_b32 s42, s42, 15
s_add_u32 s42, s42, 4096
v_add_u32 v103, s42, v88
s_xor_b32 s42, s28, 3
s_lshl_b32 s42, s42, 15
s_add_u32 s42, s42, 8192
v_add_u32 v104, s42, v88
v_and_b32 v2, 31, v224
v_lshrrev_b32 v3, 5, v224
s_lshl_b32 s42, s77, 6
buffer_load_dwordx4 a[24:27], v88, s[16:19], s34 offen sc1
v_add_u32 v12, s42, v2
s_and_b32 s40, s28, 1
s_lshl_b32 s43, s40, 5
v_add_u32 v13, s43, v12
s_xor_b32 s43, s43, 32
v_add_u32 v14, s43, v12
v_cvt_f32_u32 v8, v13
v_cvt_f32_u32 v9, v14
v_mul_f32 v105, 0x3b000000, v8
v_mul_f32 v106, 0x3b000000, v9
s_lshl_b32 s42, s28, 6
v_lshlrev_b32 v12, 2, v3
v_add_u32 v12, s42, v12
buffer_load_dwordx4 a[28:31], v88, s[16:19], s35 offen sc1
s_add_u32 s34, s34, s54
s_add_u32 s35, s35, s54
v_cvt_f32_u32 v12, v12
v_mul_f32 v107, v12, v105
v_mul_f32 v108, v12, v106
v_lshlrev_b32 v13, 31, v13
v_or_b32 v109, 0x3f003f00, v13
v_lshlrev_b32 v14, 31, v14
v_or_b32 v110, 0x3f003f00, v14
v_cmp_gt_u32 s[46:47], 32, v224
s_cmp_eq_u32 s28, 0
s_cselect_b64 s[46:47], s[46:47], 0
v_cos_f32 v116, v107
v_sin_f32 v117, v107
buffer_load_dwordx4 a[32:35], v88, s[16:19], s34 offen sc1
v_add_f32 v107, v107, v105
v_cvt_pk_bf16_f32 v160, v116, v117
v_cos_f32 v118, v107
v_sin_f32 v119, v107
v_add_f32 v107, v107, v105
v_cvt_pk_bf16_f32 v161, v118, v119
v_cos_f32 v116, v107
v_sin_f32 v117, v107
v_add_f32 v107, v107, v105
v_cvt_pk_bf16_f32 v162, v116, v117
v_cos_f32 v118, v107
v_sin_f32 v119, v107
v_add_f32 v107, v107, v105
buffer_load_dwordx4 a[36:39], v88, s[16:19], s35 offen sc1
s_add_u32 s34, s34, s54
s_add_u32 s35, s35, s54
v_cvt_pk_bf16_f32 v163, v118, v119
v_fma_f32 v107, v105, 4.0, v107
v_cndmask_b32 v160, v160, v109, s[46:47]
v_cos_f32 v116, v108
v_sin_f32 v117, v108
v_add_f32 v108, v108, v106
v_cvt_pk_bf16_f32 v164, v116, v117
v_cos_f32 v118, v108
v_sin_f32 v119, v108
v_add_f32 v108, v108, v106
v_cvt_pk_bf16_f32 v165, v118, v119
v_cos_f32 v116, v108
v_sin_f32 v117, v108
buffer_load_dwordx4 a[40:43], v88, s[16:19], s34 offen sc1
v_add_f32 v108, v108, v106
v_cvt_pk_bf16_f32 v166, v116, v117
v_cos_f32 v118, v108
v_sin_f32 v119, v108
v_add_f32 v108, v108, v106
v_cvt_pk_bf16_f32 v167, v118, v119
v_fma_f32 v108, v106, 4.0, v108
v_cndmask_b32 v164, v164, v110, s[46:47]
v_cos_f32 v116, v107
v_sin_f32 v117, v107
v_add_f32 v107, v107, v105
v_cvt_pk_bf16_f32 v168, v116, v117
buffer_load_dwordx4 a[44:47], v88, s[16:19], s35 offen sc1
s_add_u32 s34, s34, s54
s_add_u32 s35, s35, s54
v_cos_f32 v118, v107
v_sin_f32 v119, v107
v_add_f32 v107, v107, v105
v_cvt_pk_bf16_f32 v169, v118, v119
v_cos_f32 v116, v107
v_sin_f32 v117, v107
v_add_f32 v107, v107, v105
v_cvt_pk_bf16_f32 v170, v116, v117
v_cos_f32 v118, v107
v_sin_f32 v119, v107
v_add_f32 v107, v107, v105
v_cvt_pk_bf16_f32 v171, v118, v119
v_fma_f32 v107, v105, 4.0, v107
buffer_load_dwordx4 a[48:51], v88, s[16:19], s34 offen sc1
v_cos_f32 v116, v108
v_sin_f32 v117, v108
v_add_f32 v108, v108, v106
v_cvt_pk_bf16_f32 v172, v116, v117
v_cos_f32 v118, v108
v_sin_f32 v119, v108
v_add_f32 v108, v108, v106
v_cvt_pk_bf16_f32 v173, v118, v119
v_cos_f32 v116, v108
v_sin_f32 v117, v108
v_add_f32 v108, v108, v106
v_cvt_pk_bf16_f32 v174, v116, v117
v_cos_f32 v118, v108
buffer_load_dwordx4 a[52:55], v88, s[16:19], s35 offen sc1
s_add_u32 s34, s34, s54
s_add_u32 s35, s35, s54
v_sin_f32 v119, v108
v_add_f32 v108, v108, v106
v_cvt_pk_bf16_f32 v175, v118, v119
v_fma_f32 v108, v106, 4.0, v108
v_cos_f32 v116, v107
v_sin_f32 v117, v107
v_add_f32 v107, v107, v105
v_cvt_pk_bf16_f32 v176, v116, v117
v_cos_f32 v118, v107
v_sin_f32 v119, v107
v_add_f32 v107, v107, v105
v_cvt_pk_bf16_f32 v177, v118, v119
v_cos_f32 v116, v107
s_add_u32 m0, s32, 28672
s_add_u32 s49, s52, 294912
buffer_load_dwordx4 v230, s[64:67], s49 offen lds
v_sin_f32 v117, v107
v_add_f32 v107, v107, v105
v_cvt_pk_bf16_f32 v178, v116, v117
v_cos_f32 v118, v107
v_sin_f32 v119, v107
v_add_f32 v107, v107, v105
v_cvt_pk_bf16_f32 v179, v118, v119
v_fma_f32 v107, v105, 4.0, v107
v_cos_f32 v116, v108
v_sin_f32 v117, v108
v_add_f32 v108, v108, v106
v_cvt_pk_bf16_f32 v180, v116, v117
buffer_load_dwordx4 v231, s[64:67], s49 offen offset:1024 lds
v_cos_f32 v118, v108
v_sin_f32 v119, v108
v_add_f32 v108, v108, v106
v_cvt_pk_bf16_f32 v181, v118, v119
v_cos_f32 v116, v108
v_sin_f32 v117, v108
v_add_f32 v108, v108, v106
v_cvt_pk_bf16_f32 v182, v116, v117
v_cos_f32 v118, v108
v_sin_f32 v119, v108
v_add_f32 v108, v108, v106
v_cvt_pk_bf16_f32 v183, v118, v119
v_fma_f32 v108, v106, 4.0, v108
s_add_u32 m0, s32, 30720
s_add_u32 s49, s52, 311296
buffer_load_dwordx4 v230, s[64:67], s49 offen lds
v_cos_f32 v116, v107
v_sin_f32 v117, v107
v_add_f32 v107, v107, v105
v_cvt_pk_bf16_f32 v184, v116, v117
v_cos_f32 v118, v107
v_sin_f32 v119, v107
v_add_f32 v107, v107, v105
v_cvt_pk_bf16_f32 v185, v118, v119
v_cos_f32 v116, v107
v_sin_f32 v117, v107
v_add_f32 v107, v107, v105
v_cvt_pk_bf16_f32 v186, v116, v117
v_cos_f32 v118, v107
buffer_load_dwordx4 v231, s[64:67], s49 offen offset:1024 lds
v_sin_f32 v119, v107
v_add_f32 v107, v107, v105
v_cvt_pk_bf16_f32 v187, v118, v119
v_fma_f32 v107, v105, 4.0, v107
v_cos_f32 v116, v108
v_sin_f32 v117, v108
v_add_f32 v108, v108, v106
v_cvt_pk_bf16_f32 v188, v116, v117
v_cos_f32 v118, v108
v_sin_f32 v119, v108
v_add_f32 v108, v108, v106
v_cvt_pk_bf16_f32 v189, v118, v119
v_cos_f32 v116, v108
s_waitcnt vmcnt(22)
s_barrier
s_lshl_b32 s60, s75, 2
s_add_u32 s60, s60, 14696448
s_cmp_lg_u32 s28, 0
s_cbranch_scc1 L_parallel_sum__spectral_gfnet__glu_gated_reglu__prompt_kernel_flag_47
v_mul_u32_u24 v13, 2048, v224
s_mov_b64 exec, 255
v_mov_b32 v12, 1
buffer_store_dword v12, v13, s[16:19], s60 offen sc1
s_mov_b64 exec, -1
L_parallel_sum__spectral_gfnet__glu_gated_reglu__prompt_kernel_flag_47:
s_and_b32 s41, s2, 7
s_lshl_b32 s41, s41, 11
s_add_u32 s41, s41, 14696448
s_lshl_b32 s40, s28, 8
s_add_u32 s40, s40, s41
s_add_u32 s41, s41, 0x400
s_cmp_eq_u32 s28, 0
s_cselect_b32 s41, s41, s40
v_lshlrev_b32 v112, 2, v224
v_mov_b32 v115, 0
ds_read_b64_tr_b16 v[144:145], v94 offset:0
ds_read_b64_tr_b16 v[146:147], v94 offset:1024
ds_read_b64_tr_b16 v[148:149], v95 offset:0
ds_read_b64_tr_b16 v[150:151], v95 offset:1024
s_waitcnt vmcnt(20)
s_waitcnt lgkmcnt(0)
v_mfma_f32_32x32x16_bf16 v[16:31], v[144:147], a[0:3], 0
buffer_load_dwordx4 a[56:59], v88, s[16:19], s34 offen sc1
ds_read_b64_tr_b16 v[152:153], v94 offset:2048
ds_read_b64_tr_b16 v[154:155], v94 offset:3072
v_sin_f32 v117, v108
v_add_f32 v108, v108, v106
v_mfma_f32_32x32x16_bf16 v[32:47], v[148:151], a[0:3], 0
buffer_load_dwordx4 a[60:63], v88, s[16:19], s35 offen sc1
s_add_u32 s34, s34, s54
s_add_u32 s35, s35, s54
ds_read_b64_tr_b16 v[156:157], v95 offset:2048
ds_read_b64_tr_b16 v[158:159], v95 offset:3072
v_mfma_f32_32x32x16_bf16 v[48:63], v[144:147], a[4:7], 0
buffer_load_dwordx4 a[64:67], v88, s[16:19], s34 offen sc1
v_cvt_pk_bf16_f32 v190, v116, v117
v_cos_f32 v118, v108
v_sin_f32 v119, v108
v_add_f32 v108, v108, v106
v_mfma_f32_32x32x16_bf16 v[64:79], v[148:151], a[4:7], 0
buffer_load_dwordx4 a[68:71], v88, s[16:19], s35 offen sc1
s_add_u32 s34, s34, s54
s_add_u32 s35, s35, s54
v_cvt_pk_bf16_f32 v191, v118, v119
s_waitcnt vmcnt(18)
s_waitcnt lgkmcnt(0)
v_mfma_f32_32x32x16_bf16 v[16:31], v[152:155], a[8:11], v[16:31]
buffer_load_dwordx4 a[72:75], v88, s[16:19], s34 offen sc1
ds_read_b64_tr_b16 v[144:145], v94 offset:4096
ds_read_b64_tr_b16 v[146:147], v94 offset:5120
v_mfma_f32_32x32x16_bf16 v[32:47], v[156:159], a[8:11], v[32:47]
ds_read_b64_tr_b16 v[148:149], v95 offset:4096
ds_read_b64_tr_b16 v[150:151], v95 offset:5120
v_fma_f32 v108, v106, 4.0, v108
v_cos_f32 v116, v107
v_sin_f32 v117, v107
v_add_f32 v107, v107, v105
v_mfma_f32_32x32x16_bf16 v[48:63], v[152:155], a[12:15], v[48:63]
buffer_load_dwordx4 a[76:79], v88, s[16:19], s35 offen sc1
s_add_u32 s34, s34, s54
s_add_u32 s35, s35, s54
v_mfma_f32_32x32x16_bf16 v[64:79], v[156:159], a[12:15], v[64:79]
v_cvt_pk_bf16_f32 v192, v116, v117
v_cos_f32 v118, v107
v_sin_f32 v119, v107
s_waitcnt vmcnt(18)
s_waitcnt lgkmcnt(0)
v_mfma_f32_32x32x16_bf16 v[16:31], v[144:147], a[16:19], v[16:31]
buffer_load_dwordx4 a[80:83], v88, s[16:19], s34 offen sc1
ds_read_b64_tr_b16 v[152:153], v94 offset:6144
ds_read_b64_tr_b16 v[154:155], v94 offset:7168
v_add_f32 v107, v107, v105
v_cvt_pk_bf16_f32 v193, v118, v119
v_mfma_f32_32x32x16_bf16 v[32:47], v[148:151], a[16:19], v[32:47]
buffer_load_dwordx4 a[84:87], v88, s[16:19], s35 offen sc1
s_add_u32 s34, s34, s54
s_add_u32 s35, s35, s54
ds_read_b64_tr_b16 v[156:157], v95 offset:6144
ds_read_b64_tr_b16 v[158:159], v95 offset:7168
v_mfma_f32_32x32x16_bf16 v[48:63], v[144:147], a[20:23], v[48:63]
s_add_u32 m0, s51, 0
s_add_u32 s49, s52, 327680
buffer_load_dwordx4 v230, s[64:67], s49 offen lds
v_cos_f32 v116, v107
v_sin_f32 v117, v107
v_mfma_f32_32x32x16_bf16 v[64:79], v[148:151], a[20:23], v[64:79]
buffer_load_dwordx4 v231, s[64:67], s49 offen offset:1024 lds
v_add_f32 v107, v107, v105
v_cvt_pk_bf16_f32 v194, v116, v117
v_cos_f32 v118, v107
s_waitcnt vmcnt(20)
s_waitcnt lgkmcnt(0)
v_mfma_f32_32x32x16_bf16 v[16:31], v[152:155], a[24:27], v[16:31]
buffer_load_dwordx4 a[88:91], v88, s[16:19], s34 offen sc1
ds_read_b64_tr_b16 v[144:145], v92 offset:0
ds_read_b64_tr_b16 v[146:147], v92 offset:1024
v_sin_f32 v119, v107
v_add_f32 v107, v107, v105
v_mfma_f32_32x32x16_bf16 v[32:47], v[156:159], a[24:27], v[32:47]
buffer_load_dwordx4 a[92:95], v88, s[16:19], s35 offen sc1
s_add_u32 s34, s34, s54
s_add_u32 s35, s35, s54
ds_read_b64_tr_b16 v[148:149], v93 offset:0
ds_read_b64_tr_b16 v[150:151], v93 offset:1024
v_mfma_f32_32x32x16_bf16 v[48:63], v[152:155], a[28:31], v[48:63]
s_add_u32 m0, s51, 2048
s_add_u32 s49, s52, 344064
buffer_load_dwordx4 v230, s[64:67], s49 offen lds
v_cvt_pk_bf16_f32 v195, v118, v119
v_fma_f32 v107, v105, 4.0, v107
v_mfma_f32_32x32x16_bf16 v[64:79], v[156:159], a[28:31], v[64:79]
buffer_load_dwordx4 v231, s[64:67], s49 offen offset:1024 lds
v_cos_f32 v116, v108
v_sin_f32 v117, v108
v_add_f32 v108, v108, v106
s_waitcnt vmcnt(22)
s_waitcnt lgkmcnt(0)
v_mfma_f32_32x32x16_bf16 v[16:31], v[144:147], a[32:35], v[16:31]
buffer_load_dwordx4 a[96:99], v88, s[16:19], s34 offen sc1
ds_read_b64_tr_b16 v[152:153], v92 offset:2048
ds_read_b64_tr_b16 v[154:155], v92 offset:3072
v_mfma_f32_32x32x16_bf16 v[32:47], v[148:151], a[32:35], v[32:47]
ds_read_b64_tr_b16 v[156:157], v93 offset:2048
ds_read_b64_tr_b16 v[158:159], v93 offset:3072
v_cvt_pk_bf16_f32 v196, v116, v117
v_cos_f32 v118, v108
v_sin_f32 v119, v108
v_add_f32 v108, v108, v106
v_mfma_f32_32x32x16_bf16 v[48:63], v[144:147], a[36:39], v[48:63]
buffer_load_dwordx4 a[100:103], v88, s[16:19], s35 offen sc1
s_add_u32 s34, s34, s54
s_add_u32 s35, s35, s54
v_mfma_f32_32x32x16_bf16 v[64:79], v[148:151], a[36:39], v[64:79]
v_cvt_pk_bf16_f32 v197, v118, v119
v_cos_f32 v116, v108
v_sin_f32 v117, v108
s_waitcnt vmcnt(22)
s_waitcnt lgkmcnt(0)
v_mfma_f32_32x32x16_bf16 v[16:31], v[152:155], a[40:43], v[16:31]
buffer_load_dwordx4 a[104:107], v88, s[16:19], s34 offen sc1
ds_read_b64_tr_b16 v[144:145], v92 offset:4096
ds_read_b64_tr_b16 v[146:147], v92 offset:5120
v_mfma_f32_32x32x16_bf16 v[32:47], v[156:159], a[40:43], v[32:47]
ds_read_b64_tr_b16 v[148:149], v93 offset:4096
ds_read_b64_tr_b16 v[150:151], v93 offset:5120
v_add_f32 v108, v108, v106
v_cvt_pk_bf16_f32 v198, v116, v117
v_cos_f32 v118, v108
v_sin_f32 v119, v108
v_mfma_f32_32x32x16_bf16 v[48:63], v[152:155], a[44:47], v[48:63]
buffer_load_dwordx4 a[108:111], v88, s[16:19], s35 offen sc1
s_add_u32 s34, s34, s54
s_add_u32 s35, s35, s54
v_mfma_f32_32x32x16_bf16 v[64:79], v[156:159], a[44:47], v[64:79]
v_add_f32 v108, v108, v106
v_cvt_pk_bf16_f32 v199, v118, v119
v_fma_f32 v108, v106, 4.0, v108
s_waitcnt vmcnt(22)
s_waitcnt lgkmcnt(0)
v_mfma_f32_32x32x16_bf16 v[16:31], v[144:147], a[48:51], v[16:31]
buffer_load_dwordx4 a[112:115], v88, s[16:19], s34 offen sc1
ds_read_b64_tr_b16 v[152:153], v92 offset:6144
ds_read_b64_tr_b16 v[154:155], v92 offset:7168
v_mfma_f32_32x32x16_bf16 v[32:47], v[148:151], a[48:51], v[32:47]
ds_read_b64_tr_b16 v[156:157], v93 offset:6144
ds_read_b64_tr_b16 v[158:159], v93 offset:7168
v_cos_f32 v116, v107
v_sin_f32 v117, v107
v_add_f32 v107, v107, v105
v_cvt_pk_bf16_f32 v200, v116, v117
v_mfma_f32_32x32x16_bf16 v[48:63], v[144:147], a[52:55], v[48:63]
buffer_load_dwordx4 a[116:119], v88, s[16:19], s35 offen sc1
s_add_u32 s34, s34, s54
s_add_u32 s35, s35, s54
v_mfma_f32_32x32x16_bf16 v[64:79], v[148:151], a[52:55], v[64:79]
v_cos_f32 v118, v107
v_sin_f32 v119, v107
v_add_f32 v107, v107, v105
s_waitcnt vmcnt(18)
s_waitcnt lgkmcnt(0)
v_mfma_f32_32x32x16_bf16 v[16:31], v[152:155], a[56:59], v[16:31]
buffer_load_dwordx4 a[120:123], v88, s[16:19], s34 offen sc1
ds_read_b64_tr_b16 v[144:145], v92 offset:8192
ds_read_b64_tr_b16 v[146:147], v92 offset:9216
v_mfma_f32_32x32x16_bf16 v[32:47], v[156:159], a[56:59], v[32:47]
ds_read_b64_tr_b16 v[148:149], v93 offset:8192
ds_read_b64_tr_b16 v[150:151], v93 offset:9216
v_cvt_pk_bf16_f32 v201, v118, v119
v_cos_f32 v116, v107
v_sin_f32 v117, v107
v_add_f32 v107, v107, v105
v_mfma_f32_32x32x16_bf16 v[48:63], v[152:155], a[60:63], v[48:63]
buffer_load_dwordx4 a[124:127], v88, s[16:19], s35 offen sc1
s_add_u32 s34, s34, s54
s_add_u32 s35, s35, s54
v_mfma_f32_32x32x16_bf16 v[64:79], v[156:159], a[60:63], v[64:79]
v_cvt_pk_bf16_f32 v202, v116, v117
v_cos_f32 v118, v107
v_sin_f32 v119, v107
s_waitcnt vmcnt(18)
s_waitcnt lgkmcnt(0)
v_mfma_f32_32x32x16_bf16 v[16:31], v[144:147], a[64:67], v[16:31]
buffer_load_dwordx4 a[128:131], v88, s[16:19], s34 offen sc1
ds_read_b64_tr_b16 v[152:153], v92 offset:10240
ds_read_b64_tr_b16 v[154:155], v92 offset:11264
v_mfma_f32_32x32x16_bf16 v[32:47], v[148:151], a[64:67], v[32:47]
ds_read_b64_tr_b16 v[156:157], v93 offset:10240
ds_read_b64_tr_b16 v[158:159], v93 offset:11264
v_add_f32 v107, v107, v105
v_cvt_pk_bf16_f32 v203, v118, v119
v_fma_f32 v107, v105, 4.0, v107
v_cos_f32 v116, v108
v_mfma_f32_32x32x16_bf16 v[48:63], v[144:147], a[68:71], v[48:63]
buffer_load_dwordx4 a[132:135], v88, s[16:19], s35 offen sc1
s_add_u32 s34, s34, s54
s_add_u32 s35, s35, s54
v_mfma_f32_32x32x16_bf16 v[64:79], v[148:151], a[68:71], v[64:79]
v_sin_f32 v117, v108
v_add_f32 v108, v108, v106
v_cvt_pk_bf16_f32 v204, v116, v117
s_waitcnt vmcnt(18)
s_waitcnt lgkmcnt(0)
v_mfma_f32_32x32x16_bf16 v[16:31], v[152:155], a[72:75], v[16:31]
buffer_load_dwordx4 a[136:139], v88, s[16:19], s34 offen sc1
ds_read_b64_tr_b16 v[144:145], v92 offset:12288
ds_read_b64_tr_b16 v[146:147], v92 offset:13312
v_cos_f32 v118, v108
v_mfma_f32_32x32x16_bf16 v[32:47], v[156:159], a[72:75], v[32:47]
buffer_load_dwordx4 a[140:143], v88, s[16:19], s35 offen sc1
s_add_u32 s34, s34, s54
s_add_u32 s35, s35, s54
ds_read_b64_tr_b16 v[148:149], v93 offset:12288
ds_read_b64_tr_b16 v[150:151], v93 offset:13312
v_mfma_f32_32x32x16_bf16 v[48:63], v[152:155], a[76:79], v[48:63]
buffer_load_dword v113, v112, s[16:19], s40 offen sc1
v_sin_f32 v119, v108
v_add_f32 v108, v108, v106
v_cvt_pk_bf16_f32 v205, v118, v119
v_mfma_f32_32x32x16_bf16 v[64:79], v[156:159], a[76:79], v[64:79]
buffer_load_dword v114, v115, s[16:19], s41 offen sc1
v_cos_f32 v116, v108
v_sin_f32 v117, v108
v_add_f32 v108, v108, v106
s_waitcnt vmcnt(20)
s_waitcnt lgkmcnt(0)
v_mfma_f32_32x32x16_bf16 v[16:31], v[144:147], a[80:83], v[16:31]
buffer_load_dwordx4 a[144:147], v88, s[16:19], s34 offen sc1
ds_read_b64_tr_b16 v[152:153], v92 offset:14336
ds_read_b64_tr_b16 v[154:155], v92 offset:15360
v_mfma_f32_32x32x16_bf16 v[32:47], v[148:151], a[80:83], v[32:47]
ds_read_b64_tr_b16 v[156:157], v93 offset:14336
ds_read_b64_tr_b16 v[158:159], v93 offset:15360
v_cvt_pk_bf16_f32 v206, v116, v117
v_cos_f32 v118, v108
v_sin_f32 v119, v108
v_add_f32 v108, v108, v106
v_mfma_f32_32x32x16_bf16 v[48:63], v[144:147], a[84:87], v[48:63]
buffer_load_dwordx4 a[148:151], v88, s[16:19], s35 offen sc1
s_add_u32 s34, s34, s54
s_add_u32 s35, s35, s54
v_mfma_f32_32x32x16_bf16 v[64:79], v[148:151], a[84:87], v[64:79]
v_cvt_pk_bf16_f32 v207, v118, v119
v_fma_f32 v108, v106, 4.0, v108
v_cos_f32 v116, v107
s_waitcnt vmcnt(18)
s_waitcnt lgkmcnt(0)
v_mfma_f32_32x32x16_bf16 v[16:31], v[152:155], a[88:91], v[16:31]
buffer_load_dwordx4 a[152:155], v88, s[16:19], s34 offen sc1
ds_read_b64_tr_b16 v[144:145], v92 offset:16384
ds_read_b64_tr_b16 v[146:147], v92 offset:17408
v_mfma_f32_32x32x16_bf16 v[32:47], v[156:159], a[88:91], v[32:47]
ds_read_b64_tr_b16 v[148:149], v93 offset:16384
ds_read_b64_tr_b16 v[150:151], v93 offset:17408
v_sin_f32 v117, v107
v_add_f32 v107, v107, v105
v_cvt_pk_bf16_f32 v208, v116, v117
v_cos_f32 v118, v107
v_mfma_f32_32x32x16_bf16 v[48:63], v[152:155], a[92:95], v[48:63]
buffer_load_dwordx4 a[156:159], v88, s[16:19], s35 offen sc1
s_add_u32 s34, s34, s54
s_add_u32 s35, s35, s54
v_mfma_f32_32x32x16_bf16 v[64:79], v[156:159], a[92:95], v[64:79]
v_sin_f32 v119, v107
v_add_f32 v107, v107, v105
v_cvt_pk_bf16_f32 v209, v118, v119
s_waitcnt vmcnt(16)
s_waitcnt lgkmcnt(0)
v_mfma_f32_32x32x16_bf16 v[16:31], v[144:147], a[96:99], v[16:31]
s_min_u32 s34, s34, s36
s_min_u32 s35, s35, s37
buffer_load_dwordx4 a[160:163], v88, s[16:19], s34 offen sc1
ds_read_b64_tr_b16 v[152:153], v92 offset:18432
ds_read_b64_tr_b16 v[154:155], v92 offset:19456
v_mfma_f32_32x32x16_bf16 v[32:47], v[148:151], a[96:99], v[32:47]
ds_read_b64_tr_b16 v[156:157], v93 offset:18432
ds_read_b64_tr_b16 v[158:159], v93 offset:19456
v_cos_f32 v116, v107
v_sin_f32 v117, v107
v_add_f32 v107, v107, v105
v_cvt_pk_bf16_f32 v210, v116, v117
v_cos_f32 v118, v107
v_mfma_f32_32x32x16_bf16 v[48:63], v[144:147], a[100:103], v[48:63]
buffer_load_dwordx4 a[164:167], v88, s[16:19], s35 offen sc1
s_add_u32 s34, s34, s54
s_add_u32 s35, s35, s54
v_mfma_f32_32x32x16_bf16 v[64:79], v[148:151], a[100:103], v[64:79]
v_sin_f32 v119, v107
v_add_f32 v107, v107, v105
s_waitcnt vmcnt(6)
v_and_b32 v113, v113, v114
v_cmp_eq_u32 vcc, 1, v113
s_nop 4
s_cmp_eq_u64 vcc, exec
s_cbranch_scc1 L_parallel_sum__spectral_gfnet__glu_gated_reglu__prompt_kernel_tpollok_48
s_mov_b32 s56, 0
L_parallel_sum__spectral_gfnet__glu_gated_reglu__prompt_kernel_tpoll_49:
buffer_load_dword v113, v112, s[16:19], s40 offen sc1
buffer_load_dword v114, v115, s[16:19], s41 offen sc1
s_waitcnt vmcnt(0)
v_and_b32 v113, v113, v114
v_cmp_eq_u32 vcc, 1, v113
s_nop 4
s_cmp_eq_u64 vcc, exec
s_cbranch_scc1 L_parallel_sum__spectral_gfnet__glu_gated_reglu__prompt_kernel_tpolld_50
s_add_u32 s56, s56, 1
s_cmp_gt_u32 s56, 40000
s_cbranch_scc1 L_parallel_sum__spectral_gfnet__glu_gated_reglu__prompt_kernel_tpolld_50
s_sleep 4
s_branch L_parallel_sum__spectral_gfnet__glu_gated_reglu__prompt_kernel_tpoll_49
L_parallel_sum__spectral_gfnet__glu_gated_reglu__prompt_kernel_tpolld_50:
L_parallel_sum__spectral_gfnet__glu_gated_reglu__prompt_kernel_tpollok_48:
s_waitcnt lgkmcnt(0)
v_mfma_f32_32x32x16_bf16 v[16:31], v[152:155], a[104:107], v[16:31]
s_min_u32 s34, s34, s36
s_min_u32 s35, s35, s37
buffer_load_dwordx4 a[168:171], v88, s[16:19], s34 offen sc1
ds_read_b64_tr_b16 v[144:145], v92 offset:20480
ds_read_b64_tr_b16 v[146:147], v92 offset:21504
v_mfma_f32_32x32x16_bf16 v[32:47], v[156:159], a[104:107], v[32:47]
buffer_load_dwordx4 a[172:175], v88, s[16:19], s35 offen sc1
s_add_u32 s34, s34, s54
s_add_u32 s35, s35, s54
ds_read_b64_tr_b16 v[148:149], v93 offset:20480
ds_read_b64_tr_b16 v[150:151], v93 offset:21504
v_mfma_f32_32x32x16_bf16 v[48:63], v[152:155], a[108:111], v[48:63]
s_add_u32 m0, s51, 4096
s_add_u32 s60, s38, 0
buffer_load_dwordx4 v89, s[16:19], s60 offen sc1 lds
v_cvt_pk_bf16_f32 v211, v118, v119
v_fma_f32 v107, v105, 4.0, v107
v_mfma_f32_32x32x16_bf16 v[64:79], v[156:159], a[108:111], v[64:79]
buffer_load_dwordx4 v90, s[16:19], s60 offen offset:1024 sc1 lds
v_cos_f32 v116, v108
v_sin_f32 v117, v108
v_add_f32 v108, v108, v106
v_cvt_pk_bf16_f32 v212, v116, v117
v_cos_f32 v118, v108
s_waitcnt lgkmcnt(0)
v_mfma_f32_32x32x16_bf16 v[16:31], v[144:147], a[112:115], v[16:31]
s_add_u32 m0, s51, 6144
s_add_u32 s60, s38, 65536
buffer_load_dwordx4 v89, s[16:19], s60 offen sc1 lds
ds_read_b64_tr_b16 v[152:153], v92 offset:22528
ds_read_b64_tr_b16 v[154:155], v92 offset:23552
v_mfma_f32_32x32x16_bf16 v[32:47], v[148:151], a[112:115], v[32:47]
ds_read_b64_tr_b16 v[156:157], v93 offset:22528
ds_read_b64_tr_b16 v[158:159], v93 offset:23552
v_sin_f32 v119, v108
v_add_f32 v108, v108, v106
v_cvt_pk_bf16_f32 v213, v118, v119
v_cos_f32 v116, v108
v_mfma_f32_32x32x16_bf16 v[48:63], v[144:147], a[116:119], v[48:63]
buffer_load_dwordx4 v90, s[16:19], s60 offen offset:1024 sc1 lds
v_mfma_f32_32x32x16_bf16 v[64:79], v[148:151], a[116:119], v[64:79]
v_sin_f32 v117, v108
v_add_f32 v108, v108, v106
v_cvt_pk_bf16_f32 v214, v116, v117
s_waitcnt lgkmcnt(0)
v_mfma_f32_32x32x16_bf16 v[16:31], v[152:155], a[120:123], v[16:31]
s_add_u32 m0, s32, 0
s_add_u32 s60, s38, 131072
buffer_load_dwordx4 v89, s[16:19], s60 offen sc1 lds
ds_read_b64_tr_b16 v[144:145], v92 offset:24576
ds_read_b64_tr_b16 v[146:147], v92 offset:25600
v_mfma_f32_32x32x16_bf16 v[32:47], v[156:159], a[120:123], v[32:47]
buffer_load_dwordx4 v90, s[16:19], s60 offen offset:1024 sc1 lds
ds_read_b64_tr_b16 v[148:149], v93 offset:24576
ds_read_b64_tr_b16 v[150:151], v93 offset:25600
v_cos_f32 v118, v108
v_sin_f32 v119, v108
v_mfma_f32_32x32x16_bf16 v[48:63], v[152:155], a[124:127], v[48:63]
s_add_u32 m0, s32, 2048
s_add_u32 s60, s38, 196608
buffer_load_dwordx4 v89, s[16:19], s60 offen sc1 lds
v_add_f32 v108, v108, v106
v_cvt_pk_bf16_f32 v215, v118, v119
v_mfma_f32_32x32x16_bf16 v[64:79], v[156:159], a[124:127], v[64:79]
buffer_load_dwordx4 v90, s[16:19], s60 offen offset:1024 sc1 lds
v_fma_f32 v108, v106, 4.0, v108
v_cos_f32 v116, v107
v_sin_f32 v117, v107
s_waitcnt lgkmcnt(0)
v_mfma_f32_32x32x16_bf16 v[16:31], v[144:147], a[128:131], v[16:31]
s_add_u32 m0, s32, 4096
s_add_u32 s60, s38, 262144
buffer_load_dwordx4 v89, s[16:19], s60 offen sc1 lds
ds_read_b64_tr_b16 v[152:153], v92 offset:26624
ds_read_b64_tr_b16 v[154:155], v92 offset:27648
v_mfma_f32_32x32x16_bf16 v[32:47], v[148:151], a[128:131], v[32:47]
buffer_load_dwordx4 v90, s[16:19], s60 offen offset:1024 sc1 lds
ds_read_b64_tr_b16 v[156:157], v93 offset:26624
ds_read_b64_tr_b16 v[158:159], v93 offset:27648
v_add_f32 v107, v107, v105
v_cvt_pk_bf16_f32 v216, v116, v117
v_mfma_f32_32x32x16_bf16 v[48:63], v[144:147], a[132:135], v[48:63]
s_add_u32 m0, s32, 6144
s_add_u32 s60, s38, 327680
buffer_load_dwordx4 v89, s[16:19], s60 offen sc1 lds
v_cos_f32 v118, v107
v_sin_f32 v119, v107
v_mfma_f32_32x32x16_bf16 v[64:79], v[148:151], a[132:135], v[64:79]
buffer_load_dwordx4 v90, s[16:19], s60 offen offset:1024 sc1 lds
v_add_f32 v107, v107, v105
v_cvt_pk_bf16_f32 v217, v118, v119
v_cos_f32 v116, v107
s_waitcnt lgkmcnt(0)
v_mfma_f32_32x32x16_bf16 v[16:31], v[152:155], a[136:139], v[16:31]
s_add_u32 m0, s32, 8192
s_add_u32 s60, s38, 393216
buffer_load_dwordx4 v89, s[16:19], s60 offen sc1 lds
ds_read_b64_tr_b16 v[144:145], v92 offset:28672
ds_read_b64_tr_b16 v[146:147], v92 offset:29696
v_mfma_f32_32x32x16_bf16 v[32:47], v[156:159], a[136:139], v[32:47]
buffer_load_dwordx4 v90, s[16:19], s60 offen offset:1024 sc1 lds
ds_read_b64_tr_b16 v[148:149], v93 offset:28672
ds_read_b64_tr_b16 v[150:151], v93 offset:29696
v_sin_f32 v117, v107
v_add_f32 v107, v107, v105
v_mfma_f32_32x32x16_bf16 v[48:63], v[152:155], a[140:143], v[48:63]
s_add_u32 m0, s32, 10240
s_add_u32 s60, s38, 458752
buffer_load_dwordx4 v89, s[16:19], s60 offen sc1 lds
v_cvt_pk_bf16_f32 v218, v116, v117
v_cos_f32 v118, v107
v_mfma_f32_32x32x16_bf16 v[64:79], v[156:159], a[140:143], v[64:79]
buffer_load_dwordx4 v90, s[16:19], s60 offen offset:1024 sc1 lds
v_sin_f32 v119, v107
v_add_f32 v107, v107, v105
v_cvt_pk_bf16_f32 v219, v118, v119
s_waitcnt vmcnt(22)
s_waitcnt lgkmcnt(0)
v_mfma_f32_32x32x16_bf16 v[16:31], v[144:147], a[144:147], v[16:31]
ds_read_b64_tr_b16 v[152:153], v92 offset:30720
ds_read_b64_tr_b16 v[154:155], v92 offset:31744
v_cos_f32 v116, v108
v_sin_f32 v117, v108
v_add_f32 v108, v108, v106
v_cvt_pk_bf16_f32 v220, v116, v117
v_mfma_f32_32x32x16_bf16 v[32:47], v[148:151], a[144:147], v[32:47]
ds_read_b64_tr_b16 v[156:157], v93 offset:30720
ds_read_b64_tr_b16 v[158:159], v93 offset:31744
v_cos_f32 v118, v108
v_sin_f32 v119, v108
v_add_f32 v108, v108, v106
v_mfma_f32_32x32x16_bf16 v[48:63], v[144:147], a[148:151], v[48:63]
v_mfma_f32_32x32x16_bf16 v[64:79], v[148:151], a[148:151], v[64:79]
s_waitcnt vmcnt(20)
s_waitcnt lgkmcnt(0)
v_mfma_f32_32x32x16_bf16 v[16:31], v[152:155], a[152:155], v[16:31]
ds_read_b64_tr_b16 v[144:145], v94 offset:0
ds_read_b64_tr_b16 v[146:147], v94 offset:1024
v_cvt_pk_bf16_f32 v221, v118, v119
v_cos_f32 v116, v108
v_sin_f32 v117, v108
v_add_f32 v108, v108, v106
v_mfma_f32_32x32x16_bf16 v[32:47], v[156:159], a[152:155], v[32:47]
ds_read_b64_tr_b16 v[148:149], v95 offset:0
ds_read_b64_tr_b16 v[150:151], v95 offset:1024
v_cvt_pk_bf16_f32 v222, v116, v117
v_cos_f32 v118, v108
v_sin_f32 v119, v108
v_mfma_f32_32x32x16_bf16 v[48:63], v[152:155], a[156:159], v[48:63]
v_mfma_f32_32x32x16_bf16 v[64:79], v[156:159], a[156:159], v[64:79]
s_waitcnt vmcnt(18)
s_waitcnt lgkmcnt(0)
v_mfma_f32_32x32x16_bf16 v[16:31], v[144:147], a[160:163], v[16:31]
ds_read_b64_tr_b16 v[152:153], v94 offset:2048
ds_read_b64_tr_b16 v[154:155], v94 offset:3072
v_add_f32 v108, v108, v106
v_cvt_pk_bf16_f32 v223, v118, v119
v_mfma_f32_32x32x16_bf16 v[32:47], v[148:151], a[160:163], v[32:47]
ds_read_b64_tr_b16 v[156:157], v95 offset:2048
ds_read_b64_tr_b16 v[158:159], v95 offset:3072
v_mfma_f32_32x32x16_bf16 v[48:63], v[144:147], a[164:167], v[48:63]
v_mfma_f32_32x32x16_bf16 v[64:79], v[148:151], a[164:167], v[64:79]
s_waitcnt vmcnt(14)
s_waitcnt lgkmcnt(0)
v_mfma_f32_32x32x16_bf16 v[16:31], v[152:155], a[168:171], v[16:31]
ds_read_b64_tr_b16 v[144:145], v98 offset:4096
ds_read_b64_tr_b16 v[146:147], v98 offset:4608
v_mfma_f32_32x32x16_bf16 v[32:47], v[156:159], a[168:171], v[32:47]
ds_read_b64_tr_b16 v[148:149], v99 offset:4096
ds_read_b64_tr_b16 v[150:151], v99 offset:4608
v_mfma_f32_32x32x16_bf16 v[48:63], v[152:155], a[172:175], v[48:63]
v_mfma_f32_32x32x16_bf16 v[64:79], v[156:159], a[172:175], v[64:79]
s_waitcnt vmcnt(12)
s_waitcnt lgkmcnt(0)
v_mfma_f32_32x32x16_bf16 v[16:31], v[160:163], v[144:147], v[16:31]
ds_read_b64_tr_b16 v[152:153], v98 offset:6144
ds_read_b64_tr_b16 v[154:155], v98 offset:6656
v_mfma_f32_32x32x16_bf16 v[32:47], v[164:167], v[144:147], v[32:47]
ds_read_b64_tr_b16 v[156:157], v99 offset:6144
ds_read_b64_tr_b16 v[158:159], v99 offset:6656
v_mfma_f32_32x32x16_bf16 v[48:63], v[160:163], v[148:151], v[48:63]
v_mfma_f32_32x32x16_bf16 v[64:79], v[164:167], v[148:151], v[64:79]
s_waitcnt vmcnt(10)
s_waitcnt lgkmcnt(0)
v_mfma_f32_32x32x16_bf16 v[16:31], v[168:171], v[152:155], v[16:31]
ds_read_b64_tr_b16 v[144:145], v96 offset:0
ds_read_b64_tr_b16 v[146:147], v96 offset:512
v_mfma_f32_32x32x16_bf16 v[32:47], v[172:175], v[152:155], v[32:47]
ds_read_b64_tr_b16 v[148:149], v97 offset:0
ds_read_b64_tr_b16 v[150:151], v97 offset:512
v_mfma_f32_32x32x16_bf16 v[48:63], v[168:171], v[156:159], v[48:63]
v_mfma_f32_32x32x16_bf16 v[64:79], v[172:175], v[156:159], v[64:79]
s_waitcnt vmcnt(8)
s_waitcnt lgkmcnt(0)
v_mfma_f32_32x32x16_bf16 v[16:31], v[176:179], v[144:147], v[16:31]
ds_read_b64_tr_b16 v[152:153], v96 offset:2048
ds_read_b64_tr_b16 v[154:155], v96 offset:2560
v_mfma_f32_32x32x16_bf16 v[32:47], v[180:183], v[144:147], v[32:47]
ds_read_b64_tr_b16 v[156:157], v97 offset:2048
ds_read_b64_tr_b16 v[158:159], v97 offset:2560
v_mfma_f32_32x32x16_bf16 v[48:63], v[176:179], v[148:151], v[48:63]
v_mfma_f32_32x32x16_bf16 v[64:79], v[180:183], v[148:151], v[64:79]
s_waitcnt vmcnt(6)
s_waitcnt lgkmcnt(0)
v_mfma_f32_32x32x16_bf16 v[16:31], v[184:187], v[152:155], v[16:31]
ds_read_b64_tr_b16 v[144:145], v96 offset:4096
ds_read_b64_tr_b16 v[146:147], v96 offset:4608
v_mfma_f32_32x32x16_bf16 v[32:47], v[188:191], v[152:155], v[32:47]
ds_read_b64_tr_b16 v[148:149], v97 offset:4096
ds_read_b64_tr_b16 v[150:151], v97 offset:4608
v_mfma_f32_32x32x16_bf16 v[48:63], v[184:187], v[156:159], v[48:63]
v_mfma_f32_32x32x16_bf16 v[64:79], v[188:191], v[156:159], v[64:79]
s_waitcnt vmcnt(4)
s_waitcnt lgkmcnt(0)
v_mfma_f32_32x32x16_bf16 v[16:31], v[192:195], v[144:147], v[16:31]
ds_read_b64_tr_b16 v[152:153], v96 offset:6144
ds_read_b64_tr_b16 v[154:155], v96 offset:6656
v_mfma_f32_32x32x16_bf16 v[32:47], v[196:199], v[144:147], v[32:47]
ds_read_b64_tr_b16 v[156:157], v97 offset:6144
ds_read_b64_tr_b16 v[158:159], v97 offset:6656
v_mfma_f32_32x32x16_bf16 v[48:63], v[192:195], v[148:151], v[48:63]
v_mfma_f32_32x32x16_bf16 v[64:79], v[196:199], v[148:151], v[64:79]
s_waitcnt vmcnt(2)
s_waitcnt lgkmcnt(0)
v_mfma_f32_32x32x16_bf16 v[16:31], v[200:203], v[152:155], v[16:31]
ds_read_b64_tr_b16 v[144:145], v96 offset:8192
ds_read_b64_tr_b16 v[146:147], v96 offset:8704
v_mfma_f32_32x32x16_bf16 v[32:47], v[204:207], v[152:155], v[32:47]
ds_read_b64_tr_b16 v[148:149], v97 offset:8192
ds_read_b64_tr_b16 v[150:151], v97 offset:8704
v_mfma_f32_32x32x16_bf16 v[48:63], v[200:203], v[156:159], v[48:63]
v_mfma_f32_32x32x16_bf16 v[64:79], v[204:207], v[156:159], v[64:79]
s_waitcnt vmcnt(0)
s_waitcnt lgkmcnt(0)
v_mfma_f32_32x32x16_bf16 v[16:31], v[208:211], v[144:147], v[16:31]
ds_read_b64_tr_b16 v[152:153], v96 offset:10240
ds_read_b64_tr_b16 v[154:155], v96 offset:10752
v_mfma_f32_32x32x16_bf16 v[32:47], v[212:215], v[144:147], v[32:47]
ds_read_b64_tr_b16 v[156:157], v97 offset:10240
ds_read_b64_tr_b16 v[158:159], v97 offset:10752
v_mfma_f32_32x32x16_bf16 v[48:63], v[208:211], v[148:151], v[48:63]
v_mfma_f32_32x32x16_bf16 v[64:79], v[212:215], v[148:151], v[64:79]
s_waitcnt lgkmcnt(0)
v_mfma_f32_32x32x16_bf16 v[16:31], v[216:219], v[152:155], v[16:31]
v_mfma_f32_32x32x16_bf16 v[32:47], v[220:223], v[152:155], v[32:47]
v_mfma_f32_32x32x16_bf16 v[48:63], v[216:219], v[156:159], v[48:63]
v_mfma_f32_32x32x16_bf16 v[64:79], v[220:223], v[156:159], v[64:79]
s_nop 9
ds_write_b128 v101, v[32:35] offset:0
ds_write_b128 v101, v[36:39] offset:1024
ds_write_b128 v101, v[40:43] offset:2048
ds_write_b128 v101, v[44:47] offset:3072
ds_write_b128 v101, v[48:51] offset:4096
ds_write_b128 v101, v[52:55] offset:5120
ds_write_b128 v101, v[56:59] offset:6144
ds_write_b128 v101, v[60:63] offset:7168
ds_write_b128 v101, v[64:67] offset:8192
ds_write_b128 v101, v[68:71] offset:9216
ds_write_b128 v101, v[72:75] offset:10240
ds_write_b128 v101, v[76:79] offset:11264
v_lshlrev_b32 v112, 16, v80
v_and_b32 v113, s57, v80
v_add_f32 v16, v16, v112
v_add_f32 v17, v17, v113
v_lshlrev_b32 v112, 16, v81
v_and_b32 v113, s57, v81
v_add_f32 v18, v18, v112
v_add_f32 v19, v19, v113
v_lshlrev_b32 v112, 16, v82
v_and_b32 v113, s57, v82
v_add_f32 v20, v20, v112
v_add_f32 v21, v21, v113
v_lshlrev_b32 v112, 16, v83
v_and_b32 v113, s57, v83
v_add_f32 v22, v22, v112
v_add_f32 v23, v23, v113
v_lshlrev_b32 v112, 16, v84
v_and_b32 v113, s57, v84
v_add_f32 v24, v24, v112
v_add_f32 v25, v25, v113
v_lshlrev_b32 v112, 16, v85
v_and_b32 v113, s57, v85
v_add_f32 v26, v26, v112
v_add_f32 v27, v27, v113
v_lshlrev_b32 v112, 16, v86
v_and_b32 v113, s57, v86
v_add_f32 v28, v28, v112
v_add_f32 v29, v29, v113
v_lshlrev_b32 v112, 16, v87
v_and_b32 v113, s57, v87
v_add_f32 v30, v30, v112
v_add_f32 v31, v31, v113
s_waitcnt lgkmcnt(0)
s_barrier
ds_read_b128 v[160:163], v102 offset:0
ds_read_b128 v[164:167], v102 offset:1024
ds_read_b128 v[168:171], v102 offset:2048
ds_read_b128 v[172:175], v102 offset:3072
ds_read_b128 v[176:179], v103 offset:0
ds_read_b128 v[180:183], v103 offset:1024
ds_read_b128 v[184:187], v103 offset:2048
ds_read_b128 v[188:191], v103 offset:3072
ds_read_b128 v[192:195], v104 offset:0
ds_read_b128 v[196:199], v104 offset:1024
ds_read_b128 v[200:203], v104 offset:2048
ds_read_b128 v[204:207], v104 offset:3072
s_waitcnt lgkmcnt(11)
v_pk_add_f32 v[16:17], v[16:17], v[160:161]
v_pk_add_f32 v[18:19], v[18:19], v[162:163]
s_waitcnt lgkmcnt(10)
v_pk_add_f32 v[20:21], v[20:21], v[164:165]
v_pk_add_f32 v[22:23], v[22:23], v[166:167]
s_waitcnt lgkmcnt(9)
v_pk_add_f32 v[24:25], v[24:25], v[168:169]
v_pk_add_f32 v[26:27], v[26:27], v[170:171]
s_waitcnt lgkmcnt(8)
v_pk_add_f32 v[28:29], v[28:29], v[172:173]
v_pk_add_f32 v[30:31], v[30:31], v[174:175]
s_waitcnt lgkmcnt(7)
v_pk_add_f32 v[16:17], v[16:17], v[176:177]
v_pk_add_f32 v[18:19], v[18:19], v[178:179]
s_waitcnt lgkmcnt(6)
v_pk_add_f32 v[20:21], v[20:21], v[180:181]
v_pk_add_f32 v[22:23], v[22:23], v[182:183]
s_waitcnt lgkmcnt(5)
v_pk_add_f32 v[24:25], v[24:25], v[184:185]
v_pk_add_f32 v[26:27], v[26:27], v[186:187]
s_waitcnt lgkmcnt(4)
v_pk_add_f32 v[28:29], v[28:29], v[188:189]
v_pk_add_f32 v[30:31], v[30:31], v[190:191]
s_waitcnt lgkmcnt(3)
v_pk_add_f32 v[16:17], v[16:17], v[192:193]
v_pk_add_f32 v[18:19], v[18:19], v[194:195]
s_waitcnt lgkmcnt(2)
v_pk_add_f32 v[20:21], v[20:21], v[196:197]
v_pk_add_f32 v[22:23], v[22:23], v[198:199]
s_waitcnt lgkmcnt(1)
v_pk_add_f32 v[24:25], v[24:25], v[200:201]
v_pk_add_f32 v[26:27], v[26:27], v[202:203]
s_waitcnt lgkmcnt(0)
v_pk_add_f32 v[28:29], v[28:29], v[204:205]
v_pk_add_f32 v[30:31], v[30:31], v[206:207]
v_cvt_pk_bf16_f32 v144, v16, v17
v_cvt_pk_bf16_f32 v145, v18, v19
v_cvt_pk_bf16_f32 v146, v20, v21
v_cvt_pk_bf16_f32 v147, v22, v23
v_cvt_pk_bf16_f32 v148, v24, v25
v_cvt_pk_bf16_f32 v149, v26, v27
v_cvt_pk_bf16_f32 v150, v28, v29
v_cvt_pk_bf16_f32 v151, v30, v31
v_permlane32_swap_b32 v144, v146
v_permlane32_swap_b32 v145, v147
buffer_store_dwordx4 v[144:147], v100, s[68:71], 0 offen offset:0
v_permlane32_swap_b32 v148, v150
v_permlane32_swap_b32 v149, v151
buffer_store_dwordx4 v[148:151], v100, s[68:71], 0 offen offset:32
s_endpgm
L_parallel_sum__spectral_gfnet__glu_gated_reglu__prompt_kernel_heavy_6:
ds_read_b128 a[48:51], v233 offset:0
ds_read_b128 a[52:55], v233 offset:1024
ds_read_b128 a[56:59], v233 offset:2048
ds_read_b128 a[60:63], v233 offset:3072
s_waitcnt vmcnt(8)
ds_read_b128 v[0:3], v229 offset:0
ds_read_b128 v[4:7], v230 offset:0
ds_read_b128 v[8:11], v231 offset:0
ds_read_b128 v[12:15], v232 offset:0
s_waitcnt lgkmcnt(0)
ds_read_b128 a[64:67], v233 offset:4096
v_dot2c_f32_bf16 v237, s58, v0
v_dot2c_f32_bf16 v239, v0, v0
v_dot2c_f32_bf16 v238, s58, v1
v_dot2c_f32_bf16 v240, v1, v1
ds_read_b128 a[68:71], v233 offset:5120
v_dot2c_f32_bf16 v237, s58, v2
v_dot2c_f32_bf16 v239, v2, v2
v_dot2c_f32_bf16 v238, s58, v3
v_dot2c_f32_bf16 v240, v3, v3
ds_read_b128 a[72:75], v233 offset:6144
v_dot2c_f32_bf16 v237, s58, v4
v_dot2c_f32_bf16 v239, v4, v4
buffer_load_dwordx4 v225, s[4:7], s50 offen lds
s_add_u32 m0, m0, s54
v_dot2c_f32_bf16 v238, s58, v5
v_dot2c_f32_bf16 v240, v5, v5
ds_read_b128 a[76:79], v233 offset:7168
v_dot2c_f32_bf16 v237, s58, v6
v_dot2c_f32_bf16 v239, v6, v6
v_dot2c_f32_bf16 v238, s58, v7
v_dot2c_f32_bf16 v240, v7, v7
s_waitcnt vmcnt(5)
ds_read_b128 v[16:19], v229 offset:4096
v_dot2c_f32_bf16 v237, s58, v8
v_dot2c_f32_bf16 v239, v8, v8
v_dot2c_f32_bf16 v238, s58, v9
v_dot2c_f32_bf16 v240, v9, v9
ds_read_b128 v[20:23], v230 offset:4096
buffer_load_dwordx4 v226, s[4:7], s50 offen lds
s_add_u32 m0, m0, s54
v_dot2c_f32_bf16 v237, s58, v10
v_dot2c_f32_bf16 v239, v10, v10
v_dot2c_f32_bf16 v238, s58, v11
v_dot2c_f32_bf16 v240, v11, v11
ds_read_b128 v[24:27], v231 offset:4096
v_dot2c_f32_bf16 v237, s58, v12
v_dot2c_f32_bf16 v239, v12, v12
v_dot2c_f32_bf16 v238, s58, v13
v_dot2c_f32_bf16 v240, v13, v13
ds_read_b128 v[28:31], v232 offset:4096
v_dot2c_f32_bf16 v237, s58, v14
v_dot2c_f32_bf16 v239, v14, v14
v_dot2c_f32_bf16 v238, s58, v15
v_dot2c_f32_bf16 v240, v15, v15
v_mfma_f32_32x32x16_bf16 v[128:143], a[48:51], v[0:3], 0
buffer_load_dwordx4 v227, s[4:7], s50 offen lds
s_add_u32 m0, m0, s54
v_mfma_f32_32x32x16_bf16 v[128:143], a[52:55], v[4:7], v[128:143]
v_mfma_f32_32x32x16_bf16 v[128:143], a[56:59], v[8:11], v[128:143]
buffer_load_dwordx4 v228, s[4:7], s50 offen lds
s_add_u32 m0, m0, s54
s_add_u32 s50, s50, 0x80
s_and_b32 s50, s50, 0x3ff
v_mfma_f32_32x32x16_bf16 v[128:143], a[60:63], v[12:15], v[128:143]
s_waitcnt lgkmcnt(0)
ds_read_b128 a[48:51], v233 offset:8192
v_dot2c_f32_bf16 v237, s58, v16
v_dot2c_f32_bf16 v239, v16, v16
v_dot2c_f32_bf16 v238, s58, v17
v_dot2c_f32_bf16 v240, v17, v17
ds_read_b128 a[52:55], v233 offset:9216
v_dot2c_f32_bf16 v237, s58, v18
v_dot2c_f32_bf16 v239, v18, v18
v_dot2c_f32_bf16 v238, s58, v19
v_dot2c_f32_bf16 v240, v19, v19
ds_read_b128 a[56:59], v233 offset:10240
v_dot2c_f32_bf16 v237, s58, v20
v_dot2c_f32_bf16 v239, v20, v20
buffer_load_dwordx4 v225, s[4:7], s50 offen lds
s_add_u32 m0, m0, s54
v_dot2c_f32_bf16 v238, s58, v21
v_dot2c_f32_bf16 v240, v21, v21
ds_read_b128 a[60:63], v233 offset:11264
v_dot2c_f32_bf16 v237, s58, v22
v_dot2c_f32_bf16 v239, v22, v22
v_dot2c_f32_bf16 v238, s58, v23
v_dot2c_f32_bf16 v240, v23, v23
s_waitcnt vmcnt(5)
ds_read_b128 v[32:35], v229 offset:8192
v_dot2c_f32_bf16 v237, s58, v24
v_dot2c_f32_bf16 v239, v24, v24
v_dot2c_f32_bf16 v238, s58, v25
v_dot2c_f32_bf16 v240, v25, v25
ds_read_b128 v[36:39], v230 offset:8192
buffer_load_dwordx4 v226, s[4:7], s50 offen lds
s_add_u32 m0, m0, s54
v_dot2c_f32_bf16 v237, s58, v26
v_dot2c_f32_bf16 v239, v26, v26
v_dot2c_f32_bf16 v238, s58, v27
v_dot2c_f32_bf16 v240, v27, v27
ds_read_b128 v[40:43], v231 offset:8192
v_dot2c_f32_bf16 v237, s58, v28
v_dot2c_f32_bf16 v239, v28, v28
v_dot2c_f32_bf16 v238, s58, v29
v_dot2c_f32_bf16 v240, v29, v29
ds_read_b128 v[44:47], v232 offset:8192
v_dot2c_f32_bf16 v237, s58, v30
v_dot2c_f32_bf16 v239, v30, v30
v_dot2c_f32_bf16 v238, s58, v31
v_dot2c_f32_bf16 v240, v31, v31
v_mfma_f32_32x32x16_bf16 v[128:143], a[64:67], v[16:19], v[128:143]
buffer_load_dwordx4 v227, s[4:7], s50 offen lds
s_add_u32 m0, m0, s54
v_mfma_f32_32x32x16_bf16 v[128:143], a[68:71], v[20:23], v[128:143]
v_mfma_f32_32x32x16_bf16 v[128:143], a[72:75], v[24:27], v[128:143]
buffer_load_dwordx4 v228, s[4:7], s50 offen lds
s_add_u32 m0, m0, s54
s_add_u32 s50, s50, 0x80
s_and_b32 s50, s50, 0x3ff
v_mfma_f32_32x32x16_bf16 v[128:143], a[76:79], v[28:31], v[128:143]
s_waitcnt lgkmcnt(0)
ds_read_b128 a[64:67], v233 offset:12288
v_dot2c_f32_bf16 v237, s58, v32
v_dot2c_f32_bf16 v239, v32, v32
v_dot2c_f32_bf16 v238, s58, v33
v_dot2c_f32_bf16 v240, v33, v33
ds_read_b128 a[68:71], v233 offset:13312
v_dot2c_f32_bf16 v237, s58, v34
v_dot2c_f32_bf16 v239, v34, v34
v_dot2c_f32_bf16 v238, s58, v35
v_dot2c_f32_bf16 v240, v35, v35
ds_read_b128 a[72:75], v233 offset:14336
v_dot2c_f32_bf16 v237, s58, v36
v_dot2c_f32_bf16 v239, v36, v36
buffer_load_dwordx4 v225, s[4:7], s50 offen lds
s_add_u32 m0, m0, s54
v_dot2c_f32_bf16 v238, s58, v37
v_dot2c_f32_bf16 v240, v37, v37
ds_read_b128 a[76:79], v233 offset:15360
v_dot2c_f32_bf16 v237, s58, v38
v_dot2c_f32_bf16 v239, v38, v38
v_dot2c_f32_bf16 v238, s58, v39
v_dot2c_f32_bf16 v240, v39, v39
s_waitcnt vmcnt(5)
ds_read_b128 v[48:51], v229 offset:12288
v_dot2c_f32_bf16 v237, s58, v40
v_dot2c_f32_bf16 v239, v40, v40
v_dot2c_f32_bf16 v238, s58, v41
v_dot2c_f32_bf16 v240, v41, v41
ds_read_b128 v[52:55], v230 offset:12288
buffer_load_dwordx4 v226, s[4:7], s50 offen lds
s_add_u32 m0, m0, s54
v_dot2c_f32_bf16 v237, s58, v42
v_dot2c_f32_bf16 v239, v42, v42
v_dot2c_f32_bf16 v238, s58, v43
v_dot2c_f32_bf16 v240, v43, v43
ds_read_b128 v[56:59], v231 offset:12288
v_dot2c_f32_bf16 v237, s58, v44
v_dot2c_f32_bf16 v239, v44, v44
v_dot2c_f32_bf16 v238, s58, v45
v_dot2c_f32_bf16 v240, v45, v45
ds_read_b128 v[60:63], v232 offset:12288
v_dot2c_f32_bf16 v237, s58, v46
v_dot2c_f32_bf16 v239, v46, v46
v_dot2c_f32_bf16 v238, s58, v47
v_dot2c_f32_bf16 v240, v47, v47
v_mfma_f32_32x32x16_bf16 v[128:143], a[48:51], v[32:35], v[128:143]
buffer_load_dwordx4 v227, s[4:7], s50 offen lds
s_add_u32 m0, m0, s54
v_mfma_f32_32x32x16_bf16 v[128:143], a[52:55], v[36:39], v[128:143]
v_mfma_f32_32x32x16_bf16 v[128:143], a[56:59], v[40:43], v[128:143]
buffer_load_dwordx4 v228, s[4:7], s50 offen lds
s_add_u32 m0, m0, s54
s_add_u32 s50, s50, 0x80
s_and_b32 s50, s50, 0x3ff
v_mfma_f32_32x32x16_bf16 v[128:143], a[60:63], v[44:47], v[128:143]
s_cmp_lg_u32 s28, 0
s_cbranch_scc1 L_parallel_sum__spectral_gfnet__glu_gated_reglu__prompt_kernel_clr_51
s_and_b32 s60, s2, 3
s_lshl_b32 s60, s60, 6
s_mov_b64 exec, 1
v_mov_b32 v244, s60
v_mov_b32 v245, 1
global_atomic_add v244, v245, s[72:73] sc1
s_mov_b64 exec, -1
L_parallel_sum__spectral_gfnet__glu_gated_reglu__prompt_kernel_clr_51:
s_waitcnt lgkmcnt(0)
ds_read_b128 a[48:51], v233 offset:16384
v_dot2c_f32_bf16 v237, s58, v48
v_dot2c_f32_bf16 v239, v48, v48
v_dot2c_f32_bf16 v238, s58, v49
v_dot2c_f32_bf16 v240, v49, v49
ds_read_b128 a[52:55], v233 offset:17408
v_dot2c_f32_bf16 v237, s58, v50
v_dot2c_f32_bf16 v239, v50, v50
v_dot2c_f32_bf16 v238, s58, v51
v_dot2c_f32_bf16 v240, v51, v51
ds_read_b128 a[56:59], v233 offset:18432
v_dot2c_f32_bf16 v237, s58, v52
v_dot2c_f32_bf16 v239, v52, v52
buffer_load_dwordx4 v225, s[4:7], s50 offen lds
s_add_u32 m0, m0, s54
v_dot2c_f32_bf16 v238, s58, v53
v_dot2c_f32_bf16 v240, v53, v53
ds_read_b128 a[60:63], v233 offset:19456
v_dot2c_f32_bf16 v237, s58, v54
v_dot2c_f32_bf16 v239, v54, v54
v_dot2c_f32_bf16 v238, s58, v55
v_dot2c_f32_bf16 v240, v55, v55
s_waitcnt vmcnt(5)
ds_read_b128 v[64:67], v229 offset:16384
v_dot2c_f32_bf16 v237, s58, v56
v_dot2c_f32_bf16 v239, v56, v56
v_dot2c_f32_bf16 v238, s58, v57
v_dot2c_f32_bf16 v240, v57, v57
ds_read_b128 v[68:71], v230 offset:16384
buffer_load_dwordx4 v226, s[4:7], s50 offen lds
s_add_u32 m0, m0, s54
v_dot2c_f32_bf16 v237, s58, v58
v_dot2c_f32_bf16 v239, v58, v58
v_dot2c_f32_bf16 v238, s58, v59
v_dot2c_f32_bf16 v240, v59, v59
ds_read_b128 v[72:75], v231 offset:16384
v_dot2c_f32_bf16 v237, s58, v60
v_dot2c_f32_bf16 v239, v60, v60
v_dot2c_f32_bf16 v238, s58, v61
v_dot2c_f32_bf16 v240, v61, v61
ds_read_b128 v[76:79], v232 offset:16384
v_dot2c_f32_bf16 v237, s58, v62
v_dot2c_f32_bf16 v239, v62, v62
v_dot2c_f32_bf16 v238, s58, v63
v_dot2c_f32_bf16 v240, v63, v63
v_mfma_f32_32x32x16_bf16 v[128:143], a[64:67], v[48:51], v[128:143]
buffer_load_dwordx4 v227, s[4:7], s50 offen lds
s_add_u32 m0, m0, s54
v_mfma_f32_32x32x16_bf16 v[128:143], a[68:71], v[52:55], v[128:143]
v_mfma_f32_32x32x16_bf16 v[128:143], a[72:75], v[56:59], v[128:143]
buffer_load_dwordx4 v228, s[4:7], s50 offen lds
s_add_u32 m0, m0, s54
s_add_u32 s50, s50, 0x80
s_and_b32 s50, s50, 0x3ff
v_mfma_f32_32x32x16_bf16 v[128:143], a[76:79], v[60:63], v[128:143]
s_waitcnt lgkmcnt(0)
ds_read_b128 a[64:67], v233 offset:20480
v_dot2c_f32_bf16 v237, s58, v64
v_dot2c_f32_bf16 v239, v64, v64
v_dot2c_f32_bf16 v238, s58, v65
v_dot2c_f32_bf16 v240, v65, v65
ds_read_b128 a[68:71], v233 offset:21504
v_dot2c_f32_bf16 v237, s58, v66
v_dot2c_f32_bf16 v239, v66, v66
v_dot2c_f32_bf16 v238, s58, v67
v_dot2c_f32_bf16 v240, v67, v67
ds_read_b128 a[72:75], v233 offset:22528
v_dot2c_f32_bf16 v237, s58, v68
v_dot2c_f32_bf16 v239, v68, v68
buffer_load_dwordx4 v225, s[4:7], s50 offen lds
s_add_u32 m0, m0, s54
v_dot2c_f32_bf16 v238, s58, v69
v_dot2c_f32_bf16 v240, v69, v69
ds_read_b128 a[76:79], v233 offset:23552
v_dot2c_f32_bf16 v237, s58, v70
v_dot2c_f32_bf16 v239, v70, v70
v_dot2c_f32_bf16 v238, s58, v71
v_dot2c_f32_bf16 v240, v71, v71
s_waitcnt vmcnt(5)
ds_read_b128 v[80:83], v229 offset:20480
v_dot2c_f32_bf16 v237, s58, v72
v_dot2c_f32_bf16 v239, v72, v72
v_dot2c_f32_bf16 v238, s58, v73
v_dot2c_f32_bf16 v240, v73, v73
ds_read_b128 v[84:87], v230 offset:20480
buffer_load_dwordx4 v226, s[4:7], s50 offen lds
s_add_u32 m0, m0, s54
v_dot2c_f32_bf16 v237, s58, v74
v_dot2c_f32_bf16 v239, v74, v74
v_dot2c_f32_bf16 v238, s58, v75
v_dot2c_f32_bf16 v240, v75, v75
ds_read_b128 v[88:91], v231 offset:20480
v_dot2c_f32_bf16 v237, s58, v76
v_dot2c_f32_bf16 v239, v76, v76
v_dot2c_f32_bf16 v238, s58, v77
v_dot2c_f32_bf16 v240, v77, v77
ds_read_b128 v[92:95], v232 offset:20480
v_dot2c_f32_bf16 v237, s58, v78
v_dot2c_f32_bf16 v239, v78, v78
v_dot2c_f32_bf16 v238, s58, v79
v_dot2c_f32_bf16 v240, v79, v79
v_mfma_f32_32x32x16_bf16 v[128:143], a[48:51], v[64:67], v[128:143]
buffer_load_dwordx4 v227, s[4:7], s50 offen lds
s_add_u32 m0, m0, s54
v_mfma_f32_32x32x16_bf16 v[128:143], a[52:55], v[68:71], v[128:143]
v_mfma_f32_32x32x16_bf16 v[128:143], a[56:59], v[72:75], v[128:143]
buffer_load_dwordx4 v228, s[4:7], s50 offen lds
s_add_u32 m0, m0, s54
s_add_u32 s50, s50, 0x80
s_and_b32 s50, s50, 0x3ff
v_mfma_f32_32x32x16_bf16 v[128:143], a[60:63], v[76:79], v[128:143]
s_waitcnt lgkmcnt(0)
s_add_u32 s59, s53, 0
s_and_b32 s59, s59, 7
s_add_u32 m0, s32, 0
s_mul_i32 s59, s59, 176128
ds_read_b128 a[48:51], v233 offset:24576
v_dot2c_f32_bf16 v237, s58, v80
v_dot2c_f32_bf16 v239, v80, v80
v_dot2c_f32_bf16 v238, s58, v81
v_dot2c_f32_bf16 v240, v81, v81
ds_read_b128 a[52:55], v233 offset:25600
v_dot2c_f32_bf16 v237, s58, v82
v_dot2c_f32_bf16 v239, v82, v82
buffer_load_dwordx4 v236, s[8:11], s59 offen offset:0 lds
s_add_u32 m0, s32, 960
v_dot2c_f32_bf16 v238, s58, v83
v_dot2c_f32_bf16 v240, v83, v83
ds_read_b128 a[56:59], v233 offset:26624
v_dot2c_f32_bf16 v237, s58, v84
v_dot2c_f32_bf16 v239, v84, v84
v_dot2c_f32_bf16 v238, s58, v85
v_dot2c_f32_bf16 v240, v85, v85
ds_read_b128 a[60:63], v233 offset:27648
buffer_load_dwordx4 v236, s[8:11], s59 offen offset:64 lds
s_add_u32 m0, s32, 1920
v_dot2c_f32_bf16 v237, s58, v86
v_dot2c_f32_bf16 v239, v86, v86
v_dot2c_f32_bf16 v238, s58, v87
v_dot2c_f32_bf16 v240, v87, v87
s_waitcnt vmcnt(6)
ds_read_b128 v[96:99], v229 offset:24576
v_dot2c_f32_bf16 v237, s58, v88
v_dot2c_f32_bf16 v239, v88, v88
buffer_load_dwordx4 v236, s[8:11], s59 offen offset:128 lds
s_add_u32 m0, s32, 3072
v_dot2c_f32_bf16 v238, s58, v89
v_dot2c_f32_bf16 v240, v89, v89
ds_read_b128 v[100:103], v230 offset:24576
v_dot2c_f32_bf16 v237, s58, v90
v_dot2c_f32_bf16 v239, v90, v90
v_dot2c_f32_bf16 v238, s58, v91
v_dot2c_f32_bf16 v240, v91, v91
ds_read_b128 v[104:107], v231 offset:24576
buffer_load_dwordx4 v236, s[12:15], s59 offen offset:0 lds
s_add_u32 m0, s32, 4032
v_dot2c_f32_bf16 v237, s58, v92
v_dot2c_f32_bf16 v239, v92, v92
v_dot2c_f32_bf16 v238, s58, v93
v_dot2c_f32_bf16 v240, v93, v93
ds_read_b128 v[108:111], v232 offset:24576
v_dot2c_f32_bf16 v237, s58, v94
v_dot2c_f32_bf16 v239, v94, v94
v_dot2c_f32_bf16 v238, s58, v95
v_dot2c_f32_bf16 v240, v95, v95
v_mfma_f32_32x32x16_bf16 v[128:143], a[64:67], v[80:83], v[128:143]
buffer_load_dwordx4 v236, s[12:15], s59 offen offset:64 lds
s_add_u32 m0, s32, 4992
v_mfma_f32_32x32x16_bf16 v[128:143], a[68:71], v[84:87], v[128:143]
v_mfma_f32_32x32x16_bf16 v[128:143], a[72:75], v[88:91], v[128:143]
buffer_load_dwordx4 v236, s[12:15], s59 offen offset:128 lds
v_mfma_f32_32x32x16_bf16 v[128:143], a[76:79], v[92:95], v[128:143]
s_waitcnt lgkmcnt(0)
s_add_u32 s59, s53, 1
s_and_b32 s59, s59, 7
s_add_u32 m0, s32, 6144
s_mul_i32 s59, s59, 176128
ds_read_b128 a[64:67], v233 offset:28672
v_dot2c_f32_bf16 v237, s58, v96
v_dot2c_f32_bf16 v239, v96, v96
v_dot2c_f32_bf16 v238, s58, v97
v_dot2c_f32_bf16 v240, v97, v97
ds_read_b128 a[68:71], v233 offset:29696
v_dot2c_f32_bf16 v237, s58, v98
v_dot2c_f32_bf16 v239, v98, v98
buffer_load_dwordx4 v236, s[8:11], s59 offen offset:0 lds
s_add_u32 m0, s32, 7104
v_dot2c_f32_bf16 v238, s58, v99
v_dot2c_f32_bf16 v240, v99, v99
ds_read_b128 a[72:75], v233 offset:30720
v_dot2c_f32_bf16 v237, s58, v100
v_dot2c_f32_bf16 v239, v100, v100
v_dot2c_f32_bf16 v238, s58, v101
v_dot2c_f32_bf16 v240, v101, v101
ds_read_b128 a[76:79], v233 offset:31744
buffer_load_dwordx4 v236, s[8:11], s59 offen offset:64 lds
s_add_u32 m0, s32, 8064
v_dot2c_f32_bf16 v237, s58, v102
v_dot2c_f32_bf16 v239, v102, v102
v_dot2c_f32_bf16 v238, s58, v103
v_dot2c_f32_bf16 v240, v103, v103
s_waitcnt vmcnt(8)
ds_read_b128 v[112:115], v229 offset:28672
v_dot2c_f32_bf16 v237, s58, v104
v_dot2c_f32_bf16 v239, v104, v104
buffer_load_dwordx4 v236, s[8:11], s59 offen offset:128 lds
s_add_u32 m0, s32, 9216
v_dot2c_f32_bf16 v238, s58, v105
v_dot2c_f32_bf16 v240, v105, v105
ds_read_b128 v[116:119], v230 offset:28672
v_dot2c_f32_bf16 v237, s58, v106
v_dot2c_f32_bf16 v239, v106, v106
v_dot2c_f32_bf16 v238, s58, v107
v_dot2c_f32_bf16 v240, v107, v107
ds_read_b128 v[120:123], v231 offset:28672
buffer_load_dwordx4 v236, s[12:15], s59 offen offset:0 lds
s_add_u32 m0, s32, 10176
v_dot2c_f32_bf16 v237, s58, v108
v_dot2c_f32_bf16 v239, v108, v108
v_dot2c_f32_bf16 v238, s58, v109
v_dot2c_f32_bf16 v240, v109, v109
ds_read_b128 v[124:127], v232 offset:28672
v_dot2c_f32_bf16 v237, s58, v110
v_dot2c_f32_bf16 v239, v110, v110
v_dot2c_f32_bf16 v238, s58, v111
v_dot2c_f32_bf16 v240, v111, v111
v_mfma_f32_32x32x16_bf16 v[128:143], a[48:51], v[96:99], v[128:143]
buffer_load_dwordx4 v236, s[12:15], s59 offen offset:64 lds
s_add_u32 m0, s32, 11136
v_mfma_f32_32x32x16_bf16 v[128:143], a[52:55], v[100:103], v[128:143]
v_mfma_f32_32x32x16_bf16 v[128:143], a[56:59], v[104:107], v[128:143]
buffer_load_dwordx4 v236, s[12:15], s59 offen offset:128 lds
v_mfma_f32_32x32x16_bf16 v[128:143], a[60:63], v[108:111], v[128:143]
s_waitcnt lgkmcnt(0)
s_add_u32 s59, s53, 2
s_and_b32 s59, s59, 7
s_add_u32 m0, s32, 12288
s_mul_i32 s59, s59, 176128
v_dot2c_f32_bf16 v237, s58, v112
v_dot2c_f32_bf16 v239, v112, v112
v_dot2c_f32_bf16 v238, s58, v113
v_dot2c_f32_bf16 v240, v113, v113
v_dot2c_f32_bf16 v237, s58, v114
v_dot2c_f32_bf16 v239, v114, v114
buffer_load_dwordx4 v236, s[8:11], s59 offen offset:0 lds
s_add_u32 m0, s32, 13248
v_dot2c_f32_bf16 v238, s58, v115
v_dot2c_f32_bf16 v240, v115, v115
v_dot2c_f32_bf16 v237, s58, v116
v_dot2c_f32_bf16 v239, v116, v116
v_dot2c_f32_bf16 v238, s58, v117
v_dot2c_f32_bf16 v240, v117, v117
buffer_load_dwordx4 v236, s[8:11], s59 offen offset:64 lds
s_add_u32 m0, s32, 14208
v_dot2c_f32_bf16 v237, s58, v118
v_dot2c_f32_bf16 v239, v118, v118
v_dot2c_f32_bf16 v238, s58, v119
v_dot2c_f32_bf16 v240, v119, v119
v_dot2c_f32_bf16 v237, s58, v120
v_dot2c_f32_bf16 v239, v120, v120
v_dot2c_f32_bf16 v238, s58, v121
buffer_load_dwordx4 v236, s[8:11], s59 offen offset:128 lds
s_add_u32 m0, s32, 15360
v_dot2c_f32_bf16 v240, v121, v121
v_dot2c_f32_bf16 v237, s58, v122
v_dot2c_f32_bf16 v239, v122, v122
v_dot2c_f32_bf16 v238, s58, v123
v_dot2c_f32_bf16 v240, v123, v123
v_dot2c_f32_bf16 v237, s58, v124
buffer_load_dwordx4 v236, s[12:15], s59 offen offset:0 lds
s_add_u32 m0, s32, 16320
v_dot2c_f32_bf16 v239, v124, v124
v_dot2c_f32_bf16 v238, s58, v125
v_dot2c_f32_bf16 v240, v125, v125
v_dot2c_f32_bf16 v237, s58, v126
v_dot2c_f32_bf16 v239, v126, v126
v_dot2c_f32_bf16 v238, s58, v127
v_dot2c_f32_bf16 v240, v127, v127
v_mfma_f32_32x32x16_bf16 v[128:143], a[64:67], v[112:115], v[128:143]
buffer_load_dwordx4 v236, s[12:15], s59 offen offset:64 lds
s_add_u32 m0, s32, 17280
v_mfma_f32_32x32x16_bf16 v[128:143], a[68:71], v[116:119], v[128:143]
v_mfma_f32_32x32x16_bf16 v[128:143], a[72:75], v[120:123], v[128:143]
buffer_load_dwordx4 v236, s[12:15], s59 offen offset:128 lds
v_mfma_f32_32x32x16_bf16 v[128:143], a[76:79], v[124:127], v[128:143]
v_add_f32 v237, v237, v238
v_add_f32 v239, v239, v240
v_mov_b32 v244, v237
v_mov_b32 v245, v239
s_nop 0
v_permlane32_swap_b32 v237, v244
v_permlane32_swap_b32 v239, v245
v_add_f32 v237, v237, v244
v_add_f32 v239, v239, v245
v_mul_f32 v237, 0x3b000000, v237
v_mul_f32 v239, 0x3b000000, v239
v_fma_f32 v239, -v237, v237, v239
v_max_f32 v239, 0, v239
v_cvt_pk_bf16_f32 v244, v237, v239
v_and_b32 v245, s57, v244
v_lshlrev_b32 v243, 16, v244
v_add_f32 v245, 0x3727c5ac, v245
v_cvt_pk_bf16_f32 v245, v245, v245
v_lshlrev_b32 v245, 16, v245
v_sqrt_f32 v245, v245
v_cmp_gt_u32 vcc, 32, v224
v_cvt_pk_bf16_f32 v245, v245, v245
s_cmp_eq_u32 s30, 0
s_cselect_b64 vcc, vcc, 0
v_lshlrev_b32 v245, 16, v245
v_mul_f32 v244, 0x44000000, v243
v_rcp_f32 v241, v245
v_cndmask_b32 v244, 0, v244, vcc
v_mul_f32 v242, v243, v241
v_sub_f32 v128, v128, v244
v_sub_f32 v242, 0, v242
s_waitcnt vmcnt(12)
s_barrier
ds_read_b64_tr_b16 a[0:1], v234 offset:0
ds_read_b64_tr_b16 a[2:3], v234 offset:256
ds_read_b64_tr_b16 a[4:5], v234 offset:3072
ds_read_b64_tr_b16 a[6:7], v234 offset:3328
ds_read_b64_tr_b16 a[8:9], v234 offset:1024
ds_read_b64_tr_b16 a[10:11], v234 offset:1280
ds_read_b64_tr_b16 a[12:13], v234 offset:4096
ds_read_b64_tr_b16 a[14:15], v234 offset:4352
ds_read_b64_tr_b16 a[16:17], v234 offset:2048
ds_read_b64_tr_b16 a[18:19], v234 offset:2304
ds_read_b64_tr_b16 a[20:21], v234 offset:5120
ds_read_b64_tr_b16 a[22:23], v234 offset:5376
v_mul_f32 v128, v128, v241
v_mul_f32 v129, v129, v241
v_cvt_pk_bf16_f32 v144, v128, v129
v_mul_f32 v130, v130, v241
v_mul_f32 v131, v131, v241
v_cvt_pk_bf16_f32 v145, v130, v131
v_mul_f32 v132, v132, v241
v_mul_f32 v133, v133, v241
v_cvt_pk_bf16_f32 v146, v132, v133
v_mul_f32 v134, v134, v241
v_mul_f32 v135, v135, v241
v_cvt_pk_bf16_f32 v147, v134, v135
v_mul_f32 v136, v136, v241
v_mul_f32 v137, v137, v241
v_cvt_pk_bf16_f32 v148, v136, v137
v_mul_f32 v138, v138, v241
v_mul_f32 v139, v139, v241
v_cvt_pk_bf16_f32 v149, v138, v139
v_mul_f32 v140, v140, v241
v_mul_f32 v141, v141, v241
v_cvt_pk_bf16_f32 v150, v140, v141
v_mul_f32 v142, v142, v241
v_mul_f32 v143, v143, v241
v_cvt_pk_bf16_f32 v151, v142, v143
v_lshlrev_b32 v244, 16, v0
v_and_b32 v245, s57, v0
v_lshlrev_b32 v246, 16, v1
v_and_b32 v247, s57, v1
v_fma_f32 v244, v244, v241, v242
v_fma_f32 v245, v245, v241, v242
v_fma_f32 v246, v246, v241, v242
v_fma_f32 v247, v247, v241, v242
v_cvt_pk_bf16_f32 v0, v244, v245
v_cvt_pk_bf16_f32 v1, v246, v247
v_lshlrev_b32 v248, 16, v2
v_and_b32 v249, s57, v2
v_lshlrev_b32 v250, 16, v3
v_and_b32 v251, s57, v3
v_fma_f32 v248, v248, v241, v242
v_fma_f32 v249, v249, v241, v242
v_fma_f32 v250, v250, v241, v242
v_fma_f32 v251, v251, v241, v242
v_cvt_pk_bf16_f32 v2, v248, v249
v_cvt_pk_bf16_f32 v3, v250, v251
s_mov_b32 s60, 0
buffer_store_dword v144, v253, s[16:19], s60 offen sc1
s_mov_b32 s60, 8192
buffer_store_dword v145, v253, s[16:19], s60 offen sc1
s_mov_b32 s60, 32768
buffer_store_dword v146, v253, s[16:19], s60 offen sc1
s_mov_b32 s60, 40960
buffer_store_dword v147, v253, s[16:19], s60 offen sc1
s_mov_b32 s60, 65536
buffer_store_dword v148, v253, s[16:19], s60 offen sc1
s_mov_b32 s60, 73728
buffer_store_dword v149, v253, s[16:19], s60 offen sc1
s_mov_b32 s60, 98304
buffer_store_dword v150, v253, s[16:19], s60 offen sc1
s_mov_b32 s60, 106496
buffer_store_dword v151, v253, s[16:19], s60 offen sc1
s_waitcnt lgkmcnt(8)
v_mfma_f32_32x32x16_bf16 v[128:143], a[0:3], v[0:3], 0
s_add_u32 s59, s53, 3
s_and_b32 s59, s59, 7
s_add_u32 m0, s32, 18432
s_mul_i32 s59, s59, 176128
ds_read_b64_tr_b16 a[24:25], v234 offset:32768
ds_read_b64_tr_b16 a[26:27], v234 offset:33024
v_lshlrev_b32 v244, 16, v4
v_and_b32 v245, s57, v4
v_lshlrev_b32 v246, 16, v5
v_mfma_f32_32x32x16_bf16 v[144:159], a[4:7], v[0:3], 0
ds_read_b64_tr_b16 a[28:29], v234 offset:35840
ds_read_b64_tr_b16 a[30:31], v234 offset:36096
v_and_b32 v247, s57, v5
v_fma_f32 v244, v244, v241, v242
v_fma_f32 v245, v245, v241, v242
v_fma_f32 v246, v246, v241, v242
v_fma_f32 v247, v247, v241, v242
v_cvt_pk_bf16_f32 v4, v244, v245
s_waitcnt lgkmcnt(8)
v_mfma_f32_32x32x16_bf16 v[160:175], a[8:11], v[0:3], 0
buffer_load_dwordx4 v236, s[8:11], s59 offen offset:0 lds
s_add_u32 m0, s32, 19392
ds_read_b64_tr_b16 a[32:33], v234 offset:33792
ds_read_b64_tr_b16 a[34:35], v234 offset:34048
v_mfma_f32_32x32x16_bf16 v[176:191], a[12:15], v[0:3], 0
ds_read_b64_tr_b16 a[36:37], v234 offset:36864
ds_read_b64_tr_b16 a[38:39], v234 offset:37120
v_cvt_pk_bf16_f32 v5, v246, v247
v_lshlrev_b32 v248, 16, v6
v_and_b32 v249, s57, v6
v_lshlrev_b32 v250, 16, v7
v_and_b32 v251, s57, v7
v_fma_f32 v248, v248, v241, v242
s_waitcnt lgkmcnt(8)
v_mfma_f32_32x32x16_bf16 v[192:207], a[16:19], v[0:3], 0
buffer_load_dwordx4 v236, s[8:11], s59 offen offset:64 lds
s_add_u32 m0, s32, 20352
ds_read_b64_tr_b16 a[40:41], v234 offset:34816
ds_read_b64_tr_b16 a[42:43], v234 offset:35072
v_mfma_f32_32x32x16_bf16 v[208:223], a[20:23], v[0:3], 0
ds_read_b64_tr_b16 a[44:45], v234 offset:37888
ds_read_b64_tr_b16 a[46:47], v234 offset:38144
v_fma_f32 v249, v249, v241, v242
v_fma_f32 v250, v250, v241, v242
v_fma_f32 v251, v251, v241, v242
v_cvt_pk_bf16_f32 v6, v248, v249
v_cvt_pk_bf16_f32 v7, v250, v251
s_waitcnt lgkmcnt(8)
s_nop 0
v_mfma_f32_32x32x16_bf16 v[128:143], a[24:27], v[4:7], v[128:143]
buffer_load_dwordx4 v236, s[8:11], s59 offen offset:128 lds
s_add_u32 m0, s32, 21504
ds_read_b64_tr_b16 a[0:1], v235 offset:0
ds_read_b64_tr_b16 a[2:3], v235 offset:256
v_mfma_f32_32x32x16_bf16 v[144:159], a[28:31], v[4:7], v[144:159]
ds_read_b64_tr_b16 a[4:5], v235 offset:3072
ds_read_b64_tr_b16 a[6:7], v235 offset:3328
v_lshlrev_b32 v244, 16, v8
v_and_b32 v245, s57, v8
v_lshlrev_b32 v246, 16, v9
v_and_b32 v247, s57, v9
v_fma_f32 v244, v244, v241, v242
s_waitcnt lgkmcnt(8)
v_mfma_f32_32x32x16_bf16 v[160:175], a[32:35], v[4:7], v[160:175]
ds_read_b64_tr_b16 a[8:9], v235 offset:1024
ds_read_b64_tr_b16 a[10:11], v235 offset:1280
v_fma_f32 v245, v245, v241, v242
v_fma_f32 v246, v246, v241, v242
v_fma_f32 v247, v247, v241, v242
v_cvt_pk_bf16_f32 v8, v244, v245
v_cvt_pk_bf16_f32 v9, v246, v247
v_lshlrev_b32 v248, 16, v10
v_mfma_f32_32x32x16_bf16 v[176:191], a[36:39], v[4:7], v[176:191]
buffer_load_dwordx4 v236, s[12:15], s59 offen offset:0 lds
s_add_u32 m0, s32, 22464
ds_read_b64_tr_b16 a[12:13], v235 offset:4096
ds_read_b64_tr_b16 a[14:15], v235 offset:4352
s_waitcnt lgkmcnt(8)
v_mfma_f32_32x32x16_bf16 v[192:207], a[40:43], v[4:7], v[192:207]
ds_read_b64_tr_b16 a[16:17], v235 offset:2048
ds_read_b64_tr_b16 a[18:19], v235 offset:2304
v_and_b32 v249, s57, v10
v_lshlrev_b32 v250, 16, v11
v_and_b32 v251, s57, v11
v_fma_f32 v248, v248, v241, v242
v_fma_f32 v249, v249, v241, v242
v_fma_f32 v250, v250, v241, v242
v_mfma_f32_32x32x16_bf16 v[208:223], a[44:47], v[4:7], v[208:223]
ds_read_b64_tr_b16 a[20:21], v235 offset:5120
ds_read_b64_tr_b16 a[22:23], v235 offset:5376
v_fma_f32 v251, v251, v241, v242
v_cvt_pk_bf16_f32 v10, v248, v249
v_cvt_pk_bf16_f32 v11, v250, v251
s_waitcnt lgkmcnt(8)
s_nop 0
v_mfma_f32_32x32x16_bf16 v[128:143], a[0:3], v[8:11], v[128:143]
buffer_load_dwordx4 v236, s[12:15], s59 offen offset:64 lds
s_add_u32 m0, s32, 23424
ds_read_b64_tr_b16 a[24:25], v235 offset:32768
ds_read_b64_tr_b16 a[26:27], v235 offset:33024
v_mfma_f32_32x32x16_bf16 v[144:159], a[4:7], v[8:11], v[144:159]
ds_read_b64_tr_b16 a[28:29], v235 offset:35840
ds_read_b64_tr_b16 a[30:31], v235 offset:36096
v_lshlrev_b32 v244, 16, v12
v_and_b32 v245, s57, v12
v_lshlrev_b32 v246, 16, v13
v_and_b32 v247, s57, v13
v_fma_f32 v244, v244, v241, v242
s_waitcnt lgkmcnt(8)
v_mfma_f32_32x32x16_bf16 v[160:175], a[8:11], v[8:11], v[160:175]
ds_read_b64_tr_b16 a[32:33], v235 offset:33792
ds_read_b64_tr_b16 a[34:35], v235 offset:34048
v_fma_f32 v245, v245, v241, v242
v_fma_f32 v246, v246, v241, v242
v_fma_f32 v247, v247, v241, v242
v_cvt_pk_bf16_f32 v12, v244, v245
v_cvt_pk_bf16_f32 v13, v246, v247
v_lshlrev_b32 v248, 16, v14
v_mfma_f32_32x32x16_bf16 v[176:191], a[12:15], v[8:11], v[176:191]
buffer_load_dwordx4 v236, s[12:15], s59 offen offset:128 lds
ds_read_b64_tr_b16 a[36:37], v235 offset:36864
ds_read_b64_tr_b16 a[38:39], v235 offset:37120
s_waitcnt lgkmcnt(8)
v_mfma_f32_32x32x16_bf16 v[192:207], a[16:19], v[8:11], v[192:207]
ds_read_b64_tr_b16 a[40:41], v235 offset:34816
ds_read_b64_tr_b16 a[42:43], v235 offset:35072
v_and_b32 v249, s57, v14
v_lshlrev_b32 v250, 16, v15
v_and_b32 v251, s57, v15
v_fma_f32 v248, v248, v241, v242
v_fma_f32 v249, v249, v241, v242
v_fma_f32 v250, v250, v241, v242
v_mfma_f32_32x32x16_bf16 v[208:223], a[20:23], v[8:11], v[208:223]
ds_read_b64_tr_b16 a[44:45], v235 offset:37888
ds_read_b64_tr_b16 a[46:47], v235 offset:38144
v_fma_f32 v251, v251, v241, v242
v_cvt_pk_bf16_f32 v14, v248, v249
v_cvt_pk_bf16_f32 v15, v250, v251
s_waitcnt vmcnt(20)
s_barrier
s_waitcnt lgkmcnt(8)
v_mfma_f32_32x32x16_bf16 v[128:143], a[24:27], v[12:15], v[128:143]
s_add_u32 s59, s53, 4
s_and_b32 s59, s59, 7
s_add_u32 m0, s32, 24576
s_mul_i32 s59, s59, 176128
ds_read_b64_tr_b16 a[0:1], v234 offset:6144
ds_read_b64_tr_b16 a[2:3], v234 offset:6400
v_lshlrev_b32 v244, 16, v16
v_and_b32 v245, s57, v16
v_lshlrev_b32 v246, 16, v17
v_mfma_f32_32x32x16_bf16 v[144:159], a[28:31], v[12:15], v[144:159]
ds_read_b64_tr_b16 a[4:5], v234 offset:9216
ds_read_b64_tr_b16 a[6:7], v234 offset:9472
v_and_b32 v247, s57, v17
v_fma_f32 v244, v244, v241, v242
v_fma_f32 v245, v245, v241, v242
v_fma_f32 v246, v246, v241, v242
v_fma_f32 v247, v247, v241, v242
v_cvt_pk_bf16_f32 v16, v244, v245
s_waitcnt lgkmcnt(8)
v_mfma_f32_32x32x16_bf16 v[160:175], a[32:35], v[12:15], v[160:175]
buffer_load_dwordx4 v236, s[8:11], s59 offen offset:0 lds
s_add_u32 m0, s32, 25536
ds_read_b64_tr_b16 a[8:9], v234 offset:7168
ds_read_b64_tr_b16 a[10:11], v234 offset:7424
v_mfma_f32_32x32x16_bf16 v[176:191], a[36:39], v[12:15], v[176:191]
ds_read_b64_tr_b16 a[12:13], v234 offset:10240
ds_read_b64_tr_b16 a[14:15], v234 offset:10496
v_cvt_pk_bf16_f32 v17, v246, v247
v_lshlrev_b32 v248, 16, v18
v_and_b32 v249, s57, v18
v_lshlrev_b32 v250, 16, v19
v_and_b32 v251, s57, v19
v_fma_f32 v248, v248, v241, v242
s_waitcnt lgkmcnt(8)
v_mfma_f32_32x32x16_bf16 v[192:207], a[40:43], v[12:15], v[192:207]
buffer_load_dwordx4 v236, s[8:11], s59 offen offset:64 lds
s_add_u32 m0, s32, 26496
ds_read_b64_tr_b16 a[16:17], v234 offset:8192
ds_read_b64_tr_b16 a[18:19], v234 offset:8448
v_mfma_f32_32x32x16_bf16 v[208:223], a[44:47], v[12:15], v[208:223]
ds_read_b64_tr_b16 a[20:21], v234 offset:11264
ds_read_b64_tr_b16 a[22:23], v234 offset:11520
v_fma_f32 v249, v249, v241, v242
v_fma_f32 v250, v250, v241, v242
v_fma_f32 v251, v251, v241, v242
v_cvt_pk_bf16_f32 v18, v248, v249
v_cvt_pk_bf16_f32 v19, v250, v251
s_waitcnt lgkmcnt(8)
s_nop 0
v_mfma_f32_32x32x16_bf16 v[128:143], a[0:3], v[16:19], v[128:143]
buffer_load_dwordx4 v236, s[8:11], s59 offen offset:128 lds
s_add_u32 m0, s32, 27648
ds_read_b64_tr_b16 a[24:25], v234 offset:38912
ds_read_b64_tr_b16 a[26:27], v234 offset:39168
v_mfma_f32_32x32x16_bf16 v[144:159], a[4:7], v[16:19], v[144:159]
ds_read_b64_tr_b16 a[28:29], v234 offset:41984
ds_read_b64_tr_b16 a[30:31], v234 offset:42240
v_lshlrev_b32 v244, 16, v20
v_and_b32 v245, s57, v20
v_lshlrev_b32 v246, 16, v21
v_and_b32 v247, s57, v21
v_fma_f32 v244, v244, v241, v242
s_waitcnt lgkmcnt(8)
v_mfma_f32_32x32x16_bf16 v[160:175], a[8:11], v[16:19], v[160:175]
ds_read_b64_tr_b16 a[32:33], v234 offset:39936
ds_read_b64_tr_b16 a[34:35], v234 offset:40192
v_fma_f32 v245, v245, v241, v242
v_fma_f32 v246, v246, v241, v242
v_fma_f32 v247, v247, v241, v242
v_cvt_pk_bf16_f32 v20, v244, v245
v_cvt_pk_bf16_f32 v21, v246, v247
v_lshlrev_b32 v248, 16, v22
v_mfma_f32_32x32x16_bf16 v[176:191], a[12:15], v[16:19], v[176:191]
buffer_load_dwordx4 v236, s[12:15], s59 offen offset:0 lds
s_add_u32 m0, s32, 28608
ds_read_b64_tr_b16 a[36:37], v234 offset:43008
ds_read_b64_tr_b16 a[38:39], v234 offset:43264
s_waitcnt lgkmcnt(8)
v_mfma_f32_32x32x16_bf16 v[192:207], a[16:19], v[16:19], v[192:207]
ds_read_b64_tr_b16 a[40:41], v234 offset:40960
ds_read_b64_tr_b16 a[42:43], v234 offset:41216
v_and_b32 v249, s57, v22
v_lshlrev_b32 v250, 16, v23
v_and_b32 v251, s57, v23
v_fma_f32 v248, v248, v241, v242
v_fma_f32 v249, v249, v241, v242
v_fma_f32 v250, v250, v241, v242
v_mfma_f32_32x32x16_bf16 v[208:223], a[20:23], v[16:19], v[208:223]
ds_read_b64_tr_b16 a[44:45], v234 offset:44032
ds_read_b64_tr_b16 a[46:47], v234 offset:44288
v_fma_f32 v251, v251, v241, v242
v_cvt_pk_bf16_f32 v22, v248, v249
v_cvt_pk_bf16_f32 v23, v250, v251
s_waitcnt lgkmcnt(8)
s_nop 0
v_mfma_f32_32x32x16_bf16 v[128:143], a[24:27], v[20:23], v[128:143]
buffer_load_dwordx4 v236, s[12:15], s59 offen offset:64 lds
s_add_u32 m0, s32, 29568
ds_read_b64_tr_b16 a[0:1], v235 offset:6144
ds_read_b64_tr_b16 a[2:3], v235 offset:6400
v_mfma_f32_32x32x16_bf16 v[144:159], a[28:31], v[20:23], v[144:159]
ds_read_b64_tr_b16 a[4:5], v235 offset:9216
ds_read_b64_tr_b16 a[6:7], v235 offset:9472
v_lshlrev_b32 v244, 16, v24
v_and_b32 v245, s57, v24
v_lshlrev_b32 v246, 16, v25
v_and_b32 v247, s57, v25
v_fma_f32 v244, v244, v241, v242
s_waitcnt lgkmcnt(8)
v_mfma_f32_32x32x16_bf16 v[160:175], a[32:35], v[20:23], v[160:175]
ds_read_b64_tr_b16 a[8:9], v235 offset:7168
ds_read_b64_tr_b16 a[10:11], v235 offset:7424
v_fma_f32 v245, v245, v241, v242
v_fma_f32 v246, v246, v241, v242
v_fma_f32 v247, v247, v241, v242
v_cvt_pk_bf16_f32 v24, v244, v245
v_cvt_pk_bf16_f32 v25, v246, v247
v_lshlrev_b32 v248, 16, v26
v_mfma_f32_32x32x16_bf16 v[176:191], a[36:39], v[20:23], v[176:191]
buffer_load_dwordx4 v236, s[12:15], s59 offen offset:128 lds
ds_read_b64_tr_b16 a[12:13], v235 offset:10240
ds_read_b64_tr_b16 a[14:15], v235 offset:10496
s_waitcnt lgkmcnt(8)
v_mfma_f32_32x32x16_bf16 v[192:207], a[40:43], v[20:23], v[192:207]
ds_read_b64_tr_b16 a[16:17], v235 offset:8192
ds_read_b64_tr_b16 a[18:19], v235 offset:8448
v_and_b32 v249, s57, v26
v_lshlrev_b32 v250, 16, v27
v_and_b32 v251, s57, v27
v_fma_f32 v248, v248, v241, v242
v_fma_f32 v249, v249, v241, v242
v_fma_f32 v250, v250, v241, v242
v_mfma_f32_32x32x16_bf16 v[208:223], a[44:47], v[20:23], v[208:223]
ds_read_b64_tr_b16 a[20:21], v235 offset:11264
ds_read_b64_tr_b16 a[22:23], v235 offset:11520
v_fma_f32 v251, v251, v241, v242
v_cvt_pk_bf16_f32 v26, v248, v249
v_cvt_pk_bf16_f32 v27, v250, v251
s_waitcnt lgkmcnt(8)
s_nop 0
v_mfma_f32_32x32x16_bf16 v[128:143], a[0:3], v[24:27], v[128:143]
s_and_b32 s34, s2, 7
s_lshr_b32 s35, s2, 3
s_lshl_b32 s36, s34, 2
ds_read_b64_tr_b16 a[24:25], v235 offset:38912
ds_read_b64_tr_b16 a[26:27], v235 offset:39168
v_lshlrev_b32 v244, 16, v28
v_and_b32 v245, s57, v28
v_lshlrev_b32 v246, 16, v29
v_and_b32 v247, s57, v29
v_mfma_f32_32x32x16_bf16 v[144:159], a[4:7], v[24:27], v[144:159]
s_and_b32 s37, s35, 3
s_add_u32 s36, s36, s37
ds_read_b64_tr_b16 a[28:29], v235 offset:41984
ds_read_b64_tr_b16 a[30:31], v235 offset:42240
v_fma_f32 v244, v244, v241, v242
v_fma_f32 v245, v245, v241, v242
v_fma_f32 v246, v246, v241, v242
v_fma_f32 v247, v247, v241, v242
s_waitcnt lgkmcnt(8)
v_mfma_f32_32x32x16_bf16 v[160:175], a[8:11], v[24:27], v[160:175]
s_lshr_b32 s35, s35, 2
s_mul_i32 s36, s36, 44032
ds_read_b64_tr_b16 a[32:33], v235 offset:39936
ds_read_b64_tr_b16 a[34:35], v235 offset:40192
v_cvt_pk_bf16_f32 v28, v244, v245
v_cvt_pk_bf16_f32 v29, v246, v247
v_lshlrev_b32 v248, 16, v30
v_and_b32 v249, s57, v30
v_lshlrev_b32 v250, 16, v31
v_mfma_f32_32x32x16_bf16 v[176:191], a[12:15], v[24:27], v[176:191]
s_lshl_b32 s35, s35, 7
s_add_u32 s36, s36, s35
ds_read_b64_tr_b16 a[36:37], v235 offset:43008
ds_read_b64_tr_b16 a[38:39], v235 offset:43264
v_and_b32 v251, s57, v31
v_fma_f32 v248, v248, v241, v242
v_fma_f32 v249, v249, v241, v242
v_fma_f32 v250, v250, v241, v242
s_waitcnt lgkmcnt(8)
v_mfma_f32_32x32x16_bf16 v[192:207], a[16:19], v[24:27], v[192:207]
s_cmp_eq_u32 s28, 3
s_cselect_b32 s36, s36, 0x7ff00000
ds_read_b64_tr_b16 a[40:41], v235 offset:40960
ds_read_b64_tr_b16 a[42:43], v235 offset:41216
v_fma_f32 v251, v251, v241, v242
v_cvt_pk_bf16_f32 v30, v248, v249
v_cvt_pk_bf16_f32 v31, v250, v251
v_mfma_f32_32x32x16_bf16 v[208:223], a[20:23], v[24:27], v[208:223]
v_lshlrev_b32 v243, 10, v224
buffer_load_dword a250, v243, s[64:67], s36 offen
ds_read_b64_tr_b16 a[44:45], v235 offset:44032
ds_read_b64_tr_b16 a[46:47], v235 offset:44288
s_waitcnt vmcnt(21)
s_barrier
s_waitcnt lgkmcnt(8)
v_mfma_f32_32x32x16_bf16 v[128:143], a[24:27], v[28:31], v[128:143]
s_add_u32 s59, s53, 5
s_and_b32 s59, s59, 7
s_add_u32 m0, s32, 0
s_mul_i32 s59, s59, 176128
ds_read_b64_tr_b16 a[0:1], v234 offset:12288
ds_read_b64_tr_b16 a[2:3], v234 offset:12544
v_lshlrev_b32 v244, 16, v32
v_and_b32 v245, s57, v32
v_lshlrev_b32 v246, 16, v33
v_mfma_f32_32x32x16_bf16 v[144:159], a[28:31], v[28:31], v[144:159]
ds_read_b64_tr_b16 a[4:5], v234 offset:15360
ds_read_b64_tr_b16 a[6:7], v234 offset:15616
v_and_b32 v247, s57, v33
v_fma_f32 v244, v244, v241, v242
v_fma_f32 v245, v245, v241, v242
v_fma_f32 v246, v246, v241, v242
v_fma_f32 v247, v247, v241, v242
v_cvt_pk_bf16_f32 v32, v244, v245
s_waitcnt lgkmcnt(8)
v_mfma_f32_32x32x16_bf16 v[160:175], a[32:35], v[28:31], v[160:175]
buffer_load_dwordx4 v236, s[8:11], s59 offen offset:0 lds
s_add_u32 m0, s32, 960
ds_read_b64_tr_b16 a[8:9], v234 offset:13312
ds_read_b64_tr_b16 a[10:11], v234 offset:13568
v_mfma_f32_32x32x16_bf16 v[176:191], a[36:39], v[28:31], v[176:191]
ds_read_b64_tr_b16 a[12:13], v234 offset:16384
ds_read_b64_tr_b16 a[14:15], v234 offset:16640
v_cvt_pk_bf16_f32 v33, v246, v247
v_lshlrev_b32 v248, 16, v34
v_and_b32 v249, s57, v34
v_lshlrev_b32 v250, 16, v35
v_and_b32 v251, s57, v35
v_fma_f32 v248, v248, v241, v242
s_waitcnt lgkmcnt(8)
v_mfma_f32_32x32x16_bf16 v[192:207], a[40:43], v[28:31], v[192:207]
buffer_load_dwordx4 v236, s[8:11], s59 offen offset:64 lds
s_add_u32 m0, s32, 1920
ds_read_b64_tr_b16 a[16:17], v234 offset:14336
ds_read_b64_tr_b16 a[18:19], v234 offset:14592
v_mfma_f32_32x32x16_bf16 v[208:223], a[44:47], v[28:31], v[208:223]
ds_read_b64_tr_b16 a[20:21], v234 offset:17408
ds_read_b64_tr_b16 a[22:23], v234 offset:17664
v_fma_f32 v249, v249, v241, v242
v_fma_f32 v250, v250, v241, v242
v_fma_f32 v251, v251, v241, v242
v_cvt_pk_bf16_f32 v34, v248, v249
v_cvt_pk_bf16_f32 v35, v250, v251
s_waitcnt lgkmcnt(8)
s_nop 0
v_mfma_f32_32x32x16_bf16 v[128:143], a[0:3], v[32:35], v[128:143]
buffer_load_dwordx4 v236, s[8:11], s59 offen offset:128 lds
s_add_u32 m0, s32, 3072
ds_read_b64_tr_b16 a[24:25], v234 offset:45056
ds_read_b64_tr_b16 a[26:27], v234 offset:45312
v_mfma_f32_32x32x16_bf16 v[144:159], a[4:7], v[32:35], v[144:159]
ds_read_b64_tr_b16 a[28:29], v234 offset:48128
ds_read_b64_tr_b16 a[30:31], v234 offset:48384
v_lshlrev_b32 v244, 16, v36
v_and_b32 v245, s57, v36
v_lshlrev_b32 v246, 16, v37
v_and_b32 v247, s57, v37
v_fma_f32 v244, v244, v241, v242
s_waitcnt lgkmcnt(8)
v_mfma_f32_32x32x16_bf16 v[160:175], a[8:11], v[32:35], v[160:175]
ds_read_b64_tr_b16 a[32:33], v234 offset:46080
ds_read_b64_tr_b16 a[34:35], v234 offset:46336
v_fma_f32 v245, v245, v241, v242
v_fma_f32 v246, v246, v241, v242
v_fma_f32 v247, v247, v241, v242
v_cvt_pk_bf16_f32 v36, v244, v245
v_cvt_pk_bf16_f32 v37, v246, v247
v_lshlrev_b32 v248, 16, v38
v_mfma_f32_32x32x16_bf16 v[176:191], a[12:15], v[32:35], v[176:191]
buffer_load_dwordx4 v236, s[12:15], s59 offen offset:0 lds
s_add_u32 m0, s32, 4032
ds_read_b64_tr_b16 a[36:37], v234 offset:49152
ds_read_b64_tr_b16 a[38:39], v234 offset:49408
s_waitcnt lgkmcnt(8)
v_mfma_f32_32x32x16_bf16 v[192:207], a[16:19], v[32:35], v[192:207]
ds_read_b64_tr_b16 a[40:41], v234 offset:47104
ds_read_b64_tr_b16 a[42:43], v234 offset:47360
v_and_b32 v249, s57, v38
v_lshlrev_b32 v250, 16, v39
v_and_b32 v251, s57, v39
v_fma_f32 v248, v248, v241, v242
v_fma_f32 v249, v249, v241, v242
v_fma_f32 v250, v250, v241, v242
v_mfma_f32_32x32x16_bf16 v[208:223], a[20:23], v[32:35], v[208:223]
ds_read_b64_tr_b16 a[44:45], v234 offset:50176
ds_read_b64_tr_b16 a[46:47], v234 offset:50432
v_fma_f32 v251, v251, v241, v242
v_cvt_pk_bf16_f32 v38, v248, v249
v_cvt_pk_bf16_f32 v39, v250, v251
s_waitcnt lgkmcnt(8)
s_nop 0
v_mfma_f32_32x32x16_bf16 v[128:143], a[24:27], v[36:39], v[128:143]
buffer_load_dwordx4 v236, s[12:15], s59 offen offset:64 lds
s_add_u32 m0, s32, 4992
ds_read_b64_tr_b16 a[0:1], v235 offset:12288
ds_read_b64_tr_b16 a[2:3], v235 offset:12544
v_mfma_f32_32x32x16_bf16 v[144:159], a[28:31], v[36:39], v[144:159]
ds_read_b64_tr_b16 a[4:5], v235 offset:15360
ds_read_b64_tr_b16 a[6:7], v235 offset:15616
v_lshlrev_b32 v244, 16, v40
v_and_b32 v245, s57, v40
v_lshlrev_b32 v246, 16, v41
v_and_b32 v247, s57, v41
v_fma_f32 v244, v244, v241, v242
s_waitcnt lgkmcnt(8)
v_mfma_f32_32x32x16_bf16 v[160:175], a[32:35], v[36:39], v[160:175]
ds_read_b64_tr_b16 a[8:9], v235 offset:13312
ds_read_b64_tr_b16 a[10:11], v235 offset:13568
v_fma_f32 v245, v245, v241, v242
v_fma_f32 v246, v246, v241, v242
v_fma_f32 v247, v247, v241, v242
v_cvt_pk_bf16_f32 v40, v244, v245
v_cvt_pk_bf16_f32 v41, v246, v247
v_lshlrev_b32 v248, 16, v42
v_mfma_f32_32x32x16_bf16 v[176:191], a[36:39], v[36:39], v[176:191]
buffer_load_dwordx4 v236, s[12:15], s59 offen offset:128 lds
ds_read_b64_tr_b16 a[12:13], v235 offset:16384
ds_read_b64_tr_b16 a[14:15], v235 offset:16640
s_waitcnt lgkmcnt(8)
v_mfma_f32_32x32x16_bf16 v[192:207], a[40:43], v[36:39], v[192:207]
ds_read_b64_tr_b16 a[16:17], v235 offset:14336
ds_read_b64_tr_b16 a[18:19], v235 offset:14592
v_and_b32 v249, s57, v42
v_lshlrev_b32 v250, 16, v43
v_and_b32 v251, s57, v43
v_fma_f32 v248, v248, v241, v242
v_fma_f32 v249, v249, v241, v242
v_fma_f32 v250, v250, v241, v242
v_mfma_f32_32x32x16_bf16 v[208:223], a[44:47], v[36:39], v[208:223]
ds_read_b64_tr_b16 a[20:21], v235 offset:17408
ds_read_b64_tr_b16 a[22:23], v235 offset:17664
v_fma_f32 v251, v251, v241, v242
v_cvt_pk_bf16_f32 v42, v248, v249
v_cvt_pk_bf16_f32 v43, v250, v251
s_waitcnt lgkmcnt(8)
s_nop 0
v_mfma_f32_32x32x16_bf16 v[128:143], a[0:3], v[40:43], v[128:143]
ds_read_b64_tr_b16 a[24:25], v235 offset:45056
ds_read_b64_tr_b16 a[26:27], v235 offset:45312
v_lshlrev_b32 v244, 16, v44
v_and_b32 v245, s57, v44
v_lshlrev_b32 v246, 16, v45
v_and_b32 v247, s57, v45
v_mfma_f32_32x32x16_bf16 v[144:159], a[4:7], v[40:43], v[144:159]
ds_read_b64_tr_b16 a[28:29], v235 offset:48128
ds_read_b64_tr_b16 a[30:31], v235 offset:48384
v_fma_f32 v244, v244, v241, v242
v_fma_f32 v245, v245, v241, v242
v_fma_f32 v246, v246, v241, v242
s_waitcnt lgkmcnt(8)
v_mfma_f32_32x32x16_bf16 v[160:175], a[8:11], v[40:43], v[160:175]
ds_read_b64_tr_b16 a[32:33], v235 offset:46080
ds_read_b64_tr_b16 a[34:35], v235 offset:46336
v_fma_f32 v247, v247, v241, v242
v_cvt_pk_bf16_f32 v44, v244, v245
v_cvt_pk_bf16_f32 v45, v246, v247
v_lshlrev_b32 v248, 16, v46
v_mfma_f32_32x32x16_bf16 v[176:191], a[12:15], v[40:43], v[176:191]
ds_read_b64_tr_b16 a[36:37], v235 offset:49152
ds_read_b64_tr_b16 a[38:39], v235 offset:49408
v_and_b32 v249, s57, v46
v_lshlrev_b32 v250, 16, v47
v_and_b32 v251, s57, v47
s_waitcnt lgkmcnt(8)
v_mfma_f32_32x32x16_bf16 v[192:207], a[16:19], v[40:43], v[192:207]
ds_read_b64_tr_b16 a[40:41], v235 offset:47104
ds_read_b64_tr_b16 a[42:43], v235 offset:47360
v_fma_f32 v248, v248, v241, v242
v_fma_f32 v249, v249, v241, v242
v_fma_f32 v250, v250, v241, v242
v_fma_f32 v251, v251, v241, v242
v_mfma_f32_32x32x16_bf16 v[208:223], a[20:23], v[40:43], v[208:223]
ds_read_b64_tr_b16 a[44:45], v235 offset:50176
ds_read_b64_tr_b16 a[46:47], v235 offset:50432
v_cvt_pk_bf16_f32 v46, v248, v249
v_cvt_pk_bf16_f32 v47, v250, v251
s_waitcnt vmcnt(13)
s_barrier
s_lshl_b32 s60, s30, 4
s_add_u32 s60, s60, s29
s_lshl_b32 s60, s60, 2
s_add_u32 s60, s60, 14680064
s_cmp_lg_u32 s28, 0
s_cbranch_scc1 L_parallel_sum__spectral_gfnet__glu_gated_reglu__prompt_kernel_flag_52
s_mov_b64 exec, 1
v_mov_b32 v237, 1
v_mov_b32 v238, 0
buffer_store_dword v237, v238, s[16:19], s60 offen sc1
s_mov_b64 exec, -1
L_parallel_sum__spectral_gfnet__glu_gated_reglu__prompt_kernel_flag_52:
s_waitcnt lgkmcnt(8)
v_mfma_f32_32x32x16_bf16 v[128:143], a[24:27], v[44:47], v[128:143]
s_add_u32 s59, s53, 6
s_and_b32 s59, s59, 7
s_add_u32 m0, s32, 6144
s_mul_i32 s59, s59, 176128
ds_read_b64_tr_b16 a[0:1], v234 offset:18432
ds_read_b64_tr_b16 a[2:3], v234 offset:18688
v_lshlrev_b32 v244, 16, v48
v_and_b32 v245, s57, v48
v_lshlrev_b32 v246, 16, v49
v_mfma_f32_32x32x16_bf16 v[144:159], a[28:31], v[44:47], v[144:159]
ds_read_b64_tr_b16 a[4:5], v234 offset:21504
ds_read_b64_tr_b16 a[6:7], v234 offset:21760
v_and_b32 v247, s57, v49
v_fma_f32 v244, v244, v241, v242
v_fma_f32 v245, v245, v241, v242
v_fma_f32 v246, v246, v241, v242
v_fma_f32 v247, v247, v241, v242
v_cvt_pk_bf16_f32 v48, v244, v245
s_waitcnt lgkmcnt(8)
v_mfma_f32_32x32x16_bf16 v[160:175], a[32:35], v[44:47], v[160:175]
buffer_load_dwordx4 v236, s[8:11], s59 offen offset:0 lds
s_add_u32 m0, s32, 7104
ds_read_b64_tr_b16 a[8:9], v234 offset:19456
ds_read_b64_tr_b16 a[10:11], v234 offset:19712
v_mfma_f32_32x32x16_bf16 v[176:191], a[36:39], v[44:47], v[176:191]
ds_read_b64_tr_b16 a[12:13], v234 offset:22528
ds_read_b64_tr_b16 a[14:15], v234 offset:22784
v_cvt_pk_bf16_f32 v49, v246, v247
v_lshlrev_b32 v248, 16, v50
v_and_b32 v249, s57, v50
v_lshlrev_b32 v250, 16, v51
v_and_b32 v251, s57, v51
v_fma_f32 v248, v248, v241, v242
s_waitcnt lgkmcnt(8)
v_mfma_f32_32x32x16_bf16 v[192:207], a[40:43], v[44:47], v[192:207]
buffer_load_dwordx4 v236, s[8:11], s59 offen offset:64 lds
s_add_u32 m0, s32, 8064
ds_read_b64_tr_b16 a[16:17], v234 offset:20480
ds_read_b64_tr_b16 a[18:19], v234 offset:20736
v_mfma_f32_32x32x16_bf16 v[208:223], a[44:47], v[44:47], v[208:223]
ds_read_b64_tr_b16 a[20:21], v234 offset:23552
ds_read_b64_tr_b16 a[22:23], v234 offset:23808
v_fma_f32 v249, v249, v241, v242
v_fma_f32 v250, v250, v241, v242
v_fma_f32 v251, v251, v241, v242
v_cvt_pk_bf16_f32 v50, v248, v249
v_cvt_pk_bf16_f32 v51, v250, v251
s_waitcnt lgkmcnt(8)
s_nop 0
v_mfma_f32_32x32x16_bf16 v[128:143], a[0:3], v[48:51], v[128:143]
buffer_load_dwordx4 v236, s[8:11], s59 offen offset:128 lds
s_add_u32 m0, s32, 9216
ds_read_b64_tr_b16 a[24:25], v234 offset:51200
ds_read_b64_tr_b16 a[26:27], v234 offset:51456
v_mfma_f32_32x32x16_bf16 v[144:159], a[4:7], v[48:51], v[144:159]
ds_read_b64_tr_b16 a[28:29], v234 offset:54272
ds_read_b64_tr_b16 a[30:31], v234 offset:54528
v_lshlrev_b32 v244, 16, v52
v_and_b32 v245, s57, v52
v_lshlrev_b32 v246, 16, v53
v_and_b32 v247, s57, v53
v_fma_f32 v244, v244, v241, v242
s_waitcnt lgkmcnt(8)
v_mfma_f32_32x32x16_bf16 v[160:175], a[8:11], v[48:51], v[160:175]
ds_read_b64_tr_b16 a[32:33], v234 offset:52224
ds_read_b64_tr_b16 a[34:35], v234 offset:52480
v_fma_f32 v245, v245, v241, v242
v_fma_f32 v246, v246, v241, v242
v_fma_f32 v247, v247, v241, v242
v_cvt_pk_bf16_f32 v52, v244, v245
v_cvt_pk_bf16_f32 v53, v246, v247
v_lshlrev_b32 v248, 16, v54
v_mfma_f32_32x32x16_bf16 v[176:191], a[12:15], v[48:51], v[176:191]
buffer_load_dwordx4 v236, s[12:15], s59 offen offset:0 lds
s_add_u32 m0, s32, 10176
ds_read_b64_tr_b16 a[36:37], v234 offset:55296
ds_read_b64_tr_b16 a[38:39], v234 offset:55552
s_waitcnt lgkmcnt(8)
v_mfma_f32_32x32x16_bf16 v[192:207], a[16:19], v[48:51], v[192:207]
ds_read_b64_tr_b16 a[40:41], v234 offset:53248
ds_read_b64_tr_b16 a[42:43], v234 offset:53504
v_and_b32 v249, s57, v54
v_lshlrev_b32 v250, 16, v55
v_and_b32 v251, s57, v55
v_fma_f32 v248, v248, v241, v242
v_fma_f32 v249, v249, v241, v242
v_fma_f32 v250, v250, v241, v242
v_mfma_f32_32x32x16_bf16 v[208:223], a[20:23], v[48:51], v[208:223]
ds_read_b64_tr_b16 a[44:45], v234 offset:56320
ds_read_b64_tr_b16 a[46:47], v234 offset:56576
v_fma_f32 v251, v251, v241, v242
v_cvt_pk_bf16_f32 v54, v248, v249
v_cvt_pk_bf16_f32 v55, v250, v251
s_waitcnt lgkmcnt(8)
s_nop 0
v_mfma_f32_32x32x16_bf16 v[128:143], a[24:27], v[52:55], v[128:143]
buffer_load_dwordx4 v236, s[12:15], s59 offen offset:64 lds
s_add_u32 m0, s32, 11136
ds_read_b64_tr_b16 a[0:1], v235 offset:18432
ds_read_b64_tr_b16 a[2:3], v235 offset:18688
v_mfma_f32_32x32x16_bf16 v[144:159], a[28:31], v[52:55], v[144:159]
ds_read_b64_tr_b16 a[4:5], v235 offset:21504
ds_read_b64_tr_b16 a[6:7], v235 offset:21760
v_lshlrev_b32 v244, 16, v56
v_and_b32 v245, s57, v56
v_lshlrev_b32 v246, 16, v57
v_and_b32 v247, s57, v57
v_fma_f32 v244, v244, v241, v242
s_waitcnt lgkmcnt(8)
v_mfma_f32_32x32x16_bf16 v[160:175], a[32:35], v[52:55], v[160:175]
ds_read_b64_tr_b16 a[8:9], v235 offset:19456
ds_read_b64_tr_b16 a[10:11], v235 offset:19712
v_fma_f32 v245, v245, v241, v242
v_fma_f32 v246, v246, v241, v242
v_fma_f32 v247, v247, v241, v242
v_cvt_pk_bf16_f32 v56, v244, v245
v_cvt_pk_bf16_f32 v57, v246, v247
v_lshlrev_b32 v248, 16, v58
v_mfma_f32_32x32x16_bf16 v[176:191], a[36:39], v[52:55], v[176:191]
buffer_load_dwordx4 v236, s[12:15], s59 offen offset:128 lds
ds_read_b64_tr_b16 a[12:13], v235 offset:22528
ds_read_b64_tr_b16 a[14:15], v235 offset:22784
s_waitcnt lgkmcnt(8)
v_mfma_f32_32x32x16_bf16 v[192:207], a[40:43], v[52:55], v[192:207]
ds_read_b64_tr_b16 a[16:17], v235 offset:20480
ds_read_b64_tr_b16 a[18:19], v235 offset:20736
v_and_b32 v249, s57, v58
v_lshlrev_b32 v250, 16, v59
v_and_b32 v251, s57, v59
v_fma_f32 v248, v248, v241, v242
v_fma_f32 v249, v249, v241, v242
v_fma_f32 v250, v250, v241, v242
v_mfma_f32_32x32x16_bf16 v[208:223], a[44:47], v[52:55], v[208:223]
ds_read_b64_tr_b16 a[20:21], v235 offset:23552
ds_read_b64_tr_b16 a[22:23], v235 offset:23808
v_fma_f32 v251, v251, v241, v242
v_cvt_pk_bf16_f32 v58, v248, v249
v_cvt_pk_bf16_f32 v59, v250, v251
s_waitcnt lgkmcnt(8)
s_nop 0
v_mfma_f32_32x32x16_bf16 v[128:143], a[0:3], v[56:59], v[128:143]
ds_read_b64_tr_b16 a[24:25], v235 offset:51200
ds_read_b64_tr_b16 a[26:27], v235 offset:51456
v_lshlrev_b32 v244, 16, v60
v_and_b32 v245, s57, v60
v_lshlrev_b32 v246, 16, v61
v_and_b32 v247, s57, v61
v_mfma_f32_32x32x16_bf16 v[144:159], a[4:7], v[56:59], v[144:159]
ds_read_b64_tr_b16 a[28:29], v235 offset:54272
ds_read_b64_tr_b16 a[30:31], v235 offset:54528
v_fma_f32 v244, v244, v241, v242
v_fma_f32 v245, v245, v241, v242
v_fma_f32 v246, v246, v241, v242
s_waitcnt lgkmcnt(8)
v_mfma_f32_32x32x16_bf16 v[160:175], a[8:11], v[56:59], v[160:175]
ds_read_b64_tr_b16 a[32:33], v235 offset:52224
ds_read_b64_tr_b16 a[34:35], v235 offset:52480
v_fma_f32 v247, v247, v241, v242
v_cvt_pk_bf16_f32 v60, v244, v245
v_cvt_pk_bf16_f32 v61, v246, v247
v_lshlrev_b32 v248, 16, v62
v_mfma_f32_32x32x16_bf16 v[176:191], a[12:15], v[56:59], v[176:191]
ds_read_b64_tr_b16 a[36:37], v235 offset:55296
ds_read_b64_tr_b16 a[38:39], v235 offset:55552
v_and_b32 v249, s57, v62
v_lshlrev_b32 v250, 16, v63
v_and_b32 v251, s57, v63
s_waitcnt lgkmcnt(8)
v_mfma_f32_32x32x16_bf16 v[192:207], a[16:19], v[56:59], v[192:207]
ds_read_b64_tr_b16 a[40:41], v235 offset:53248
ds_read_b64_tr_b16 a[42:43], v235 offset:53504
v_fma_f32 v248, v248, v241, v242
v_fma_f32 v249, v249, v241, v242
v_fma_f32 v250, v250, v241, v242
v_fma_f32 v251, v251, v241, v242
v_mfma_f32_32x32x16_bf16 v[208:223], a[20:23], v[56:59], v[208:223]
ds_read_b64_tr_b16 a[44:45], v235 offset:56320
ds_read_b64_tr_b16 a[46:47], v235 offset:56576
v_cvt_pk_bf16_f32 v62, v248, v249
v_cvt_pk_bf16_f32 v63, v250, v251
s_waitcnt vmcnt(13)
s_barrier
s_waitcnt lgkmcnt(8)
v_mfma_f32_32x32x16_bf16 v[128:143], a[24:27], v[60:63], v[128:143]
s_add_u32 s59, s53, 7
s_and_b32 s59, s59, 7
s_add_u32 m0, s32, 12288
s_mul_i32 s59, s59, 176128
ds_read_b64_tr_b16 a[0:1], v234 offset:24576
ds_read_b64_tr_b16 a[2:3], v234 offset:24832
v_lshlrev_b32 v244, 16, v64
v_and_b32 v245, s57, v64
v_lshlrev_b32 v246, 16, v65
v_mfma_f32_32x32x16_bf16 v[144:159], a[28:31], v[60:63], v[144:159]
ds_read_b64_tr_b16 a[4:5], v234 offset:27648
ds_read_b64_tr_b16 a[6:7], v234 offset:27904
v_and_b32 v247, s57, v65
v_fma_f32 v244, v244, v241, v242
v_fma_f32 v245, v245, v241, v242
v_fma_f32 v246, v246, v241, v242
v_fma_f32 v247, v247, v241, v242
v_cvt_pk_bf16_f32 v64, v244, v245
s_waitcnt lgkmcnt(8)
v_mfma_f32_32x32x16_bf16 v[160:175], a[32:35], v[60:63], v[160:175]
buffer_load_dwordx4 v236, s[8:11], s59 offen offset:0 lds
s_add_u32 m0, s32, 13248
ds_read_b64_tr_b16 a[8:9], v234 offset:25600
ds_read_b64_tr_b16 a[10:11], v234 offset:25856
v_mfma_f32_32x32x16_bf16 v[176:191], a[36:39], v[60:63], v[176:191]
ds_read_b64_tr_b16 a[12:13], v234 offset:28672
ds_read_b64_tr_b16 a[14:15], v234 offset:28928
v_cvt_pk_bf16_f32 v65, v246, v247
v_lshlrev_b32 v248, 16, v66
v_and_b32 v249, s57, v66
v_lshlrev_b32 v250, 16, v67
v_and_b32 v251, s57, v67
v_fma_f32 v248, v248, v241, v242
s_waitcnt lgkmcnt(8)
v_mfma_f32_32x32x16_bf16 v[192:207], a[40:43], v[60:63], v[192:207]
buffer_load_dwordx4 v236, s[8:11], s59 offen offset:64 lds
s_add_u32 m0, s32, 14208
ds_read_b64_tr_b16 a[16:17], v234 offset:26624
ds_read_b64_tr_b16 a[18:19], v234 offset:26880
v_mfma_f32_32x32x16_bf16 v[208:223], a[44:47], v[60:63], v[208:223]
ds_read_b64_tr_b16 a[20:21], v234 offset:29696
ds_read_b64_tr_b16 a[22:23], v234 offset:29952
v_fma_f32 v249, v249, v241, v242
v_fma_f32 v250, v250, v241, v242
v_fma_f32 v251, v251, v241, v242
v_cvt_pk_bf16_f32 v66, v248, v249
v_cvt_pk_bf16_f32 v67, v250, v251
s_waitcnt lgkmcnt(8)
s_nop 0
v_mfma_f32_32x32x16_bf16 v[128:143], a[0:3], v[64:67], v[128:143]
buffer_load_dwordx4 v236, s[8:11], s59 offen offset:128 lds
s_add_u32 m0, s32, 15360
ds_read_b64_tr_b16 a[24:25], v234 offset:57344
ds_read_b64_tr_b16 a[26:27], v234 offset:57600
v_mfma_f32_32x32x16_bf16 v[144:159], a[4:7], v[64:67], v[144:159]
ds_read_b64_tr_b16 a[28:29], v234 offset:60416
ds_read_b64_tr_b16 a[30:31], v234 offset:60672
v_lshlrev_b32 v244, 16, v68
v_and_b32 v245, s57, v68
v_lshlrev_b32 v246, 16, v69
v_and_b32 v247, s57, v69
v_fma_f32 v244, v244, v241, v242
s_waitcnt lgkmcnt(8)
v_mfma_f32_32x32x16_bf16 v[160:175], a[8:11], v[64:67], v[160:175]
ds_read_b64_tr_b16 a[32:33], v234 offset:58368
ds_read_b64_tr_b16 a[34:35], v234 offset:58624
v_fma_f32 v245, v245, v241, v242
v_fma_f32 v246, v246, v241, v242
v_fma_f32 v247, v247, v241, v242
v_cvt_pk_bf16_f32 v68, v244, v245
v_cvt_pk_bf16_f32 v69, v246, v247
v_lshlrev_b32 v248, 16, v70
v_mfma_f32_32x32x16_bf16 v[176:191], a[12:15], v[64:67], v[176:191]
buffer_load_dwordx4 v236, s[12:15], s59 offen offset:0 lds
s_add_u32 m0, s32, 16320
ds_read_b64_tr_b16 a[36:37], v234 offset:61440
ds_read_b64_tr_b16 a[38:39], v234 offset:61696
s_waitcnt lgkmcnt(8)
v_mfma_f32_32x32x16_bf16 v[192:207], a[16:19], v[64:67], v[192:207]
ds_read_b64_tr_b16 a[40:41], v234 offset:59392
ds_read_b64_tr_b16 a[42:43], v234 offset:59648
v_and_b32 v249, s57, v70
v_lshlrev_b32 v250, 16, v71
v_and_b32 v251, s57, v71
v_fma_f32 v248, v248, v241, v242
v_fma_f32 v249, v249, v241, v242
v_fma_f32 v250, v250, v241, v242
v_mfma_f32_32x32x16_bf16 v[208:223], a[20:23], v[64:67], v[208:223]
ds_read_b64_tr_b16 a[44:45], v234 offset:62464
ds_read_b64_tr_b16 a[46:47], v234 offset:62720
v_fma_f32 v251, v251, v241, v242
v_cvt_pk_bf16_f32 v70, v248, v249
v_cvt_pk_bf16_f32 v71, v250, v251
s_waitcnt lgkmcnt(8)
s_nop 0
v_mfma_f32_32x32x16_bf16 v[128:143], a[24:27], v[68:71], v[128:143]
buffer_load_dwordx4 v236, s[12:15], s59 offen offset:64 lds
s_add_u32 m0, s32, 17280
ds_read_b64_tr_b16 a[0:1], v235 offset:24576
ds_read_b64_tr_b16 a[2:3], v235 offset:24832
v_mfma_f32_32x32x16_bf16 v[144:159], a[28:31], v[68:71], v[144:159]
ds_read_b64_tr_b16 a[4:5], v235 offset:27648
ds_read_b64_tr_b16 a[6:7], v235 offset:27904
v_lshlrev_b32 v244, 16, v72
v_and_b32 v245, s57, v72
v_lshlrev_b32 v246, 16, v73
v_and_b32 v247, s57, v73
v_fma_f32 v244, v244, v241, v242
s_waitcnt lgkmcnt(8)
v_mfma_f32_32x32x16_bf16 v[160:175], a[32:35], v[68:71], v[160:175]
ds_read_b64_tr_b16 a[8:9], v235 offset:25600
ds_read_b64_tr_b16 a[10:11], v235 offset:25856
v_fma_f32 v245, v245, v241, v242
v_fma_f32 v246, v246, v241, v242
v_fma_f32 v247, v247, v241, v242
v_cvt_pk_bf16_f32 v72, v244, v245
v_cvt_pk_bf16_f32 v73, v246, v247
v_lshlrev_b32 v248, 16, v74
v_mfma_f32_32x32x16_bf16 v[176:191], a[36:39], v[68:71], v[176:191]
buffer_load_dwordx4 v236, s[12:15], s59 offen offset:128 lds
ds_read_b64_tr_b16 a[12:13], v235 offset:28672
ds_read_b64_tr_b16 a[14:15], v235 offset:28928
s_waitcnt lgkmcnt(8)
v_mfma_f32_32x32x16_bf16 v[192:207], a[40:43], v[68:71], v[192:207]
ds_read_b64_tr_b16 a[16:17], v235 offset:26624
ds_read_b64_tr_b16 a[18:19], v235 offset:26880
v_and_b32 v249, s57, v74
v_lshlrev_b32 v250, 16, v75
v_and_b32 v251, s57, v75
v_fma_f32 v248, v248, v241, v242
v_fma_f32 v249, v249, v241, v242
v_fma_f32 v250, v250, v241, v242
v_mfma_f32_32x32x16_bf16 v[208:223], a[44:47], v[68:71], v[208:223]
ds_read_b64_tr_b16 a[20:21], v235 offset:29696
ds_read_b64_tr_b16 a[22:23], v235 offset:29952
v_fma_f32 v251, v251, v241, v242
v_cvt_pk_bf16_f32 v74, v248, v249
v_cvt_pk_bf16_f32 v75, v250, v251
s_waitcnt lgkmcnt(8)
s_nop 0
v_mfma_f32_32x32x16_bf16 v[128:143], a[0:3], v[72:75], v[128:143]
ds_read_b64_tr_b16 a[24:25], v235 offset:57344
ds_read_b64_tr_b16 a[26:27], v235 offset:57600
v_lshlrev_b32 v244, 16, v76
v_and_b32 v245, s57, v76
v_lshlrev_b32 v246, 16, v77
v_and_b32 v247, s57, v77
v_mfma_f32_32x32x16_bf16 v[144:159], a[4:7], v[72:75], v[144:159]
ds_read_b64_tr_b16 a[28:29], v235 offset:60416
ds_read_b64_tr_b16 a[30:31], v235 offset:60672
v_fma_f32 v244, v244, v241, v242
v_fma_f32 v245, v245, v241, v242
v_fma_f32 v246, v246, v241, v242
s_waitcnt lgkmcnt(8)
v_mfma_f32_32x32x16_bf16 v[160:175], a[8:11], v[72:75], v[160:175]
ds_read_b64_tr_b16 a[32:33], v235 offset:58368
ds_read_b64_tr_b16 a[34:35], v235 offset:58624
v_fma_f32 v247, v247, v241, v242
v_cvt_pk_bf16_f32 v76, v244, v245
v_cvt_pk_bf16_f32 v77, v246, v247
v_lshlrev_b32 v248, 16, v78
v_mfma_f32_32x32x16_bf16 v[176:191], a[12:15], v[72:75], v[176:191]
ds_read_b64_tr_b16 a[36:37], v235 offset:61440
ds_read_b64_tr_b16 a[38:39], v235 offset:61696
v_and_b32 v249, s57, v78
v_lshlrev_b32 v250, 16, v79
v_and_b32 v251, s57, v79
s_waitcnt lgkmcnt(8)
v_mfma_f32_32x32x16_bf16 v[192:207], a[16:19], v[72:75], v[192:207]
ds_read_b64_tr_b16 a[40:41], v235 offset:59392
ds_read_b64_tr_b16 a[42:43], v235 offset:59648
v_fma_f32 v248, v248, v241, v242
v_fma_f32 v249, v249, v241, v242
v_fma_f32 v250, v250, v241, v242
v_fma_f32 v251, v251, v241, v242
v_mfma_f32_32x32x16_bf16 v[208:223], a[20:23], v[72:75], v[208:223]
ds_read_b64_tr_b16 a[44:45], v235 offset:62464
ds_read_b64_tr_b16 a[46:47], v235 offset:62720
v_cvt_pk_bf16_f32 v78, v248, v249
v_cvt_pk_bf16_f32 v79, v250, v251
s_waitcnt vmcnt(12)
s_barrier
v_and_b32 v243, 3, v224
v_lshlrev_b32 v243, 6, v243
s_cmp_lg_u32 s28, 0
s_cbranch_scc1 L_parallel_sum__spectral_gfnet__glu_gated_reglu__prompt_kernel_w0i_53
global_load_dword v255, v243, s[72:73] sc1
L_parallel_sum__spectral_gfnet__glu_gated_reglu__prompt_kernel_w0i_53:
s_waitcnt lgkmcnt(8)
v_mfma_f32_32x32x16_bf16 v[128:143], a[24:27], v[76:79], v[128:143]
s_and_b32 s34, s2, 7
s_lshr_b32 s35, s2, 3
ds_read_b64_tr_b16 a[0:1], v234 offset:0
ds_read_b64_tr_b16 a[2:3], v234 offset:256
v_lshlrev_b32 v244, 16, v80
v_and_b32 v245, s57, v80
v_lshlrev_b32 v246, 16, v81
v_mfma_f32_32x32x16_bf16 v[144:159], a[28:31], v[76:79], v[144:159]
s_lshl_b32 s76, s34, 2
ds_read_b64_tr_b16 a[4:5], v234 offset:3072
ds_read_b64_tr_b16 a[6:7], v234 offset:3328
v_and_b32 v247, s57, v81
v_fma_f32 v244, v244, v241, v242
v_fma_f32 v245, v245, v241, v242
s_waitcnt lgkmcnt(8)
v_mfma_f32_32x32x16_bf16 v[160:175], a[32:35], v[76:79], v[160:175]
s_and_b32 s34, s35, 3
s_add_u32 s76, s76, s34
ds_read_b64_tr_b16 a[8:9], v234 offset:1024
ds_read_b64_tr_b16 a[10:11], v234 offset:1280
v_fma_f32 v246, v246, v241, v242
v_fma_f32 v247, v247, v241, v242
v_cvt_pk_bf16_f32 v80, v244, v245
v_mfma_f32_32x32x16_bf16 v[176:191], a[36:39], v[76:79], v[176:191]
s_lshr_b32 s77, s35, 2
ds_read_b64_tr_b16 a[12:13], v234 offset:4096
ds_read_b64_tr_b16 a[14:15], v234 offset:4352
v_cvt_pk_bf16_f32 v81, v246, v247
v_lshlrev_b32 v248, 16, v82
v_and_b32 v249, s57, v82
s_waitcnt lgkmcnt(8)
v_mfma_f32_32x32x16_bf16 v[192:207], a[40:43], v[76:79], v[192:207]
s_lshl_b32 s51, s28, 13
s_add_u32 s51, s51, 131072
ds_read_b64_tr_b16 a[16:17], v234 offset:2048
ds_read_b64_tr_b16 a[18:19], v234 offset:2304
v_lshlrev_b32 v250, 16, v83
v_and_b32 v251, s57, v83
v_fma_f32 v248, v248, v241, v242
v_mfma_f32_32x32x16_bf16 v[208:223], a[44:47], v[76:79], v[208:223]
s_mul_i32 s52, s28, 360448
ds_read_b64_tr_b16 a[20:21], v234 offset:5120
ds_read_b64_tr_b16 a[22:23], v234 offset:5376
v_fma_f32 v249, v249, v241, v242
v_fma_f32 v250, v250, v241, v242
v_fma_f32 v251, v251, v241, v242
v_cvt_pk_bf16_f32 v82, v248, v249
v_cvt_pk_bf16_f32 v83, v250, v251
s_waitcnt lgkmcnt(8)
s_nop 0
v_mfma_f32_32x32x16_bf16 v[128:143], a[0:3], v[80:83], v[128:143]
v_lshrrev_b32 v225, 3, v224
v_and_b32 v226, 7, v224
ds_read_b64_tr_b16 a[24:25], v234 offset:32768
ds_read_b64_tr_b16 a[26:27], v234 offset:33024
v_lshlrev_b32 v244, 16, v84
v_and_b32 v245, s57, v84
v_lshlrev_b32 v246, 16, v85
v_mfma_f32_32x32x16_bf16 v[144:159], a[4:7], v[80:83], v[144:159]
v_bfe_u32 v227, v224, 4, 1
v_lshlrev_b32 v227, 2, v227
ds_read_b64_tr_b16 a[28:29], v234 offset:35840
ds_read_b64_tr_b16 a[30:31], v234 offset:36096
v_and_b32 v247, s57, v85
v_fma_f32 v244, v244, v241, v242
s_waitcnt lgkmcnt(8)
v_mfma_f32_32x32x16_bf16 v[160:175], a[8:11], v[80:83], v[160:175]
v_xor_b32 v226, v226, v227
ds_read_b64_tr_b16 a[32:33], v234 offset:33792
ds_read_b64_tr_b16 a[34:35], v234 offset:34048
v_fma_f32 v245, v245, v241, v242
v_fma_f32 v246, v246, v241, v242
v_fma_f32 v247, v247, v241, v242
v_cvt_pk_bf16_f32 v84, v244, v245
v_mfma_f32_32x32x16_bf16 v[176:191], a[12:15], v[80:83], v[176:191]
v_lshlrev_b32 v226, 4, v226
s_lshl_b32 s34, s77, 7
ds_read_b64_tr_b16 a[36:37], v234 offset:36864
ds_read_b64_tr_b16 a[38:39], v234 offset:37120
v_cvt_pk_bf16_f32 v85, v246, v247
v_lshlrev_b32 v248, 16, v86
s_waitcnt lgkmcnt(8)
v_mfma_f32_32x32x16_bf16 v[192:207], a[16:19], v[80:83], v[192:207]
v_lshlrev_b32 v225, 10, v225
v_add3_u32 v230, v225, v226, s34
ds_read_b64_tr_b16 a[40:41], v234 offset:34816
ds_read_b64_tr_b16 a[42:43], v234 offset:35072
v_and_b32 v249, s57, v86
v_lshlrev_b32 v250, 16, v87
v_and_b32 v251, s57, v87
v_mfma_f32_32x32x16_bf16 v[208:223], a[20:23], v[80:83], v[208:223]
v_add_u32 v231, 7168, v230
ds_read_b64_tr_b16 a[44:45], v234 offset:37888
ds_read_b64_tr_b16 a[46:47], v234 offset:38144
v_fma_f32 v248, v248, v241, v242
v_fma_f32 v249, v249, v241, v242
v_fma_f32 v250, v250, v241, v242
v_fma_f32 v251, v251, v241, v242
v_cvt_pk_bf16_f32 v86, v248, v249
v_cvt_pk_bf16_f32 v87, v250, v251
s_waitcnt lgkmcnt(8)
s_nop 0
v_mfma_f32_32x32x16_bf16 v[128:143], a[24:27], v[84:87], v[128:143]
ds_read_b64_tr_b16 a[0:1], v235 offset:0
ds_read_b64_tr_b16 a[2:3], v235 offset:256
v_lshlrev_b32 v244, 16, v88
v_and_b32 v245, s57, v88
v_lshlrev_b32 v246, 16, v89
v_and_b32 v247, s57, v89
v_mfma_f32_32x32x16_bf16 v[144:159], a[28:31], v[84:87], v[144:159]
ds_read_b64_tr_b16 a[4:5], v235 offset:3072
ds_read_b64_tr_b16 a[6:7], v235 offset:3328
v_fma_f32 v244, v244, v241, v242
v_fma_f32 v245, v245, v241, v242
v_fma_f32 v246, v246, v241, v242
s_waitcnt lgkmcnt(8)
v_mfma_f32_32x32x16_bf16 v[160:175], a[32:35], v[84:87], v[160:175]
ds_read_b64_tr_b16 a[8:9], v235 offset:1024
ds_read_b64_tr_b16 a[10:11], v235 offset:1280
v_fma_f32 v247, v247, v241, v242
v_cvt_pk_bf16_f32 v88, v244, v245
v_cvt_pk_bf16_f32 v89, v246, v247
v_lshlrev_b32 v248, 16, v90
v_mfma_f32_32x32x16_bf16 v[176:191], a[36:39], v[84:87], v[176:191]
ds_read_b64_tr_b16 a[12:13], v235 offset:4096
ds_read_b64_tr_b16 a[14:15], v235 offset:4352
v_and_b32 v249, s57, v90
v_lshlrev_b32 v250, 16, v91
v_and_b32 v251, s57, v91
s_waitcnt lgkmcnt(8)
v_mfma_f32_32x32x16_bf16 v[192:207], a[40:43], v[84:87], v[192:207]
ds_read_b64_tr_b16 a[16:17], v235 offset:2048
ds_read_b64_tr_b16 a[18:19], v235 offset:2304
v_fma_f32 v248, v248, v241, v242
v_fma_f32 v249, v249, v241, v242
v_fma_f32 v250, v250, v241, v242
v_fma_f32 v251, v251, v241, v242
v_mfma_f32_32x32x16_bf16 v[208:223], a[44:47], v[84:87], v[208:223]
ds_read_b64_tr_b16 a[20:21], v235 offset:5120
ds_read_b64_tr_b16 a[22:23], v235 offset:5376
v_cvt_pk_bf16_f32 v90, v248, v249
v_cvt_pk_bf16_f32 v91, v250, v251
s_waitcnt lgkmcnt(8)
s_nop 0
v_mfma_f32_32x32x16_bf16 v[128:143], a[0:3], v[88:91], v[128:143]
s_add_u32 m0, s51, 0
s_add_u32 s49, s52, 0
buffer_load_dwordx4 v230, s[64:67], s49 offen lds
ds_read_b64_tr_b16 a[24:25], v235 offset:32768
ds_read_b64_tr_b16 a[26:27], v235 offset:33024
v_mfma_f32_32x32x16_bf16 v[144:159], a[4:7], v[88:91], v[144:159]
ds_read_b64_tr_b16 a[28:29], v235 offset:35840
ds_read_b64_tr_b16 a[30:31], v235 offset:36096
v_lshlrev_b32 v244, 16, v92
v_and_b32 v245, s57, v92
v_lshlrev_b32 v246, 16, v93
v_and_b32 v247, s57, v93
s_waitcnt lgkmcnt(8)
v_mfma_f32_32x32x16_bf16 v[160:175], a[8:11], v[88:91], v[160:175]
ds_read_b64_tr_b16 a[32:33], v235 offset:33792
ds_read_b64_tr_b16 a[34:35], v235 offset:34048
v_fma_f32 v244, v244, v241, v242
v_fma_f32 v245, v245, v241, v242
v_fma_f32 v246, v246, v241, v242
v_fma_f32 v247, v247, v241, v242
v_cvt_pk_bf16_f32 v92, v244, v245
v_mfma_f32_32x32x16_bf16 v[176:191], a[12:15], v[88:91], v[176:191]
ds_read_b64_tr_b16 a[36:37], v235 offset:36864
ds_read_b64_tr_b16 a[38:39], v235 offset:37120
v_cvt_pk_bf16_f32 v93, v246, v247
v_lshlrev_b32 v248, 16, v94
v_and_b32 v249, s57, v94
v_lshlrev_b32 v250, 16, v95
s_waitcnt lgkmcnt(8)
v_mfma_f32_32x32x16_bf16 v[192:207], a[16:19], v[88:91], v[192:207]
ds_read_b64_tr_b16 a[40:41], v235 offset:34816
ds_read_b64_tr_b16 a[42:43], v235 offset:35072
v_and_b32 v251, s57, v95
v_fma_f32 v248, v248, v241, v242
v_fma_f32 v249, v249, v241, v242
v_fma_f32 v250, v250, v241, v242
v_fma_f32 v251, v251, v241, v242
v_mfma_f32_32x32x16_bf16 v[208:223], a[20:23], v[88:91], v[208:223]
ds_read_b64_tr_b16 a[44:45], v235 offset:37888
ds_read_b64_tr_b16 a[46:47], v235 offset:38144
v_cvt_pk_bf16_f32 v94, v248, v249
v_cvt_pk_bf16_f32 v95, v250, v251
s_waitcnt vmcnt(7)
s_cmp_lg_u32 s28, 0
s_cbranch_scc1 L_parallel_sum__spectral_gfnet__glu_gated_reglu__prompt_kernel_w0c_54
s_waitcnt vmcnt(1)
v_cmp_eq_u32 vcc, 64, v255
s_nop 4
s_cmp_eq_u64 vcc, exec
s_cbranch_scc1 L_parallel_sum__spectral_gfnet__glu_gated_reglu__prompt_kernel_clrok_55
s_mov_b32 s56, 0
L_parallel_sum__spectral_gfnet__glu_gated_reglu__prompt_kernel_clr_56:
global_load_dword v255, v243, s[72:73] sc1
s_waitcnt vmcnt(0)
v_cmp_eq_u32 vcc, 64, v255
s_nop 4
s_cmp_eq_u64 vcc, exec
s_cbranch_scc1 L_parallel_sum__spectral_gfnet__glu_gated_reglu__prompt_kernel_clrd_57
s_add_u32 s56, s56, 1
s_cmp_gt_u32 s56, 40000
s_cbranch_scc1 L_parallel_sum__spectral_gfnet__glu_gated_reglu__prompt_kernel_clrd_57
s_sleep 4
s_branch L_parallel_sum__spectral_gfnet__glu_gated_reglu__prompt_kernel_clr_56
L_parallel_sum__spectral_gfnet__glu_gated_reglu__prompt_kernel_clrd_57:
L_parallel_sum__spectral_gfnet__glu_gated_reglu__prompt_kernel_clrok_55:
L_parallel_sum__spectral_gfnet__glu_gated_reglu__prompt_kernel_w0c_54:
s_barrier
s_waitcnt lgkmcnt(8)
v_mfma_f32_32x32x16_bf16 v[128:143], a[24:27], v[92:95], v[128:143]
buffer_load_dwordx4 v231, s[64:67], s49 offen offset:1024 lds
ds_read_b64_tr_b16 a[0:1], v234 offset:6144
ds_read_b64_tr_b16 a[2:3], v234 offset:6400
v_mfma_f32_32x32x16_bf16 v[144:159], a[28:31], v[92:95], v[144:159]
ds_read_b64_tr_b16 a[4:5], v234 offset:9216
ds_read_b64_tr_b16 a[6:7], v234 offset:9472
v_lshlrev_b32 v244, 16, v96
v_and_b32 v245, s57, v96
v_lshlrev_b32 v246, 16, v97
v_and_b32 v247, s57, v97
s_waitcnt lgkmcnt(8)
v_mfma_f32_32x32x16_bf16 v[160:175], a[32:35], v[92:95], v[160:175]
ds_read_b64_tr_b16 a[8:9], v234 offset:7168
ds_read_b64_tr_b16 a[10:11], v234 offset:7424
v_fma_f32 v244, v244, v241, v242
v_fma_f32 v245, v245, v241, v242
v_fma_f32 v246, v246, v241, v242
v_fma_f32 v247, v247, v241, v242
v_cvt_pk_bf16_f32 v96, v244, v245
v_mfma_f32_32x32x16_bf16 v[176:191], a[36:39], v[92:95], v[176:191]
ds_read_b64_tr_b16 a[12:13], v234 offset:10240
ds_read_b64_tr_b16 a[14:15], v234 offset:10496
v_cvt_pk_bf16_f32 v97, v246, v247
v_lshlrev_b32 v248, 16, v98
v_and_b32 v249, s57, v98
v_lshlrev_b32 v250, 16, v99
s_waitcnt lgkmcnt(8)
v_mfma_f32_32x32x16_bf16 v[192:207], a[40:43], v[92:95], v[192:207]
ds_read_b64_tr_b16 a[16:17], v234 offset:8192
ds_read_b64_tr_b16 a[18:19], v234 offset:8448
v_and_b32 v251, s57, v99
v_fma_f32 v248, v248, v241, v242
v_fma_f32 v249, v249, v241, v242
v_fma_f32 v250, v250, v241, v242
v_fma_f32 v251, v251, v241, v242
v_mfma_f32_32x32x16_bf16 v[208:223], a[44:47], v[92:95], v[208:223]
ds_read_b64_tr_b16 a[20:21], v234 offset:11264
ds_read_b64_tr_b16 a[22:23], v234 offset:11520
v_cvt_pk_bf16_f32 v98, v248, v249
v_cvt_pk_bf16_f32 v99, v250, v251
s_waitcnt lgkmcnt(8)
s_nop 0
v_mfma_f32_32x32x16_bf16 v[128:143], a[0:3], v[96:99], v[128:143]
s_add_u32 m0, s51, 2048
s_add_u32 s49, s52, 16384
buffer_load_dwordx4 v230, s[64:67], s49 offen lds
ds_read_b64_tr_b16 a[24:25], v234 offset:38912
ds_read_b64_tr_b16 a[26:27], v234 offset:39168
v_mfma_f32_32x32x16_bf16 v[144:159], a[4:7], v[96:99], v[144:159]
ds_read_b64_tr_b16 a[28:29], v234 offset:41984
ds_read_b64_tr_b16 a[30:31], v234 offset:42240
v_lshlrev_b32 v244, 16, v100
v_and_b32 v245, s57, v100
v_lshlrev_b32 v246, 16, v101
v_and_b32 v247, s57, v101
s_waitcnt lgkmcnt(8)
v_mfma_f32_32x32x16_bf16 v[160:175], a[8:11], v[96:99], v[160:175]
ds_read_b64_tr_b16 a[32:33], v234 offset:39936
ds_read_b64_tr_b16 a[34:35], v234 offset:40192
v_fma_f32 v244, v244, v241, v242
v_fma_f32 v245, v245, v241, v242
v_fma_f32 v246, v246, v241, v242
v_fma_f32 v247, v247, v241, v242
v_cvt_pk_bf16_f32 v100, v244, v245
v_mfma_f32_32x32x16_bf16 v[176:191], a[12:15], v[96:99], v[176:191]
ds_read_b64_tr_b16 a[36:37], v234 offset:43008
ds_read_b64_tr_b16 a[38:39], v234 offset:43264
v_cvt_pk_bf16_f32 v101, v246, v247
v_lshlrev_b32 v248, 16, v102
v_and_b32 v249, s57, v102
v_lshlrev_b32 v250, 16, v103
s_waitcnt lgkmcnt(8)
v_mfma_f32_32x32x16_bf16 v[192:207], a[16:19], v[96:99], v[192:207]
ds_read_b64_tr_b16 a[40:41], v234 offset:40960
ds_read_b64_tr_b16 a[42:43], v234 offset:41216
v_and_b32 v251, s57, v103
v_fma_f32 v248, v248, v241, v242
v_fma_f32 v249, v249, v241, v242
v_fma_f32 v250, v250, v241, v242
v_fma_f32 v251, v251, v241, v242
v_mfma_f32_32x32x16_bf16 v[208:223], a[20:23], v[96:99], v[208:223]
ds_read_b64_tr_b16 a[44:45], v234 offset:44032
ds_read_b64_tr_b16 a[46:47], v234 offset:44288
v_cvt_pk_bf16_f32 v102, v248, v249
v_cvt_pk_bf16_f32 v103, v250, v251
s_waitcnt lgkmcnt(8)
s_nop 0
v_mfma_f32_32x32x16_bf16 v[128:143], a[24:27], v[100:103], v[128:143]
buffer_load_dwordx4 v231, s[64:67], s49 offen offset:1024 lds
ds_read_b64_tr_b16 a[0:1], v235 offset:6144
ds_read_b64_tr_b16 a[2:3], v235 offset:6400
v_mfma_f32_32x32x16_bf16 v[144:159], a[28:31], v[100:103], v[144:159]
ds_read_b64_tr_b16 a[4:5], v235 offset:9216
ds_read_b64_tr_b16 a[6:7], v235 offset:9472
v_lshlrev_b32 v244, 16, v104
v_and_b32 v245, s57, v104
v_lshlrev_b32 v246, 16, v105
v_and_b32 v247, s57, v105
s_waitcnt lgkmcnt(8)
v_mfma_f32_32x32x16_bf16 v[160:175], a[32:35], v[100:103], v[160:175]
ds_read_b64_tr_b16 a[8:9], v235 offset:7168
ds_read_b64_tr_b16 a[10:11], v235 offset:7424
v_fma_f32 v244, v244, v241, v242
v_fma_f32 v245, v245, v241, v242
v_fma_f32 v246, v246, v241, v242
v_fma_f32 v247, v247, v241, v242
v_cvt_pk_bf16_f32 v104, v244, v245
v_mfma_f32_32x32x16_bf16 v[176:191], a[36:39], v[100:103], v[176:191]
ds_read_b64_tr_b16 a[12:13], v235 offset:10240
ds_read_b64_tr_b16 a[14:15], v235 offset:10496
v_cvt_pk_bf16_f32 v105, v246, v247
v_lshlrev_b32 v248, 16, v106
v_and_b32 v249, s57, v106
v_lshlrev_b32 v250, 16, v107
s_waitcnt lgkmcnt(8)
v_mfma_f32_32x32x16_bf16 v[192:207], a[40:43], v[100:103], v[192:207]
ds_read_b64_tr_b16 a[16:17], v235 offset:8192
ds_read_b64_tr_b16 a[18:19], v235 offset:8448
v_and_b32 v251, s57, v107
v_fma_f32 v248, v248, v241, v242
v_fma_f32 v249, v249, v241, v242
v_fma_f32 v250, v250, v241, v242
v_fma_f32 v251, v251, v241, v242
v_mfma_f32_32x32x16_bf16 v[208:223], a[44:47], v[100:103], v[208:223]
ds_read_b64_tr_b16 a[20:21], v235 offset:11264
ds_read_b64_tr_b16 a[22:23], v235 offset:11520
v_cvt_pk_bf16_f32 v106, v248, v249
v_cvt_pk_bf16_f32 v107, v250, v251
s_waitcnt lgkmcnt(8)
s_nop 0
v_mfma_f32_32x32x16_bf16 v[128:143], a[0:3], v[104:107], v[128:143]
s_add_u32 m0, s51, 4096
s_add_u32 s49, s52, 32768
buffer_load_dwordx4 v230, s[64:67], s49 offen lds
ds_read_b64_tr_b16 a[24:25], v235 offset:38912
ds_read_b64_tr_b16 a[26:27], v235 offset:39168
v_mfma_f32_32x32x16_bf16 v[144:159], a[4:7], v[104:107], v[144:159]
ds_read_b64_tr_b16 a[28:29], v235 offset:41984
ds_read_b64_tr_b16 a[30:31], v235 offset:42240
v_lshlrev_b32 v244, 16, v108
v_and_b32 v245, s57, v108
v_lshlrev_b32 v246, 16, v109
v_and_b32 v247, s57, v109
s_waitcnt lgkmcnt(8)
v_mfma_f32_32x32x16_bf16 v[160:175], a[8:11], v[104:107], v[160:175]
ds_read_b64_tr_b16 a[32:33], v235 offset:39936
ds_read_b64_tr_b16 a[34:35], v235 offset:40192
v_fma_f32 v244, v244, v241, v242
v_fma_f32 v245, v245, v241, v242
v_fma_f32 v246, v246, v241, v242
v_fma_f32 v247, v247, v241, v242
v_cvt_pk_bf16_f32 v108, v244, v245
v_mfma_f32_32x32x16_bf16 v[176:191], a[12:15], v[104:107], v[176:191]
ds_read_b64_tr_b16 a[36:37], v235 offset:43008
ds_read_b64_tr_b16 a[38:39], v235 offset:43264
v_cvt_pk_bf16_f32 v109, v246, v247
v_lshlrev_b32 v248, 16, v110
v_and_b32 v249, s57, v110
v_lshlrev_b32 v250, 16, v111
s_waitcnt lgkmcnt(8)
v_mfma_f32_32x32x16_bf16 v[192:207], a[16:19], v[104:107], v[192:207]
ds_read_b64_tr_b16 a[40:41], v235 offset:40960
ds_read_b64_tr_b16 a[42:43], v235 offset:41216
v_and_b32 v251, s57, v111
v_fma_f32 v248, v248, v241, v242
v_fma_f32 v249, v249, v241, v242
v_fma_f32 v250, v250, v241, v242
v_fma_f32 v251, v251, v241, v242
v_mfma_f32_32x32x16_bf16 v[208:223], a[20:23], v[104:107], v[208:223]
ds_read_b64_tr_b16 a[44:45], v235 offset:44032
ds_read_b64_tr_b16 a[46:47], v235 offset:44288
v_cvt_pk_bf16_f32 v110, v248, v249
v_cvt_pk_bf16_f32 v111, v250, v251
s_waitcnt vmcnt(5)
s_barrier
s_waitcnt lgkmcnt(8)
v_mfma_f32_32x32x16_bf16 v[128:143], a[24:27], v[108:111], v[128:143]
buffer_load_dwordx4 v231, s[64:67], s49 offen offset:1024 lds
ds_read_b64_tr_b16 a[0:1], v234 offset:12288
ds_read_b64_tr_b16 a[2:3], v234 offset:12544
v_mfma_f32_32x32x16_bf16 v[144:159], a[28:31], v[108:111], v[144:159]
ds_read_b64_tr_b16 a[4:5], v234 offset:15360
ds_read_b64_tr_b16 a[6:7], v234 offset:15616
v_lshlrev_b32 v244, 16, v112
v_and_b32 v245, s57, v112
v_lshlrev_b32 v246, 16, v113
v_and_b32 v247, s57, v113
s_waitcnt lgkmcnt(8)
v_mfma_f32_32x32x16_bf16 v[160:175], a[32:35], v[108:111], v[160:175]
ds_read_b64_tr_b16 a[8:9], v234 offset:13312
ds_read_b64_tr_b16 a[10:11], v234 offset:13568
v_fma_f32 v244, v244, v241, v242
v_fma_f32 v245, v245, v241, v242
v_fma_f32 v246, v246, v241, v242
v_fma_f32 v247, v247, v241, v242
v_cvt_pk_bf16_f32 v112, v244, v245
v_mfma_f32_32x32x16_bf16 v[176:191], a[36:39], v[108:111], v[176:191]
ds_read_b64_tr_b16 a[12:13], v234 offset:16384
ds_read_b64_tr_b16 a[14:15], v234 offset:16640
v_cvt_pk_bf16_f32 v113, v246, v247
v_lshlrev_b32 v248, 16, v114
v_and_b32 v249, s57, v114
v_lshlrev_b32 v250, 16, v115
s_waitcnt lgkmcnt(8)
v_mfma_f32_32x32x16_bf16 v[192:207], a[40:43], v[108:111], v[192:207]
ds_read_b64_tr_b16 a[16:17], v234 offset:14336
ds_read_b64_tr_b16 a[18:19], v234 offset:14592
v_and_b32 v251, s57, v115
v_fma_f32 v248, v248, v241, v242
v_fma_f32 v249, v249, v241, v242
v_fma_f32 v250, v250, v241, v242
v_fma_f32 v251, v251, v241, v242
v_mfma_f32_32x32x16_bf16 v[208:223], a[44:47], v[108:111], v[208:223]
ds_read_b64_tr_b16 a[20:21], v234 offset:17408
ds_read_b64_tr_b16 a[22:23], v234 offset:17664
v_cvt_pk_bf16_f32 v114, v248, v249
v_cvt_pk_bf16_f32 v115, v250, v251
s_lshr_b32 s42, s75, 4
s_cmp_eq_u32 s75, 256
s_cselect_b32 s42, 0, s42
s_lshl_b32 s42, s42, 6
s_add_u32 s42, s42, 14680064
v_and_b32 v25, 15, v224
v_lshlrev_b32 v25, 2, v25
s_cmp_lg_u32 s28, 0
s_cbranch_scc1 L_parallel_sum__spectral_gfnet__glu_gated_reglu__prompt_kernel_w0i_58
buffer_load_dword v24, v25, s[16:19], s42 offen sc1
L_parallel_sum__spectral_gfnet__glu_gated_reglu__prompt_kernel_w0i_58:
s_waitcnt lgkmcnt(8)
v_mfma_f32_32x32x16_bf16 v[128:143], a[0:3], v[112:115], v[128:143]
s_add_u32 m0, s51, 6144
s_add_u32 s49, s52, 49152
buffer_load_dwordx4 v230, s[64:67], s49 offen lds
ds_read_b64_tr_b16 a[24:25], v234 offset:45056
ds_read_b64_tr_b16 a[26:27], v234 offset:45312
v_mfma_f32_32x32x16_bf16 v[144:159], a[4:7], v[112:115], v[144:159]
ds_read_b64_tr_b16 a[28:29], v234 offset:48128
ds_read_b64_tr_b16 a[30:31], v234 offset:48384
v_lshlrev_b32 v244, 16, v116
v_and_b32 v245, s57, v116
v_lshlrev_b32 v246, 16, v117
v_and_b32 v247, s57, v117
s_waitcnt lgkmcnt(8)
v_mfma_f32_32x32x16_bf16 v[160:175], a[8:11], v[112:115], v[160:175]
ds_read_b64_tr_b16 a[32:33], v234 offset:46080
ds_read_b64_tr_b16 a[34:35], v234 offset:46336
v_fma_f32 v244, v244, v241, v242
v_fma_f32 v245, v245, v241, v242
v_fma_f32 v246, v246, v241, v242
v_fma_f32 v247, v247, v241, v242
v_cvt_pk_bf16_f32 v116, v244, v245
v_mfma_f32_32x32x16_bf16 v[176:191], a[12:15], v[112:115], v[176:191]
ds_read_b64_tr_b16 a[36:37], v234 offset:49152
ds_read_b64_tr_b16 a[38:39], v234 offset:49408
v_cvt_pk_bf16_f32 v117, v246, v247
v_lshlrev_b32 v248, 16, v118
v_and_b32 v249, s57, v118
v_lshlrev_b32 v250, 16, v119
s_waitcnt lgkmcnt(8)
v_mfma_f32_32x32x16_bf16 v[192:207], a[16:19], v[112:115], v[192:207]
ds_read_b64_tr_b16 a[40:41], v234 offset:47104
ds_read_b64_tr_b16 a[42:43], v234 offset:47360
v_and_b32 v251, s57, v119
v_fma_f32 v248, v248, v241, v242
v_fma_f32 v249, v249, v241, v242
v_fma_f32 v250, v250, v241, v242
v_fma_f32 v251, v251, v241, v242
v_mfma_f32_32x32x16_bf16 v[208:223], a[20:23], v[112:115], v[208:223]
ds_read_b64_tr_b16 a[44:45], v234 offset:50176
ds_read_b64_tr_b16 a[46:47], v234 offset:50432
v_cvt_pk_bf16_f32 v118, v248, v249
v_cvt_pk_bf16_f32 v119, v250, v251
s_waitcnt lgkmcnt(8)
s_nop 0
v_mfma_f32_32x32x16_bf16 v[128:143], a[24:27], v[116:119], v[128:143]
buffer_load_dwordx4 v231, s[64:67], s49 offen offset:1024 lds
ds_read_b64_tr_b16 a[0:1], v235 offset:12288
ds_read_b64_tr_b16 a[2:3], v235 offset:12544
v_mfma_f32_32x32x16_bf16 v[144:159], a[28:31], v[116:119], v[144:159]
ds_read_b64_tr_b16 a[4:5], v235 offset:15360
ds_read_b64_tr_b16 a[6:7], v235 offset:15616
v_lshlrev_b32 v244, 16, v120
v_and_b32 v245, s57, v120
v_lshlrev_b32 v246, 16, v121
v_and_b32 v247, s57, v121
s_waitcnt lgkmcnt(8)
v_mfma_f32_32x32x16_bf16 v[160:175], a[32:35], v[116:119], v[160:175]
ds_read_b64_tr_b16 a[8:9], v235 offset:13312
ds_read_b64_tr_b16 a[10:11], v235 offset:13568
v_fma_f32 v244, v244, v241, v242
v_fma_f32 v245, v245, v241, v242
v_fma_f32 v246, v246, v241, v242
v_fma_f32 v247, v247, v241, v242
v_cvt_pk_bf16_f32 v120, v244, v245
v_mfma_f32_32x32x16_bf16 v[176:191], a[36:39], v[116:119], v[176:191]
ds_read_b64_tr_b16 a[12:13], v235 offset:16384
ds_read_b64_tr_b16 a[14:15], v235 offset:16640
v_cvt_pk_bf16_f32 v121, v246, v247
v_lshlrev_b32 v248, 16, v122
v_and_b32 v249, s57, v122
v_lshlrev_b32 v250, 16, v123
s_waitcnt lgkmcnt(8)
v_mfma_f32_32x32x16_bf16 v[192:207], a[40:43], v[116:119], v[192:207]
ds_read_b64_tr_b16 a[16:17], v235 offset:14336
ds_read_b64_tr_b16 a[18:19], v235 offset:14592
v_and_b32 v251, s57, v123
v_fma_f32 v248, v248, v241, v242
v_fma_f32 v249, v249, v241, v242
v_fma_f32 v250, v250, v241, v242
v_fma_f32 v251, v251, v241, v242
v_mfma_f32_32x32x16_bf16 v[208:223], a[44:47], v[116:119], v[208:223]
ds_read_b64_tr_b16 a[20:21], v235 offset:17408
ds_read_b64_tr_b16 a[22:23], v235 offset:17664
v_cvt_pk_bf16_f32 v122, v248, v249
v_cvt_pk_bf16_f32 v123, v250, v251
s_waitcnt lgkmcnt(8)
s_nop 0
v_mfma_f32_32x32x16_bf16 v[128:143], a[0:3], v[120:123], v[128:143]
ds_read_b64_tr_b16 a[24:25], v235 offset:45056
ds_read_b64_tr_b16 a[26:27], v235 offset:45312
v_lshlrev_b32 v244, 16, v124
v_and_b32 v245, s57, v124
v_lshlrev_b32 v246, 16, v125
v_and_b32 v247, s57, v125
v_mfma_f32_32x32x16_bf16 v[144:159], a[4:7], v[120:123], v[144:159]
ds_read_b64_tr_b16 a[28:29], v235 offset:48128
ds_read_b64_tr_b16 a[30:31], v235 offset:48384
v_fma_f32 v244, v244, v241, v242
v_fma_f32 v245, v245, v241, v242
v_fma_f32 v246, v246, v241, v242
s_waitcnt lgkmcnt(8)
v_mfma_f32_32x32x16_bf16 v[160:175], a[8:11], v[120:123], v[160:175]
ds_read_b64_tr_b16 a[32:33], v235 offset:46080
ds_read_b64_tr_b16 a[34:35], v235 offset:46336
v_fma_f32 v247, v247, v241, v242
v_cvt_pk_bf16_f32 v124, v244, v245
v_cvt_pk_bf16_f32 v125, v246, v247
v_lshlrev_b32 v248, 16, v126
v_mfma_f32_32x32x16_bf16 v[176:191], a[12:15], v[120:123], v[176:191]
ds_read_b64_tr_b16 a[36:37], v235 offset:49152
ds_read_b64_tr_b16 a[38:39], v235 offset:49408
v_and_b32 v249, s57, v126
v_lshlrev_b32 v250, 16, v127
v_and_b32 v251, s57, v127
s_waitcnt lgkmcnt(8)
v_mfma_f32_32x32x16_bf16 v[192:207], a[16:19], v[120:123], v[192:207]
ds_read_b64_tr_b16 a[40:41], v235 offset:47104
ds_read_b64_tr_b16 a[42:43], v235 offset:47360
v_fma_f32 v248, v248, v241, v242
v_fma_f32 v249, v249, v241, v242
v_fma_f32 v250, v250, v241, v242
v_fma_f32 v251, v251, v241, v242
v_mfma_f32_32x32x16_bf16 v[208:223], a[20:23], v[120:123], v[208:223]
ds_read_b64_tr_b16 a[44:45], v235 offset:50176
ds_read_b64_tr_b16 a[46:47], v235 offset:50432
v_cvt_pk_bf16_f32 v126, v248, v249
v_cvt_pk_bf16_f32 v127, v250, v251
s_waitcnt lgkmcnt(8)
s_nop 0
v_mfma_f32_32x32x16_bf16 v[128:143], a[24:27], v[124:127], v[128:143]
v_mfma_f32_32x32x16_bf16 v[144:159], a[28:31], v[124:127], v[144:159]
s_waitcnt lgkmcnt(4)
v_mfma_f32_32x32x16_bf16 v[160:175], a[32:35], v[124:127], v[160:175]
v_mfma_f32_32x32x16_bf16 v[176:191], a[36:39], v[124:127], v[176:191]
s_waitcnt lgkmcnt(0)
v_mfma_f32_32x32x16_bf16 v[192:207], a[40:43], v[124:127], v[192:207]
v_mfma_f32_32x32x16_bf16 v[208:223], a[44:47], v[124:127], v[208:223]
s_cmp_lg_u32 s28, 0
s_cbranch_scc1 L_parallel_sum__spectral_gfnet__glu_gated_reglu__prompt_kernel_w0c_59
s_waitcnt vmcnt(2)
v_cmp_eq_u32 vcc, 1, v24
s_nop 4
s_cmp_eq_u64 vcc, exec
s_cbranch_scc1 L_parallel_sum__spectral_gfnet__glu_gated_reglu__prompt_kernel_zpok_60
s_mov_b32 s56, 0
L_parallel_sum__spectral_gfnet__glu_gated_reglu__prompt_kernel_zp_61:
buffer_load_dword v24, v25, s[16:19], s42 offen sc1
s_waitcnt vmcnt(0)
v_cmp_eq_u32 vcc, 1, v24
s_nop 4
s_cmp_eq_u64 vcc, exec
s_cbranch_scc1 L_parallel_sum__spectral_gfnet__glu_gated_reglu__prompt_kernel_zpd_62
s_add_u32 s56, s56, 1
s_cmp_gt_u32 s56, 40000
s_cbranch_scc1 L_parallel_sum__spectral_gfnet__glu_gated_reglu__prompt_kernel_zpd_62
s_sleep 4
s_branch L_parallel_sum__spectral_gfnet__glu_gated_reglu__prompt_kernel_zp_61
L_parallel_sum__spectral_gfnet__glu_gated_reglu__prompt_kernel_zpd_62:
L_parallel_sum__spectral_gfnet__glu_gated_reglu__prompt_kernel_zpok_60:
L_parallel_sum__spectral_gfnet__glu_gated_reglu__prompt_kernel_w0c_59:
s_barrier
v_and_b32 v8, 15, v224
v_lshrrev_b32 v9, 4, v224
s_cmp_eq_u32 s75, 256
s_cselect_b32 s35, 0, s75
s_lshl_b32 s35, s35, 13
s_add_u32 s35, s35, 0
s_lshl_b32 s36, s28, 4
v_add_u32 v10, s36, v8
v_lshlrev_b32 v10, 7, v10
v_lshl_add_u32 v10, v9, 4, v10
buffer_load_dwordx4 v[32:35], v10, s[16:19], s35 offen sc1
buffer_load_dwordx4 v[36:39], v10, s[16:19], s35 offen offset:64 sc1
s_and_b32 s43, s2, 7
s_lshl_b32 s43, s43, 9
s_add_u32 s43, s43, 14688256
v_lshlrev_b32 v27, 2, v224
s_cmp_lg_u32 s28, 0
s_cbranch_scc1 L_parallel_sum__spectral_gfnet__glu_gated_reglu__prompt_kernel_w0i_63
buffer_load_dword v26, v27, s[16:19], s43 offen sc1
L_parallel_sum__spectral_gfnet__glu_gated_reglu__prompt_kernel_w0i_63:
v_max_f32 v128, 0, v128
v_max_f32 v129, 0, v129
v_max_f32 v130, 0, v130
v_max_f32 v131, 0, v131
v_max_f32 v132, 0, v132
v_max_f32 v133, 0, v133
v_max_f32 v134, 0, v134
v_max_f32 v135, 0, v135
v_max_f32 v136, 0, v136
v_max_f32 v137, 0, v137
v_max_f32 v138, 0, v138
v_max_f32 v139, 0, v139
v_max_f32 v140, 0, v140
v_max_f32 v141, 0, v141
v_max_f32 v142, 0, v142
v_max_f32 v143, 0, v143
v_pk_mul_f32 v[128:129], v[128:129], v[144:145]
v_pk_mul_f32 v[130:131], v[130:131], v[146:147]
v_pk_mul_f32 v[132:133], v[132:133], v[148:149]
v_pk_mul_f32 v[134:135], v[134:135], v[150:151]
v_pk_mul_f32 v[136:137], v[136:137], v[152:153]
v_pk_mul_f32 v[138:139], v[138:139], v[154:155]
v_pk_mul_f32 v[140:141], v[140:141], v[156:157]
v_pk_mul_f32 v[142:143], v[142:143], v[158:159]
v_cvt_pk_bf16_f32 v144, v128, v129
v_cvt_pk_bf16_f32 v145, v130, v131
v_cvt_pk_bf16_f32 v146, v132, v133
v_cvt_pk_bf16_f32 v147, v134, v135
v_cvt_pk_bf16_f32 v148, v136, v137
v_cvt_pk_bf16_f32 v149, v138, v139
v_cvt_pk_bf16_f32 v150, v140, v141
v_cvt_pk_bf16_f32 v151, v142, v143
buffer_store_dwordx4 v[144:147], v252, s[16:19], 0 offen offset:0 sc1
buffer_store_dwordx4 v[148:151], v252, s[16:19], 0 offen offset:1024 sc1
v_max_f32 v160, 0, v160
v_max_f32 v161, 0, v161
v_max_f32 v162, 0, v162
v_max_f32 v163, 0, v163
v_max_f32 v164, 0, v164
v_max_f32 v165, 0, v165
v_max_f32 v166, 0, v166
v_max_f32 v167, 0, v167
v_max_f32 v168, 0, v168
v_max_f32 v169, 0, v169
v_max_f32 v170, 0, v170
v_max_f32 v171, 0, v171
v_max_f32 v172, 0, v172
v_max_f32 v173, 0, v173
v_max_f32 v174, 0, v174
v_max_f32 v175, 0, v175
v_pk_mul_f32 v[160:161], v[160:161], v[176:177]
v_pk_mul_f32 v[162:163], v[162:163], v[178:179]
v_pk_mul_f32 v[164:165], v[164:165], v[180:181]
v_pk_mul_f32 v[166:167], v[166:167], v[182:183]
v_pk_mul_f32 v[168:169], v[168:169], v[184:185]
v_pk_mul_f32 v[170:171], v[170:171], v[186:187]
v_pk_mul_f32 v[172:173], v[172:173], v[188:189]
v_pk_mul_f32 v[174:175], v[174:175], v[190:191]
v_cvt_pk_bf16_f32 v176, v160, v161
v_cvt_pk_bf16_f32 v177, v162, v163
v_cvt_pk_bf16_f32 v178, v164, v165
v_cvt_pk_bf16_f32 v179, v166, v167
v_cvt_pk_bf16_f32 v180, v168, v169
v_cvt_pk_bf16_f32 v181, v170, v171
v_cvt_pk_bf16_f32 v182, v172, v173
v_cvt_pk_bf16_f32 v183, v174, v175
buffer_store_dwordx4 v[176:179], v252, s[16:19], 0 offen offset:2048 sc1
buffer_store_dwordx4 v[180:183], v252, s[16:19], 0 offen offset:3072 sc1
v_max_f32 v192, 0, v192
v_max_f32 v193, 0, v193
v_max_f32 v194, 0, v194
v_max_f32 v195, 0, v195
v_max_f32 v196, 0, v196
v_max_f32 v197, 0, v197
v_max_f32 v198, 0, v198
v_max_f32 v199, 0, v199
v_max_f32 v200, 0, v200
v_max_f32 v201, 0, v201
v_max_f32 v202, 0, v202
v_max_f32 v203, 0, v203
v_max_f32 v204, 0, v204
v_max_f32 v205, 0, v205
v_max_f32 v206, 0, v206
v_max_f32 v207, 0, v207
v_pk_mul_f32 v[192:193], v[192:193], v[208:209]
v_pk_mul_f32 v[194:195], v[194:195], v[210:211]
v_pk_mul_f32 v[196:197], v[196:197], v[212:213]
v_pk_mul_f32 v[198:199], v[198:199], v[214:215]
v_pk_mul_f32 v[200:201], v[200:201], v[216:217]
v_pk_mul_f32 v[202:203], v[202:203], v[218:219]
v_pk_mul_f32 v[204:205], v[204:205], v[220:221]
v_pk_mul_f32 v[206:207], v[206:207], v[222:223]
v_cvt_pk_bf16_f32 v208, v192, v193
v_cvt_pk_bf16_f32 v209, v194, v195
v_cvt_pk_bf16_f32 v210, v196, v197
v_cvt_pk_bf16_f32 v211, v198, v199
v_cvt_pk_bf16_f32 v212, v200, v201
v_cvt_pk_bf16_f32 v213, v202, v203
v_cvt_pk_bf16_f32 v214, v204, v205
v_cvt_pk_bf16_f32 v215, v206, v207
buffer_store_dwordx4 v[208:211], v252, s[16:19], s63 offen offset:0 sc1
buffer_store_dwordx4 v[212:215], v252, s[16:19], s63 offen offset:1024 sc1
v_and_b32 v1, 15, v224
v_lshrrev_b32 v2, 4, v224
s_lshl_b32 s36, s28, 4
v_add_u32 v4, s36, v1
v_lshlrev_b32 v5, 4, v224
v_add_u32 v216, 28672, v5
v_add_u32 v217, 0x10000, v216
v_add_u32 v218, s32, v216
v_lshlrev_b32 v219, 6, v4
v_and_b32 v5, 1, v2
v_lshl_add_u32 v219, v5, 5, v219
v_lshrrev_b32 v5, 1, v2
v_lshl_add_u32 v219, v5, 4, v219
v_cvt_f32_u32 v7, v1
s_add_u32 m0, s32, 0
s_add_u32 s49, s52, 65536
buffer_load_dwordx4 v230, s[64:67], s49 offen lds
v_lshlrev_b32 v6, 2, v2
v_cvt_f32_u32 v6, v6
v_and_b32 v220, 1, v1
v_mul_u32_u24 v220, 0x8000, v220
v_lshl_or_b32 v220, v220, 16, v220
s_mov_b32 s34, 0x80008000
v_mul_f32 v208, 0x3d000000, v7
v_mul_f32 v209, v6, v208
v_cos_f32 v200, v209
v_sin_f32 v201, v209
v_add_f32 v209, v209, v208
v_cos_f32 v202, v209
v_sin_f32 v203, v209
v_add_f32 v209, v209, v208
buffer_load_dwordx4 v231, s[64:67], s49 offen offset:1024 lds
v_cos_f32 v204, v209
v_sin_f32 v205, v209
v_add_f32 v209, v209, v208
v_cos_f32 v206, v209
v_sin_f32 v207, v209
v_cvt_pk_bf16_f32 v48, v200, v201
v_cvt_pk_bf16_f32 v64, -v201, v200
v_cvt_pk_bf16_f32 v49, v202, v203
v_cvt_pk_bf16_f32 v65, -v203, v202
v_cvt_pk_bf16_f32 v50, v204, v205
v_cvt_pk_bf16_f32 v66, -v205, v204
v_cvt_pk_bf16_f32 v51, v206, v207
v_cvt_pk_bf16_f32 v67, -v207, v206
v_xor_b32 v52, v48, v220
s_add_u32 m0, s32, 2048
s_add_u32 s49, s52, 81920
buffer_load_dwordx4 v230, s[64:67], s49 offen lds
v_xor_b32 v53, v49, v220
v_xor_b32 v54, v50, v220
v_xor_b32 v55, v51, v220
v_mov_b32 v56, v48
v_xor_b32 v57, s34, v49
v_mov_b32 v58, v50
v_xor_b32 v59, s34, v51
v_mov_b32 v60, v52
v_xor_b32 v61, s34, v53
v_mov_b32 v62, v54
v_xor_b32 v63, s34, v55
v_xor_b32 v68, v64, v220
v_xor_b32 v69, v65, v220
v_xor_b32 v70, v66, v220
buffer_load_dwordx4 v231, s[64:67], s49 offen offset:1024 lds
v_xor_b32 v71, v67, v220
v_mov_b32 v72, v64
v_xor_b32 v73, s34, v65
v_mov_b32 v74, v66
v_xor_b32 v75, s34, v67
v_mov_b32 v76, v68
v_xor_b32 v77, s34, v69
v_mov_b32 v78, v70
v_xor_b32 v79, s34, v71
v_cvt_f32_u32 v4, v4
v_mul_f32 v208, 0x3c800000, v4
v_mov_b32 v210, v6
v_mul_f32 v209, v210, v208
v_cos_f32 v200, v209
s_add_u32 m0, s32, 4096
s_add_u32 s49, s52, 98304
buffer_load_dwordx4 v230, s[64:67], s49 offen lds
v_sin_f32 v201, v209
v_add_f32 v209, v209, v208
v_cos_f32 v202, v209
v_sin_f32 v203, v209
v_add_f32 v209, v209, v208
v_cos_f32 v204, v209
v_sin_f32 v205, v209
v_add_f32 v209, v209, v208
v_cos_f32 v206, v209
v_sin_f32 v207, v209
v_cvt_pk_bf16_f32 v80, v200, v201
v_cvt_pk_bf16_f32 v96, -v201, v200
v_cvt_pk_bf16_f32 v81, v202, v203
v_cvt_pk_bf16_f32 v97, -v203, v202
buffer_load_dwordx4 v231, s[64:67], s49 offen offset:1024 lds
v_cvt_pk_bf16_f32 v82, v204, v205
v_cvt_pk_bf16_f32 v98, -v205, v204
v_cvt_pk_bf16_f32 v83, v206, v207
v_cvt_pk_bf16_f32 v99, -v207, v206
v_add_f32 v210, 16.0, v6
v_mul_f32 v209, v210, v208
v_cos_f32 v200, v209
v_sin_f32 v201, v209
v_add_f32 v209, v209, v208
v_cos_f32 v202, v209
v_sin_f32 v203, v209
v_add_f32 v209, v209, v208
v_cos_f32 v204, v209
v_sin_f32 v205, v209
s_add_u32 m0, s32, 6144
s_add_u32 s49, s52, 114688
buffer_load_dwordx4 v230, s[64:67], s49 offen lds
v_add_f32 v209, v209, v208
v_cos_f32 v206, v209
v_sin_f32 v207, v209
v_cvt_pk_bf16_f32 v84, v200, v201
v_cvt_pk_bf16_f32 v100, -v201, v200
v_cvt_pk_bf16_f32 v85, v202, v203
v_cvt_pk_bf16_f32 v101, -v203, v202
v_cvt_pk_bf16_f32 v86, v204, v205
v_cvt_pk_bf16_f32 v102, -v205, v204
v_cvt_pk_bf16_f32 v87, v206, v207
v_cvt_pk_bf16_f32 v103, -v207, v206
v_xor_b32 v88, v80, v220
v_xor_b32 v89, v81, v220
v_xor_b32 v90, v82, v220
buffer_load_dwordx4 v231, s[64:67], s49 offen offset:1024 lds
v_xor_b32 v91, v83, v220
v_xor_b32 v92, v84, v220
v_xor_b32 v93, v85, v220
v_xor_b32 v94, v86, v220
v_xor_b32 v95, v87, v220
v_xor_b32 v104, v96, v220
v_xor_b32 v105, v97, v220
v_xor_b32 v106, v98, v220
v_xor_b32 v107, v99, v220
v_xor_b32 v108, v100, v220
v_xor_b32 v109, v101, v220
v_xor_b32 v110, v102, v220
v_xor_b32 v111, v103, v220
v_cvt_f32_u32 v5, s36
s_add_u32 m0, s32, 8192
s_add_u32 s49, s52, 131072
buffer_load_dwordx4 v230, s[64:67], s49 offen lds
v_add_f32 v5, v5, v6
v_mov_b32 v208, v7
v_mul_f32 v208, 0x3a000000, v208
v_mul_f32 v209, v5, v208
v_cos_f32 v112, v209
v_sin_f32 v113, v209
v_add_f32 v209, v209, v208
v_cos_f32 v114, v209
v_sin_f32 v115, v209
v_add_f32 v209, v209, v208
v_cos_f32 v116, v209
v_sin_f32 v117, v209
v_add_f32 v209, v209, v208
v_cos_f32 v118, v209
buffer_load_dwordx4 v231, s[64:67], s49 offen offset:1024 lds
v_sin_f32 v119, v209
v_add_f32 v208, 16.0, v7
v_mul_f32 v208, 0x3a000000, v208
v_mul_f32 v209, v5, v208
v_cos_f32 v120, v209
v_sin_f32 v121, v209
v_add_f32 v209, v209, v208
v_cos_f32 v122, v209
v_sin_f32 v123, v209
v_add_f32 v209, v209, v208
v_cos_f32 v124, v209
v_sin_f32 v125, v209
v_add_f32 v209, v209, v208
v_cos_f32 v126, v209
s_add_u32 m0, s32, 10240
s_add_u32 s49, s52, 147456
buffer_load_dwordx4 v230, s[64:67], s49 offen lds
v_sin_f32 v127, v209
v_mul_f32 v208, 0x3a000000, v4
v_mov_b32 v210, v6
v_mul_f32 v209, v210, v208
v_cos_f32 v128, v209
v_sin_f32 v129, v209
v_add_f32 v209, v209, v208
v_cos_f32 v130, v209
v_sin_f32 v131, v209
v_add_f32 v209, v209, v208
v_cos_f32 v132, v209
v_sin_f32 v133, v209
v_add_f32 v209, v209, v208
v_cos_f32 v134, v209
buffer_load_dwordx4 v231, s[64:67], s49 offen offset:1024 lds
v_sin_f32 v135, v209
v_add_f32 v210, 16.0, v6
v_mul_f32 v209, v210, v208
v_cos_f32 v136, v209
v_sin_f32 v137, v209
v_add_f32 v209, v209, v208
v_cos_f32 v138, v209
v_sin_f32 v139, v209
v_add_f32 v209, v209, v208
v_cos_f32 v140, v209
v_sin_f32 v141, v209
v_add_f32 v209, v209, v208
v_cos_f32 v142, v209
v_sin_f32 v143, v209
s_cmp_lg_u32 s28, 0
s_cbranch_scc1 L_parallel_sum__spectral_gfnet__glu_gated_reglu__prompt_kernel_w0c_64
s_waitcnt vmcnt(18)
v_cmp_eq_u32 vcc, 1, v26
s_nop 4
s_cmp_eq_u64 vcc, exec
s_cbranch_scc1 L_parallel_sum__spectral_gfnet__glu_gated_reglu__prompt_kernel_ppok_65
s_mov_b32 s56, 0
L_parallel_sum__spectral_gfnet__glu_gated_reglu__prompt_kernel_pp_66:
buffer_load_dword v26, v27, s[16:19], s43 offen sc1
s_waitcnt vmcnt(0)
v_cmp_eq_u32 vcc, 1, v26
s_nop 4
s_cmp_eq_u64 vcc, exec
s_cbranch_scc1 L_parallel_sum__spectral_gfnet__glu_gated_reglu__prompt_kernel_ppd_67
s_add_u32 s56, s56, 1
s_cmp_gt_u32 s56, 40000
s_cbranch_scc1 L_parallel_sum__spectral_gfnet__glu_gated_reglu__prompt_kernel_ppd_67
s_sleep 4
s_branch L_parallel_sum__spectral_gfnet__glu_gated_reglu__prompt_kernel_pp_66
L_parallel_sum__spectral_gfnet__glu_gated_reglu__prompt_kernel_ppd_67:
L_parallel_sum__spectral_gfnet__glu_gated_reglu__prompt_kernel_ppok_65:
L_parallel_sum__spectral_gfnet__glu_gated_reglu__prompt_kernel_w0c_64:
s_waitcnt vmcnt(12)
s_barrier
s_lshl_b32 s60, s29, 4
s_add_u32 s60, s60, s30
s_lshl_b32 s60, s60, 2
s_add_u32 s60, s60, 14684160
s_cmp_lg_u32 s28, 0
s_cbranch_scc1 L_parallel_sum__spectral_gfnet__glu_gated_reglu__prompt_kernel_flag_68
s_mov_b64 exec, 1
v_mov_b32 v212, 1
v_mov_b32 v213, 0
buffer_store_dword v212, v213, s[16:19], s60 offen sc1
s_mov_b64 exec, -1
L_parallel_sum__spectral_gfnet__glu_gated_reglu__prompt_kernel_flag_68:
v_and_b32 v8, 15, v224
v_lshrrev_b32 v9, 4, v224
s_lshl_b32 s35, s75, 13
s_lshl_b32 s37, s28, 11
s_add_u32 s35, s35, s37
s_add_u32 s35, s35, 2097152
v_lshlrev_b32 v10, 9, v9
v_lshl_add_u32 v10, v8, 4, v10
buffer_load_dwordx4 v[40:43], v10, s[16:19], s35 offen sc1
buffer_load_dwordx4 v[44:47], v10, s[16:19], s35 offen offset:256 sc1
s_cmp_eq_u32 s75, 256
s_cselect_b32 s35, 16, 0
s_and_b32 s37, s75, 255
s_cmp_lg_u32 s37, 0
s_cbranch_scc1 L_parallel_sum__spectral_gfnet__glu_gated_reglu__prompt_kernel_normal_69
v_lshrrev_b32 v32, s35, v32
v_and_b32 v32, 0xffff, v32
v_lshrrev_b32 v33, s35, v33
v_and_b32 v33, 0xffff, v33
v_lshrrev_b32 v34, s35, v34
v_and_b32 v34, 0xffff, v34
v_lshrrev_b32 v35, s35, v35
v_and_b32 v35, 0xffff, v35
v_lshrrev_b32 v36, s35, v36
v_and_b32 v36, 0xffff, v36
v_lshrrev_b32 v37, s35, v37
v_and_b32 v37, 0xffff, v37
v_lshrrev_b32 v38, s35, v38
v_and_b32 v38, 0xffff, v38
v_lshrrev_b32 v39, s35, v39
v_and_b32 v39, 0xffff, v39
L_parallel_sum__spectral_gfnet__glu_gated_reglu__prompt_kernel_normal_69:
v_mfma_f32_16x16x32_bf16 v[144:147], v[32:35], v[48:51], 0
v_mfma_f32_16x16x32_bf16 v[152:155], v[32:35], v[64:67], 0
v_mfma_f32_16x16x32_bf16 v[144:147], v[36:39], v[52:55], v[144:147]
v_mfma_f32_16x16x32_bf16 v[152:155], v[36:39], v[68:71], v[152:155]
v_mfma_f32_16x16x32_bf16 v[148:151], v[32:35], v[56:59], 0
v_mfma_f32_16x16x32_bf16 v[156:159], v[32:35], v[72:75], 0
v_mfma_f32_16x16x32_bf16 v[148:151], v[36:39], v[60:63], v[148:151]
v_mfma_f32_16x16x32_bf16 v[156:159], v[36:39], v[76:79], v[156:159]
s_add_u32 m0, s32, 12288
s_add_u32 s49, s52, 163840
buffer_load_dwordx4 v230, s[64:67], s49 offen lds
v_mul_f32 v200, v144, v112
v_mul_f32 v201, v152, v112
v_fma_f32 v200, v152, v113, v200
v_fma_f32 v201, -v144, v113, v201
v_mul_f32 v202, v145, v114
v_mul_f32 v203, v153, v114
v_fma_f32 v202, v153, v115, v202
v_fma_f32 v203, -v145, v115, v203
v_mul_f32 v204, v146, v116
v_mul_f32 v205, v154, v116
v_fma_f32 v204, v154, v117, v204
v_fma_f32 v205, -v146, v117, v205
v_mul_f32 v206, v147, v118
v_mul_f32 v207, v155, v118
v_fma_f32 v206, v155, v119, v206
v_fma_f32 v207, -v147, v119, v207
v_cvt_pk_bf16_f32 v160, v200, v201
v_cvt_pk_bf16_f32 v161, v202, v203
v_cvt_pk_bf16_f32 v162, v204, v205
v_cvt_pk_bf16_f32 v163, v206, v207
v_mul_f32 v200, v148, v120
v_mul_f32 v201, v156, v120
v_fma_f32 v200, v156, v121, v200
v_fma_f32 v201, -v148, v121, v201
v_mul_f32 v202, v149, v122
v_mul_f32 v203, v157, v122
v_fma_f32 v202, v157, v123, v202
v_fma_f32 v203, -v149, v123, v203
v_mul_f32 v204, v150, v124
v_mul_f32 v205, v158, v124
v_fma_f32 v204, v158, v125, v204
v_fma_f32 v205, -v150, v125, v205
v_mul_f32 v206, v151, v126
v_mul_f32 v207, v159, v126
v_fma_f32 v206, v159, v127, v206
v_fma_f32 v207, -v151, v127, v207
v_cvt_pk_bf16_f32 v164, v200, v201
v_cvt_pk_bf16_f32 v165, v202, v203
v_cvt_pk_bf16_f32 v166, v204, v205
v_cvt_pk_bf16_f32 v167, v206, v207
buffer_load_dwordx4 v231, s[64:67], s49 offen offset:1024 lds
s_add_u32 m0, s32, 14336
s_add_u32 s49, s52, 180224
buffer_load_dwordx4 v230, s[64:67], s49 offen lds
ds_write_b128 v218, v[160:163] offset:0
ds_write_b128 v218, v[164:167] offset:1024
buffer_load_dwordx4 v231, s[64:67], s49 offen offset:1024 lds
s_waitcnt lgkmcnt(0)
s_barrier
s_add_u32 m0, s32, 16384
s_add_u32 s49, s52, 196608
buffer_load_dwordx4 v230, s[64:67], s49 offen lds
buffer_load_dwordx4 v231, s[64:67], s49 offen offset:1024 lds
ds_read_b128 v[168:171], v216 offset:0
ds_read_b128 v[172:175], v216 offset:1024
ds_read_b128 v[176:179], v216 offset:32768
ds_read_b128 v[180:183], v216 offset:33792
ds_read_b128 v[184:187], v217 offset:0
ds_read_b128 v[188:191], v217 offset:1024
ds_read_b128 v[192:195], v217 offset:32768
ds_read_b128 v[196:199], v217 offset:33792
s_add_u32 m0, s32, 18432
s_add_u32 s49, s52, 212992
buffer_load_dwordx4 v230, s[64:67], s49 offen lds
s_waitcnt lgkmcnt(7)
v_mfma_f32_16x16x32_bf16 v[144:147], v[80:83], v[168:171], 0
v_mfma_f32_16x16x32_bf16 v[152:155], v[96:99], v[168:171], 0
s_waitcnt lgkmcnt(5)
v_mfma_f32_16x16x32_bf16 v[144:147], v[84:87], v[176:179], v[144:147]
v_mfma_f32_16x16x32_bf16 v[152:155], v[100:103], v[176:179], v[152:155]
s_waitcnt lgkmcnt(3)
v_mfma_f32_16x16x32_bf16 v[144:147], v[88:91], v[184:187], v[144:147]
v_mfma_f32_16x16x32_bf16 v[152:155], v[104:107], v[184:187], v[152:155]
s_waitcnt lgkmcnt(1)
v_mfma_f32_16x16x32_bf16 v[144:147], v[92:95], v[192:195], v[144:147]
v_mfma_f32_16x16x32_bf16 v[152:155], v[108:111], v[192:195], v[152:155]
v_mfma_f32_16x16x32_bf16 v[148:151], v[80:83], v[172:175], 0
v_mfma_f32_16x16x32_bf16 v[156:159], v[96:99], v[172:175], 0
v_mfma_f32_16x16x32_bf16 v[148:151], v[84:87], v[180:183], v[148:151]
v_mfma_f32_16x16x32_bf16 v[156:159], v[100:103], v[180:183], v[156:159]
v_mfma_f32_16x16x32_bf16 v[148:151], v[88:91], v[188:191], v[148:151]
v_mfma_f32_16x16x32_bf16 v[156:159], v[104:107], v[188:191], v[156:159]
s_waitcnt lgkmcnt(0)
v_mfma_f32_16x16x32_bf16 v[148:151], v[92:95], v[196:199], v[148:151]
v_mfma_f32_16x16x32_bf16 v[156:159], v[108:111], v[196:199], v[156:159]
buffer_load_dwordx4 v231, s[64:67], s49 offen offset:1024 lds
s_waitcnt vmcnt(9)
v_lshlrev_b32 v208, 16, v40
v_and_b32 v209, s57, v40
v_mul_f32 v200, v144, v208
v_mul_f32 v201, -v144, v209
v_fma_f32 v200, -v152, v209, v200
v_fma_f32 v201, -v152, v208, v201
v_lshlrev_b32 v208, 16, v41
v_and_b32 v209, s57, v41
v_mul_f32 v202, v145, v208
v_mul_f32 v203, -v145, v209
v_fma_f32 v202, -v153, v209, v202
v_fma_f32 v203, -v153, v208, v203
v_lshlrev_b32 v208, 16, v42
v_and_b32 v209, s57, v42
v_mul_f32 v204, v146, v208
v_mul_f32 v205, -v146, v209
v_fma_f32 v204, -v154, v209, v204
v_fma_f32 v205, -v154, v208, v205
v_lshlrev_b32 v208, 16, v43
v_and_b32 v209, s57, v43
v_mul_f32 v206, v147, v208
v_mul_f32 v207, -v147, v209
v_fma_f32 v206, -v155, v209, v206
v_fma_f32 v207, -v155, v208, v207
v_cvt_pk_bf16_f32 v160, v200, v201
v_cvt_pk_bf16_f32 v161, v202, v203
v_cvt_pk_bf16_f32 v162, v204, v205
v_cvt_pk_bf16_f32 v163, v206, v207
s_waitcnt vmcnt(8)
v_lshlrev_b32 v208, 16, v44
v_and_b32 v209, s57, v44
v_mul_f32 v200, v148, v208
v_mul_f32 v201, -v148, v209
v_fma_f32 v200, -v156, v209, v200
v_fma_f32 v201, -v156, v208, v201
v_lshlrev_b32 v208, 16, v45
v_and_b32 v209, s57, v45
v_mul_f32 v202, v149, v208
v_mul_f32 v203, -v149, v209
v_fma_f32 v202, -v157, v209, v202
v_fma_f32 v203, -v157, v208, v203
v_lshlrev_b32 v208, 16, v46
v_and_b32 v209, s57, v46
v_mul_f32 v204, v150, v208
v_mul_f32 v205, -v150, v209
v_fma_f32 v204, -v158, v209, v204
v_fma_f32 v205, -v158, v208, v205
v_lshlrev_b32 v208, 16, v47
v_and_b32 v209, s57, v47
v_mul_f32 v206, v151, v208
v_mul_f32 v207, -v151, v209
v_fma_f32 v206, -v159, v209, v206
v_fma_f32 v207, -v159, v208, v207
v_cvt_pk_bf16_f32 v164, v200, v201
v_cvt_pk_bf16_f32 v165, v202, v203
v_cvt_pk_bf16_f32 v166, v204, v205
v_cvt_pk_bf16_f32 v167, v206, v207
ds_write_b128 v218, v[160:163] offset:2048
ds_write_b128 v218, v[164:167] offset:3072
s_add_u32 m0, s32, 20480
s_add_u32 s49, s52, 229376
buffer_load_dwordx4 v230, s[64:67], s49 offen lds
s_waitcnt lgkmcnt(0)
s_barrier
s_lshr_b32 s44, s76, 1
s_lshl_b32 s44, s44, 6
s_add_u32 s44, s44, 14684160
v_and_b32 v221, 15, v224
v_lshlrev_b32 v221, 2, v221
s_cmp_lg_u32 s28, 0
s_cbranch_scc1 L_parallel_sum__spectral_gfnet__glu_gated_reglu__prompt_kernel_w0i_70
buffer_load_dword v222, v221, s[16:19], s44 offen sc1
L_parallel_sum__spectral_gfnet__glu_gated_reglu__prompt_kernel_w0i_70:
buffer_load_dwordx4 v231, s[64:67], s49 offen offset:1024 lds
s_add_u32 m0, s32, 22528
s_add_u32 s49, s52, 245760
buffer_load_dwordx4 v230, s[64:67], s49 offen lds
ds_read_b128 v[168:171], v216 offset:2048
ds_read_b128 v[172:175], v216 offset:3072
ds_read_b128 v[176:179], v216 offset:34816
ds_read_b128 v[180:183], v216 offset:35840
ds_read_b128 v[184:187], v217 offset:2048
ds_read_b128 v[188:191], v217 offset:3072
ds_read_b128 v[192:195], v217 offset:34816
ds_read_b128 v[196:199], v217 offset:35840
buffer_load_dwordx4 v231, s[64:67], s49 offen offset:1024 lds
s_waitcnt lgkmcnt(7)
v_mfma_f32_16x16x32_bf16 v[144:147], v[168:171], v[80:83], 0
v_mfma_f32_16x16x32_bf16 v[152:155], v[168:171], v[96:99], 0
s_waitcnt lgkmcnt(5)
v_mfma_f32_16x16x32_bf16 v[144:147], v[176:179], v[84:87], v[144:147]
v_mfma_f32_16x16x32_bf16 v[152:155], v[176:179], v[100:103], v[152:155]
s_waitcnt lgkmcnt(3)
v_mfma_f32_16x16x32_bf16 v[144:147], v[184:187], v[88:91], v[144:147]
v_mfma_f32_16x16x32_bf16 v[152:155], v[184:187], v[104:107], v[152:155]
s_waitcnt lgkmcnt(1)
v_mfma_f32_16x16x32_bf16 v[144:147], v[192:195], v[92:95], v[144:147]
v_mfma_f32_16x16x32_bf16 v[152:155], v[192:195], v[108:111], v[152:155]
v_mfma_f32_16x16x32_bf16 v[148:151], v[172:175], v[80:83], 0
v_mfma_f32_16x16x32_bf16 v[156:159], v[172:175], v[96:99], 0
v_mfma_f32_16x16x32_bf16 v[148:151], v[180:183], v[84:87], v[148:151]
v_mfma_f32_16x16x32_bf16 v[156:159], v[180:183], v[100:103], v[156:159]
v_mfma_f32_16x16x32_bf16 v[148:151], v[188:191], v[88:91], v[148:151]
v_mfma_f32_16x16x32_bf16 v[156:159], v[188:191], v[104:107], v[156:159]
s_waitcnt lgkmcnt(0)
v_mfma_f32_16x16x32_bf16 v[148:151], v[196:199], v[92:95], v[148:151]
v_mfma_f32_16x16x32_bf16 v[156:159], v[196:199], v[108:111], v[156:159]
s_add_u32 m0, s32, 24576
s_add_u32 s49, s52, 262144
buffer_load_dwordx4 v230, s[64:67], s49 offen lds
buffer_load_dwordx4 v231, s[64:67], s49 offen offset:1024 lds
v_mul_f32 v200, v144, v128
v_mul_f32 v201, v152, v128
v_fma_f32 v200, v152, v129, v200
v_fma_f32 v201, -v144, v129, v201
v_mul_f32 v202, v145, v130
v_mul_f32 v203, v153, v130
v_fma_f32 v202, v153, v131, v202
v_fma_f32 v203, -v145, v131, v203
v_mul_f32 v204, v146, v132
v_mul_f32 v205, v154, v132
v_fma_f32 v204, v154, v133, v204
v_fma_f32 v205, -v146, v133, v205
v_mul_f32 v206, v147, v134
v_mul_f32 v207, v155, v134
v_fma_f32 v206, v155, v135, v206
v_fma_f32 v207, -v147, v135, v207
v_cvt_pk_bf16_f32 v160, v200, v201
v_cvt_pk_bf16_f32 v161, v202, v203
v_cvt_pk_bf16_f32 v162, v204, v205
v_cvt_pk_bf16_f32 v163, v206, v207
v_mul_f32 v200, v148, v136
v_mul_f32 v201, v156, v136
v_fma_f32 v200, v156, v137, v200
v_fma_f32 v201, -v148, v137, v201
v_mul_f32 v202, v149, v138
v_mul_f32 v203, v157, v138
v_fma_f32 v202, v157, v139, v202
v_fma_f32 v203, -v149, v139, v203
v_mul_f32 v204, v150, v140
v_mul_f32 v205, v158, v140
v_fma_f32 v204, v158, v141, v204
v_fma_f32 v205, -v150, v141, v205
v_mul_f32 v206, v151, v142
v_mul_f32 v207, v159, v142
v_fma_f32 v206, v159, v143, v206
v_fma_f32 v207, -v151, v143, v207
v_cvt_pk_bf16_f32 v164, v200, v201
v_cvt_pk_bf16_f32 v165, v202, v203
v_cvt_pk_bf16_f32 v166, v204, v205
v_cvt_pk_bf16_f32 v167, v206, v207
s_add_u32 m0, s32, 26624
s_add_u32 s49, s52, 278528
buffer_load_dwordx4 v230, s[64:67], s49 offen lds
v_mfma_f32_16x16x32_bf16 v[144:147], v[48:51], v[160:163], 0
v_mfma_f32_16x16x32_bf16 v[152:155], v[64:67], v[160:163], 0
v_mfma_f32_16x16x32_bf16 v[144:147], v[52:55], v[164:167], v[144:147]
v_mfma_f32_16x16x32_bf16 v[152:155], v[68:71], v[164:167], v[152:155]
v_mfma_f32_16x16x32_bf16 v[148:151], v[56:59], v[160:163], 0
v_mfma_f32_16x16x32_bf16 v[156:159], v[72:75], v[160:163], 0
v_mfma_f32_16x16x32_bf16 v[148:151], v[60:63], v[164:167], v[148:151]
v_mfma_f32_16x16x32_bf16 v[156:159], v[76:79], v[164:167], v[156:159]
buffer_load_dwordx4 v231, s[64:67], s49 offen offset:1024 lds
s_lshl_b32 s35, s75, 1
s_cmp_eq_u32 s75, 256
s_cselect_b32 s35, 1, s35
s_lshl_b32 s35, s35, 12
s_add_u32 s35, s35, 11534336
v_mul_f32 v144, 0x36000000, v144
v_mul_f32 v145, 0x36000000, v145
v_mul_f32 v146, 0x36000000, v146
v_mul_f32 v147, 0x36000000, v147
v_mul_f32 v148, 0x36000000, v148
v_mul_f32 v149, 0x36000000, v149
v_mul_f32 v150, 0x36000000, v150
v_mul_f32 v151, 0x36000000, v151
v_cvt_pk_bf16_f32 v200, v144, v145
v_cvt_pk_bf16_f32 v201, v146, v147
v_cvt_pk_bf16_f32 v202, v148, v149
v_cvt_pk_bf16_f32 v203, v150, v151
s_nop 0
v_permlane16_swap_b32 v200, v202
v_permlane16_swap_b32 v201, v203
buffer_store_dwordx4 v[200:203], v219, s[16:19], s35 offen sc1
s_and_b32 s37, s75, 255
s_cmp_eq_u32 s37, 0
s_cbranch_scc1 L_parallel_sum__spectral_gfnet__glu_gated_reglu__prompt_kernel_noim_71
s_add_u32 s35, s35, 4096
v_mul_f32 v152, 0x36000000, v152
v_mul_f32 v153, 0x36000000, v153
v_mul_f32 v154, 0x36000000, v154
v_mul_f32 v155, 0x36000000, v155
v_mul_f32 v156, 0x36000000, v156
v_mul_f32 v157, 0x36000000, v157
v_mul_f32 v158, 0x36000000, v158
v_mul_f32 v159, 0x36000000, v159
v_cvt_pk_bf16_f32 v204, v152, v153
v_cvt_pk_bf16_f32 v205, v154, v155
v_cvt_pk_bf16_f32 v206, v156, v157
v_cvt_pk_bf16_f32 v207, v158, v159
s_nop 0
v_permlane16_swap_b32 v204, v206
v_permlane16_swap_b32 v205, v207
buffer_store_dwordx4 v[204:207], v219, s[16:19], s35 offen sc1
L_parallel_sum__spectral_gfnet__glu_gated_reglu__prompt_kernel_noim_71:
s_lshr_b32 s40, s28, 1
s_lshl_b32 s41, s76, 1
s_add_u32 s42, s41, s40
s_xor_b32 s43, s40, 1
s_add_u32 s43, s41, s43
s_mul_i32 s36, s42, 88064
s_mul_i32 s37, s43, 88064
s_add_u32 s36, s36, 5242880
s_add_u32 s37, s37, 5242880
s_mul_i32 s40, s28, 22528
s_add_u32 s34, s36, s40
s_add_u32 s35, s37, s40
s_add_u32 s36, s36, 87040
s_add_u32 s37, s37, 87040
s_lshl_b32 s38, s28, 19
s_add_u32 s38, s38, 11534336
v_lshlrev_b32 v88, 4, v224
s_cmp_lg_u32 s28, 0
s_cbranch_scc1 L_parallel_sum__spectral_gfnet__glu_gated_reglu__prompt_kernel_w0c_72
s_waitcnt vmcnt(8)
v_cmp_eq_u32 vcc, 1, v222
s_nop 4
s_cmp_eq_u64 vcc, exec
s_cbranch_scc1 L_parallel_sum__spectral_gfnet__glu_gated_reglu__prompt_kernel_haok_73
s_mov_b32 s56, 0
L_parallel_sum__spectral_gfnet__glu_gated_reglu__prompt_kernel_ha_74:
buffer_load_dword v222, v221, s[16:19], s44 offen sc1
s_waitcnt vmcnt(0)
v_cmp_eq_u32 vcc, 1, v222
s_nop 4
s_cmp_eq_u64 vcc, exec
s_cbranch_scc1 L_parallel_sum__spectral_gfnet__glu_gated_reglu__prompt_kernel_had_75
s_add_u32 s56, s56, 1
s_cmp_gt_u32 s56, 40000
s_cbranch_scc1 L_parallel_sum__spectral_gfnet__glu_gated_reglu__prompt_kernel_had_75
s_sleep 4
s_branch L_parallel_sum__spectral_gfnet__glu_gated_reglu__prompt_kernel_ha_74
L_parallel_sum__spectral_gfnet__glu_gated_reglu__prompt_kernel_had_75:
L_parallel_sum__spectral_gfnet__glu_gated_reglu__prompt_kernel_haok_73:
L_parallel_sum__spectral_gfnet__glu_gated_reglu__prompt_kernel_w0c_72:
s_barrier
buffer_load_dwordx4 a[0:3], v88, s[16:19], s34 offen sc1
s_lshr_b32 s40, s28, 1
s_lshl_b32 s41, s76, 1
s_add_u32 s42, s41, s40
v_lshrrev_b32 v2, 3, v224
v_and_b32 v3, 7, v224
v_bfe_u32 v4, v224, 4, 1
v_lshlrev_b32 v4, 2, v4
v_xor_b32 v3, v3, v4
v_lshlrev_b32 v3, 4, v3
s_lshl_b32 s40, s76, 7
v_lshlrev_b32 v4, 12, v2
v_add3_u32 v89, v4, v3, s40
buffer_load_dwordx4 a[4:7], v88, s[16:19], s35 offen sc1
s_add_u32 s34, s34, s54
s_add_u32 s35, s35, s54
v_add_u32 v90, 31744, v89
v_and_b32 v2, 31, v224
v_lshrrev_b32 v3, 5, v224
v_lshlrev_b32 v4, 6, v2
v_add_u32 v4, s42, v4
v_lshlrev_b32 v4, 10, v4
s_and_b32 s40, s28, 1
s_lshl_b32 s40, s40, 6
s_lshl_b32 s41, s77, 7
s_add_u32 s40, s40, s41
v_add_u32 v4, s40, v4
v_lshlrev_b32 v5, 3, v3
v_add_u32 v5, v4, v5
buffer_load_dwordx4 a[8:11], v88, s[16:19], s34 offen sc1
buffer_load_dwordx2 v[80:81], v5, s[4:7], 0 offen offset:0
buffer_load_dwordx2 v[82:83], v5, s[4:7], 0 offen offset:16
buffer_load_dwordx2 v[84:85], v5, s[4:7], 0 offen offset:32
buffer_load_dwordx2 v[86:87], v5, s[4:7], 0 offen offset:48
v_lshlrev_b32 v5, 4, v3
v_add_u32 v100, v4, v5
v_bfe_u32 v4, v224, 2, 2
v_bfe_u32 v5, v224, 4, 1
v_lshlrev_b32 v5, 5, v5
v_and_b32 v6, 3, v224
v_lshlrev_b32 v6, 3, v6
v_add_u32 v5, v5, v6
v_lshrrev_b32 v6, 1, v4
buffer_load_dwordx4 a[12:15], v88, s[16:19], s35 offen sc1
s_add_u32 s34, s34, s54
s_add_u32 s35, s35, s54
s_and_b32 s40, s28, 1
s_lshr_b32 s41, s28, 1
v_lshl_add_u32 v7, v3, 2, v4
v_lshl_add_u32 v7, v7, 7, v5
v_xor_b32 v8, s40, v6
v_lshl_add_u32 v9, v8, 6, v7
v_xor_b32 v8, 1, v8
v_lshl_add_u32 v10, v8, 6, v7
v_add_u32 v92, s32, v9
v_add_u32 v93, s32, v10
v_add_u32 v94, s51, v9
v_add_u32 v95, s51, v10
buffer_load_dwordx4 a[16:19], v88, s[16:19], s34 offen sc1
v_lshl_add_u32 v7, v3, 3, v4
v_lshl_add_u32 v7, v7, 7, v5
v_xor_b32 v8, s41, v6
v_lshl_add_u32 v9, v8, 6, v7
v_xor_b32 v8, 1, v8
v_lshl_add_u32 v10, v8, 6, v7
v_add_u32 v96, s32, v9
v_add_u32 v97, s32, v10
v_add_u32 v98, s51, v9
v_add_u32 v99, s51, v10
v_add_u32 v101, s32, v88
s_xor_b32 s42, s28, 1
s_lshl_b32 s42, s42, 15
buffer_load_dwordx4 a[20:23], v88, s[16:19], s35 offen sc1
s_add_u32 s34, s34, s54
s_add_u32 s35, s35, s54
s_add_u32 s42, s42, 0
v_add_u32 v102, s42, v88
s_xor_b32 s42, s28, 2
s_lshl_b32 s42, s42, 15
s_add_u32 s42, s42, 4096
v_add_u32 v103, s42, v88
s_xor_b32 s42, s28, 3
s_lshl_b32 s42, s42, 15
s_add_u32 s42, s42, 8192
v_add_u32 v104, s42, v88
v_and_b32 v2, 31, v224
v_lshrrev_b32 v3, 5, v224
s_lshl_b32 s42, s77, 6
buffer_load_dwordx4 a[24:27], v88, s[16:19], s34 offen sc1
v_add_u32 v12, s42, v2
s_and_b32 s40, s28, 1
s_lshl_b32 s43, s40, 5
v_add_u32 v13, s43, v12
s_xor_b32 s43, s43, 32
v_add_u32 v14, s43, v12
v_cvt_f32_u32 v8, v13
v_cvt_f32_u32 v9, v14
v_mul_f32 v105, 0x3b000000, v8
v_mul_f32 v106, 0x3b000000, v9
s_lshl_b32 s42, s28, 6
v_lshlrev_b32 v12, 2, v3
v_add_u32 v12, s42, v12
buffer_load_dwordx4 a[28:31], v88, s[16:19], s35 offen sc1
s_add_u32 s34, s34, s54
s_add_u32 s35, s35, s54
v_cvt_f32_u32 v12, v12
v_mul_f32 v107, v12, v105
v_mul_f32 v108, v12, v106
v_lshlrev_b32 v13, 31, v13
v_or_b32 v109, 0x3f003f00, v13
v_lshlrev_b32 v14, 31, v14
v_or_b32 v110, 0x3f003f00, v14
v_cmp_gt_u32 s[46:47], 32, v224
s_cmp_eq_u32 s28, 0
s_cselect_b64 s[46:47], s[46:47], 0
v_cos_f32 v116, v107
v_sin_f32 v117, v107
buffer_load_dwordx4 a[32:35], v88, s[16:19], s34 offen sc1
v_add_f32 v107, v107, v105
v_cvt_pk_bf16_f32 v160, v116, v117
v_cos_f32 v118, v107
v_sin_f32 v119, v107
v_add_f32 v107, v107, v105
v_cvt_pk_bf16_f32 v161, v118, v119
v_cos_f32 v116, v107
v_sin_f32 v117, v107
v_add_f32 v107, v107, v105
v_cvt_pk_bf16_f32 v162, v116, v117
v_cos_f32 v118, v107
v_sin_f32 v119, v107
v_add_f32 v107, v107, v105
buffer_load_dwordx4 a[36:39], v88, s[16:19], s35 offen sc1
s_add_u32 s34, s34, s54
s_add_u32 s35, s35, s54
v_cvt_pk_bf16_f32 v163, v118, v119
v_fma_f32 v107, v105, 4.0, v107
v_cndmask_b32 v160, v160, v109, s[46:47]
v_cos_f32 v116, v108
v_sin_f32 v117, v108
v_add_f32 v108, v108, v106
v_cvt_pk_bf16_f32 v164, v116, v117
v_cos_f32 v118, v108
v_sin_f32 v119, v108
v_add_f32 v108, v108, v106
v_cvt_pk_bf16_f32 v165, v118, v119
v_cos_f32 v116, v108
v_sin_f32 v117, v108
buffer_load_dwordx4 a[40:43], v88, s[16:19], s34 offen sc1
v_add_f32 v108, v108, v106
v_cvt_pk_bf16_f32 v166, v116, v117
v_cos_f32 v118, v108
v_sin_f32 v119, v108
v_add_f32 v108, v108, v106
v_cvt_pk_bf16_f32 v167, v118, v119
v_fma_f32 v108, v106, 4.0, v108
v_cndmask_b32 v164, v164, v110, s[46:47]
v_cos_f32 v116, v107
v_sin_f32 v117, v107
v_add_f32 v107, v107, v105
v_cvt_pk_bf16_f32 v168, v116, v117
buffer_load_dwordx4 a[44:47], v88, s[16:19], s35 offen sc1
s_add_u32 s34, s34, s54
s_add_u32 s35, s35, s54
v_cos_f32 v118, v107
v_sin_f32 v119, v107
v_add_f32 v107, v107, v105
v_cvt_pk_bf16_f32 v169, v118, v119
v_cos_f32 v116, v107
v_sin_f32 v117, v107
v_add_f32 v107, v107, v105
v_cvt_pk_bf16_f32 v170, v116, v117
v_cos_f32 v118, v107
v_sin_f32 v119, v107
v_add_f32 v107, v107, v105
v_cvt_pk_bf16_f32 v171, v118, v119
v_fma_f32 v107, v105, 4.0, v107
buffer_load_dwordx4 a[48:51], v88, s[16:19], s34 offen sc1
v_cos_f32 v116, v108
v_sin_f32 v117, v108
v_add_f32 v108, v108, v106
v_cvt_pk_bf16_f32 v172, v116, v117
v_cos_f32 v118, v108
v_sin_f32 v119, v108
v_add_f32 v108, v108, v106
v_cvt_pk_bf16_f32 v173, v118, v119
v_cos_f32 v116, v108
v_sin_f32 v117, v108
v_add_f32 v108, v108, v106
v_cvt_pk_bf16_f32 v174, v116, v117
v_cos_f32 v118, v108
buffer_load_dwordx4 a[52:55], v88, s[16:19], s35 offen sc1
s_add_u32 s34, s34, s54
s_add_u32 s35, s35, s54
v_sin_f32 v119, v108
v_add_f32 v108, v108, v106
v_cvt_pk_bf16_f32 v175, v118, v119
v_fma_f32 v108, v106, 4.0, v108
v_cos_f32 v116, v107
v_sin_f32 v117, v107
v_add_f32 v107, v107, v105
v_cvt_pk_bf16_f32 v176, v116, v117
v_cos_f32 v118, v107
v_sin_f32 v119, v107
v_add_f32 v107, v107, v105
v_cvt_pk_bf16_f32 v177, v118, v119
v_cos_f32 v116, v107
s_add_u32 m0, s32, 28672
s_add_u32 s49, s52, 294912
buffer_load_dwordx4 v230, s[64:67], s49 offen lds
v_sin_f32 v117, v107
v_add_f32 v107, v107, v105
v_cvt_pk_bf16_f32 v178, v116, v117
v_cos_f32 v118, v107
v_sin_f32 v119, v107
v_add_f32 v107, v107, v105
v_cvt_pk_bf16_f32 v179, v118, v119
v_fma_f32 v107, v105, 4.0, v107
v_cos_f32 v116, v108
v_sin_f32 v117, v108
v_add_f32 v108, v108, v106
v_cvt_pk_bf16_f32 v180, v116, v117
buffer_load_dwordx4 v231, s[64:67], s49 offen offset:1024 lds
v_cos_f32 v118, v108
v_sin_f32 v119, v108
v_add_f32 v108, v108, v106
v_cvt_pk_bf16_f32 v181, v118, v119
v_cos_f32 v116, v108
v_sin_f32 v117, v108
v_add_f32 v108, v108, v106
v_cvt_pk_bf16_f32 v182, v116, v117
v_cos_f32 v118, v108
v_sin_f32 v119, v108
v_add_f32 v108, v108, v106
v_cvt_pk_bf16_f32 v183, v118, v119
v_fma_f32 v108, v106, 4.0, v108
s_add_u32 m0, s32, 30720
s_add_u32 s49, s52, 311296
buffer_load_dwordx4 v230, s[64:67], s49 offen lds
v_cos_f32 v116, v107
v_sin_f32 v117, v107
v_add_f32 v107, v107, v105
v_cvt_pk_bf16_f32 v184, v116, v117
v_cos_f32 v118, v107
v_sin_f32 v119, v107
v_add_f32 v107, v107, v105
v_cvt_pk_bf16_f32 v185, v118, v119
v_cos_f32 v116, v107
v_sin_f32 v117, v107
v_add_f32 v107, v107, v105
v_cvt_pk_bf16_f32 v186, v116, v117
v_cos_f32 v118, v107
buffer_load_dwordx4 v231, s[64:67], s49 offen offset:1024 lds
v_sin_f32 v119, v107
v_add_f32 v107, v107, v105
v_cvt_pk_bf16_f32 v187, v118, v119
v_fma_f32 v107, v105, 4.0, v107
v_cos_f32 v116, v108
v_sin_f32 v117, v108
v_add_f32 v108, v108, v106
v_cvt_pk_bf16_f32 v188, v116, v117
v_cos_f32 v118, v108
v_sin_f32 v119, v108
v_add_f32 v108, v108, v106
v_cvt_pk_bf16_f32 v189, v118, v119
v_cos_f32 v116, v108
s_waitcnt vmcnt(22)
s_barrier
s_lshl_b32 s60, s75, 2
s_add_u32 s60, s60, 14696448
s_cmp_lg_u32 s28, 0
s_cbranch_scc1 L_parallel_sum__spectral_gfnet__glu_gated_reglu__prompt_kernel_flag_76
v_mul_u32_u24 v13, 2048, v224
s_mov_b64 exec, 255
v_mov_b32 v12, 1
buffer_store_dword v12, v13, s[16:19], s60 offen sc1
s_mov_b64 exec, -1
L_parallel_sum__spectral_gfnet__glu_gated_reglu__prompt_kernel_flag_76:
s_and_b32 s41, s2, 7
s_lshl_b32 s41, s41, 11
s_add_u32 s41, s41, 14696448
s_lshl_b32 s40, s28, 8
s_add_u32 s40, s40, s41
s_add_u32 s41, s41, 0x400
s_cmp_eq_u32 s28, 0
s_cselect_b32 s41, s41, s40
v_lshlrev_b32 v112, 2, v224
v_mov_b32 v115, 0
ds_read_b64_tr_b16 v[144:145], v94 offset:0
ds_read_b64_tr_b16 v[146:147], v94 offset:1024
ds_read_b64_tr_b16 v[148:149], v95 offset:0
ds_read_b64_tr_b16 v[150:151], v95 offset:1024
s_waitcnt vmcnt(20)
s_waitcnt lgkmcnt(0)
v_mfma_f32_32x32x16_bf16 v[16:31], v[144:147], a[0:3], 0
buffer_load_dwordx4 a[56:59], v88, s[16:19], s34 offen sc1
ds_read_b64_tr_b16 v[152:153], v94 offset:2048
ds_read_b64_tr_b16 v[154:155], v94 offset:3072
v_sin_f32 v117, v108
v_add_f32 v108, v108, v106
v_mfma_f32_32x32x16_bf16 v[32:47], v[148:151], a[0:3], 0
buffer_load_dwordx4 a[60:63], v88, s[16:19], s35 offen sc1
s_add_u32 s34, s34, s54
s_add_u32 s35, s35, s54
ds_read_b64_tr_b16 v[156:157], v95 offset:2048
ds_read_b64_tr_b16 v[158:159], v95 offset:3072
v_mfma_f32_32x32x16_bf16 v[48:63], v[144:147], a[4:7], 0
buffer_load_dwordx4 a[64:67], v88, s[16:19], s34 offen sc1
v_cvt_pk_bf16_f32 v190, v116, v117
v_cos_f32 v118, v108
v_sin_f32 v119, v108
v_add_f32 v108, v108, v106
v_mfma_f32_32x32x16_bf16 v[64:79], v[148:151], a[4:7], 0
buffer_load_dwordx4 a[68:71], v88, s[16:19], s35 offen sc1
s_add_u32 s34, s34, s54
s_add_u32 s35, s35, s54
v_cvt_pk_bf16_f32 v191, v118, v119
s_waitcnt vmcnt(18)
s_waitcnt lgkmcnt(0)
v_mfma_f32_32x32x16_bf16 v[16:31], v[152:155], a[8:11], v[16:31]
buffer_load_dwordx4 a[72:75], v88, s[16:19], s34 offen sc1
ds_read_b64_tr_b16 v[144:145], v94 offset:4096
ds_read_b64_tr_b16 v[146:147], v94 offset:5120
v_mfma_f32_32x32x16_bf16 v[32:47], v[156:159], a[8:11], v[32:47]
ds_read_b64_tr_b16 v[148:149], v95 offset:4096
ds_read_b64_tr_b16 v[150:151], v95 offset:5120
v_fma_f32 v108, v106, 4.0, v108
v_cos_f32 v116, v107
v_sin_f32 v117, v107
v_add_f32 v107, v107, v105
v_mfma_f32_32x32x16_bf16 v[48:63], v[152:155], a[12:15], v[48:63]
buffer_load_dwordx4 a[76:79], v88, s[16:19], s35 offen sc1
s_add_u32 s34, s34, s54
s_add_u32 s35, s35, s54
v_mfma_f32_32x32x16_bf16 v[64:79], v[156:159], a[12:15], v[64:79]
v_cvt_pk_bf16_f32 v192, v116, v117
v_cos_f32 v118, v107
v_sin_f32 v119, v107
s_waitcnt vmcnt(18)
s_waitcnt lgkmcnt(0)
v_mfma_f32_32x32x16_bf16 v[16:31], v[144:147], a[16:19], v[16:31]
buffer_load_dwordx4 a[80:83], v88, s[16:19], s34 offen sc1
ds_read_b64_tr_b16 v[152:153], v94 offset:6144
ds_read_b64_tr_b16 v[154:155], v94 offset:7168
v_add_f32 v107, v107, v105
v_cvt_pk_bf16_f32 v193, v118, v119
v_mfma_f32_32x32x16_bf16 v[32:47], v[148:151], a[16:19], v[32:47]
buffer_load_dwordx4 a[84:87], v88, s[16:19], s35 offen sc1
s_add_u32 s34, s34, s54
s_add_u32 s35, s35, s54
ds_read_b64_tr_b16 v[156:157], v95 offset:6144
ds_read_b64_tr_b16 v[158:159], v95 offset:7168
v_mfma_f32_32x32x16_bf16 v[48:63], v[144:147], a[20:23], v[48:63]
s_add_u32 m0, s51, 0
s_add_u32 s49, s52, 327680
buffer_load_dwordx4 v230, s[64:67], s49 offen lds
v_cos_f32 v116, v107
v_sin_f32 v117, v107
v_mfma_f32_32x32x16_bf16 v[64:79], v[148:151], a[20:23], v[64:79]
buffer_load_dwordx4 v231, s[64:67], s49 offen offset:1024 lds
v_add_f32 v107, v107, v105
v_cvt_pk_bf16_f32 v194, v116, v117
v_cos_f32 v118, v107
s_waitcnt vmcnt(20)
s_waitcnt lgkmcnt(0)
v_mfma_f32_32x32x16_bf16 v[16:31], v[152:155], a[24:27], v[16:31]
buffer_load_dwordx4 a[88:91], v88, s[16:19], s34 offen sc1
ds_read_b64_tr_b16 v[144:145], v92 offset:0
ds_read_b64_tr_b16 v[146:147], v92 offset:1024
v_sin_f32 v119, v107
v_add_f32 v107, v107, v105
v_mfma_f32_32x32x16_bf16 v[32:47], v[156:159], a[24:27], v[32:47]
buffer_load_dwordx4 a[92:95], v88, s[16:19], s35 offen sc1
s_add_u32 s34, s34, s54
s_add_u32 s35, s35, s54
ds_read_b64_tr_b16 v[148:149], v93 offset:0
ds_read_b64_tr_b16 v[150:151], v93 offset:1024
v_mfma_f32_32x32x16_bf16 v[48:63], v[152:155], a[28:31], v[48:63]
s_add_u32 m0, s51, 2048
s_add_u32 s49, s52, 344064
buffer_load_dwordx4 v230, s[64:67], s49 offen lds
v_cvt_pk_bf16_f32 v195, v118, v119
v_fma_f32 v107, v105, 4.0, v107
v_mfma_f32_32x32x16_bf16 v[64:79], v[156:159], a[28:31], v[64:79]
buffer_load_dwordx4 v231, s[64:67], s49 offen offset:1024 lds
v_cos_f32 v116, v108
v_sin_f32 v117, v108
v_add_f32 v108, v108, v106
s_waitcnt vmcnt(22)
s_waitcnt lgkmcnt(0)
v_mfma_f32_32x32x16_bf16 v[16:31], v[144:147], a[32:35], v[16:31]
buffer_load_dwordx4 a[96:99], v88, s[16:19], s34 offen sc1
ds_read_b64_tr_b16 v[152:153], v92 offset:2048
ds_read_b64_tr_b16 v[154:155], v92 offset:3072
v_mfma_f32_32x32x16_bf16 v[32:47], v[148:151], a[32:35], v[32:47]
ds_read_b64_tr_b16 v[156:157], v93 offset:2048
ds_read_b64_tr_b16 v[158:159], v93 offset:3072
v_cvt_pk_bf16_f32 v196, v116, v117
v_cos_f32 v118, v108
v_sin_f32 v119, v108
v_add_f32 v108, v108, v106
v_mfma_f32_32x32x16_bf16 v[48:63], v[144:147], a[36:39], v[48:63]
buffer_load_dwordx4 a[100:103], v88, s[16:19], s35 offen sc1
s_add_u32 s34, s34, s54
s_add_u32 s35, s35, s54
v_mfma_f32_32x32x16_bf16 v[64:79], v[148:151], a[36:39], v[64:79]
v_cvt_pk_bf16_f32 v197, v118, v119
v_cos_f32 v116, v108
v_sin_f32 v117, v108
s_waitcnt vmcnt(22)
s_waitcnt lgkmcnt(0)
v_mfma_f32_32x32x16_bf16 v[16:31], v[152:155], a[40:43], v[16:31]
buffer_load_dwordx4 a[104:107], v88, s[16:19], s34 offen sc1
ds_read_b64_tr_b16 v[144:145], v92 offset:4096
ds_read_b64_tr_b16 v[146:147], v92 offset:5120
v_mfma_f32_32x32x16_bf16 v[32:47], v[156:159], a[40:43], v[32:47]
ds_read_b64_tr_b16 v[148:149], v93 offset:4096
ds_read_b64_tr_b16 v[150:151], v93 offset:5120
v_add_f32 v108, v108, v106
v_cvt_pk_bf16_f32 v198, v116, v117
v_cos_f32 v118, v108
v_sin_f32 v119, v108
v_mfma_f32_32x32x16_bf16 v[48:63], v[152:155], a[44:47], v[48:63]
buffer_load_dwordx4 a[108:111], v88, s[16:19], s35 offen sc1
s_add_u32 s34, s34, s54
s_add_u32 s35, s35, s54
v_mfma_f32_32x32x16_bf16 v[64:79], v[156:159], a[44:47], v[64:79]
v_add_f32 v108, v108, v106
v_cvt_pk_bf16_f32 v199, v118, v119
v_fma_f32 v108, v106, 4.0, v108
s_waitcnt vmcnt(22)
s_waitcnt lgkmcnt(0)
v_mfma_f32_32x32x16_bf16 v[16:31], v[144:147], a[48:51], v[16:31]
buffer_load_dwordx4 a[112:115], v88, s[16:19], s34 offen sc1
ds_read_b64_tr_b16 v[152:153], v92 offset:6144
ds_read_b64_tr_b16 v[154:155], v92 offset:7168
v_mfma_f32_32x32x16_bf16 v[32:47], v[148:151], a[48:51], v[32:47]
ds_read_b64_tr_b16 v[156:157], v93 offset:6144
ds_read_b64_tr_b16 v[158:159], v93 offset:7168
v_cos_f32 v116, v107
v_sin_f32 v117, v107
v_add_f32 v107, v107, v105
v_cvt_pk_bf16_f32 v200, v116, v117
v_mfma_f32_32x32x16_bf16 v[48:63], v[144:147], a[52:55], v[48:63]
buffer_load_dwordx4 a[116:119], v88, s[16:19], s35 offen sc1
s_add_u32 s34, s34, s54
s_add_u32 s35, s35, s54
v_mfma_f32_32x32x16_bf16 v[64:79], v[148:151], a[52:55], v[64:79]
v_cos_f32 v118, v107
v_sin_f32 v119, v107
v_add_f32 v107, v107, v105
s_waitcnt vmcnt(18)
s_waitcnt lgkmcnt(0)
v_mfma_f32_32x32x16_bf16 v[16:31], v[152:155], a[56:59], v[16:31]
buffer_load_dwordx4 a[120:123], v88, s[16:19], s34 offen sc1
ds_read_b64_tr_b16 v[144:145], v92 offset:8192
ds_read_b64_tr_b16 v[146:147], v92 offset:9216
v_mfma_f32_32x32x16_bf16 v[32:47], v[156:159], a[56:59], v[32:47]
ds_read_b64_tr_b16 v[148:149], v93 offset:8192
ds_read_b64_tr_b16 v[150:151], v93 offset:9216
v_cvt_pk_bf16_f32 v201, v118, v119
v_cos_f32 v116, v107
v_sin_f32 v117, v107
v_add_f32 v107, v107, v105
v_mfma_f32_32x32x16_bf16 v[48:63], v[152:155], a[60:63], v[48:63]
buffer_load_dwordx4 a[124:127], v88, s[16:19], s35 offen sc1
s_add_u32 s34, s34, s54
s_add_u32 s35, s35, s54
v_mfma_f32_32x32x16_bf16 v[64:79], v[156:159], a[60:63], v[64:79]
v_cvt_pk_bf16_f32 v202, v116, v117
v_cos_f32 v118, v107
v_sin_f32 v119, v107
s_waitcnt vmcnt(18)
s_waitcnt lgkmcnt(0)
v_mfma_f32_32x32x16_bf16 v[16:31], v[144:147], a[64:67], v[16:31]
buffer_load_dwordx4 a[128:131], v88, s[16:19], s34 offen sc1
ds_read_b64_tr_b16 v[152:153], v92 offset:10240
ds_read_b64_tr_b16 v[154:155], v92 offset:11264
v_mfma_f32_32x32x16_bf16 v[32:47], v[148:151], a[64:67], v[32:47]
ds_read_b64_tr_b16 v[156:157], v93 offset:10240
ds_read_b64_tr_b16 v[158:159], v93 offset:11264
v_add_f32 v107, v107, v105
v_cvt_pk_bf16_f32 v203, v118, v119
v_fma_f32 v107, v105, 4.0, v107
v_cos_f32 v116, v108
v_mfma_f32_32x32x16_bf16 v[48:63], v[144:147], a[68:71], v[48:63]
buffer_load_dwordx4 a[132:135], v88, s[16:19], s35 offen sc1
s_add_u32 s34, s34, s54
s_add_u32 s35, s35, s54
v_mfma_f32_32x32x16_bf16 v[64:79], v[148:151], a[68:71], v[64:79]
v_sin_f32 v117, v108
v_add_f32 v108, v108, v106
v_cvt_pk_bf16_f32 v204, v116, v117
s_waitcnt vmcnt(18)
s_waitcnt lgkmcnt(0)
v_mfma_f32_32x32x16_bf16 v[16:31], v[152:155], a[72:75], v[16:31]
buffer_load_dwordx4 a[136:139], v88, s[16:19], s34 offen sc1
ds_read_b64_tr_b16 v[144:145], v92 offset:12288
ds_read_b64_tr_b16 v[146:147], v92 offset:13312
v_cos_f32 v118, v108
v_mfma_f32_32x32x16_bf16 v[32:47], v[156:159], a[72:75], v[32:47]
buffer_load_dwordx4 a[140:143], v88, s[16:19], s35 offen sc1
s_add_u32 s34, s34, s54
s_add_u32 s35, s35, s54
ds_read_b64_tr_b16 v[148:149], v93 offset:12288
ds_read_b64_tr_b16 v[150:151], v93 offset:13312
v_mfma_f32_32x32x16_bf16 v[48:63], v[152:155], a[76:79], v[48:63]
buffer_load_dword v113, v112, s[16:19], s40 offen sc1
v_sin_f32 v119, v108
v_add_f32 v108, v108, v106
v_cvt_pk_bf16_f32 v205, v118, v119
v_mfma_f32_32x32x16_bf16 v[64:79], v[156:159], a[76:79], v[64:79]
buffer_load_dword v114, v115, s[16:19], s41 offen sc1
v_cos_f32 v116, v108
v_sin_f32 v117, v108
v_add_f32 v108, v108, v106
s_waitcnt vmcnt(20)
s_waitcnt lgkmcnt(0)
v_mfma_f32_32x32x16_bf16 v[16:31], v[144:147], a[80:83], v[16:31]
buffer_load_dwordx4 a[144:147], v88, s[16:19], s34 offen sc1
ds_read_b64_tr_b16 v[152:153], v92 offset:14336
ds_read_b64_tr_b16 v[154:155], v92 offset:15360
v_mfma_f32_32x32x16_bf16 v[32:47], v[148:151], a[80:83], v[32:47]
ds_read_b64_tr_b16 v[156:157], v93 offset:14336
ds_read_b64_tr_b16 v[158:159], v93 offset:15360
v_cvt_pk_bf16_f32 v206, v116, v117
v_cos_f32 v118, v108
v_sin_f32 v119, v108
v_add_f32 v108, v108, v106
v_mfma_f32_32x32x16_bf16 v[48:63], v[144:147], a[84:87], v[48:63]
buffer_load_dwordx4 a[148:151], v88, s[16:19], s35 offen sc1
s_add_u32 s34, s34, s54
s_add_u32 s35, s35, s54
v_mfma_f32_32x32x16_bf16 v[64:79], v[148:151], a[84:87], v[64:79]
v_cvt_pk_bf16_f32 v207, v118, v119
v_fma_f32 v108, v106, 4.0, v108
v_cos_f32 v116, v107
s_waitcnt vmcnt(18)
s_waitcnt lgkmcnt(0)
v_mfma_f32_32x32x16_bf16 v[16:31], v[152:155], a[88:91], v[16:31]
buffer_load_dwordx4 a[152:155], v88, s[16:19], s34 offen sc1
ds_read_b64_tr_b16 v[144:145], v92 offset:16384
ds_read_b64_tr_b16 v[146:147], v92 offset:17408
v_mfma_f32_32x32x16_bf16 v[32:47], v[156:159], a[88:91], v[32:47]
ds_read_b64_tr_b16 v[148:149], v93 offset:16384
ds_read_b64_tr_b16 v[150:151], v93 offset:17408
v_sin_f32 v117, v107
v_add_f32 v107, v107, v105
v_cvt_pk_bf16_f32 v208, v116, v117
v_cos_f32 v118, v107
v_mfma_f32_32x32x16_bf16 v[48:63], v[152:155], a[92:95], v[48:63]
buffer_load_dwordx4 a[156:159], v88, s[16:19], s35 offen sc1
s_add_u32 s34, s34, s54
s_add_u32 s35, s35, s54
v_mfma_f32_32x32x16_bf16 v[64:79], v[156:159], a[92:95], v[64:79]
v_sin_f32 v119, v107
v_add_f32 v107, v107, v105
v_cvt_pk_bf16_f32 v209, v118, v119
s_waitcnt vmcnt(16)
s_waitcnt lgkmcnt(0)
v_mfma_f32_32x32x16_bf16 v[16:31], v[144:147], a[96:99], v[16:31]
s_min_u32 s34, s34, s36
s_min_u32 s35, s35, s37
buffer_load_dwordx4 a[160:163], v88, s[16:19], s34 offen sc1
ds_read_b64_tr_b16 v[152:153], v92 offset:18432
ds_read_b64_tr_b16 v[154:155], v92 offset:19456
v_mfma_f32_32x32x16_bf16 v[32:47], v[148:151], a[96:99], v[32:47]
ds_read_b64_tr_b16 v[156:157], v93 offset:18432
ds_read_b64_tr_b16 v[158:159], v93 offset:19456
v_cos_f32 v116, v107
v_sin_f32 v117, v107
v_add_f32 v107, v107, v105
v_cvt_pk_bf16_f32 v210, v116, v117
v_cos_f32 v118, v107
v_mfma_f32_32x32x16_bf16 v[48:63], v[144:147], a[100:103], v[48:63]
buffer_load_dwordx4 a[164:167], v88, s[16:19], s35 offen sc1
s_add_u32 s34, s34, s54
s_add_u32 s35, s35, s54
v_mfma_f32_32x32x16_bf16 v[64:79], v[148:151], a[100:103], v[64:79]
v_sin_f32 v119, v107
v_add_f32 v107, v107, v105
s_waitcnt vmcnt(6)
v_and_b32 v113, v113, v114
v_cmp_eq_u32 vcc, 1, v113
s_nop 4
s_cmp_eq_u64 vcc, exec
s_cbranch_scc1 L_parallel_sum__spectral_gfnet__glu_gated_reglu__prompt_kernel_tpollok_77
s_mov_b32 s56, 0
L_parallel_sum__spectral_gfnet__glu_gated_reglu__prompt_kernel_tpoll_78:
buffer_load_dword v113, v112, s[16:19], s40 offen sc1
buffer_load_dword v114, v115, s[16:19], s41 offen sc1
s_waitcnt vmcnt(0)
v_and_b32 v113, v113, v114
v_cmp_eq_u32 vcc, 1, v113
s_nop 4
s_cmp_eq_u64 vcc, exec
s_cbranch_scc1 L_parallel_sum__spectral_gfnet__glu_gated_reglu__prompt_kernel_tpolld_79
s_add_u32 s56, s56, 1
s_cmp_gt_u32 s56, 40000
s_cbranch_scc1 L_parallel_sum__spectral_gfnet__glu_gated_reglu__prompt_kernel_tpolld_79
s_sleep 4
s_branch L_parallel_sum__spectral_gfnet__glu_gated_reglu__prompt_kernel_tpoll_78
L_parallel_sum__spectral_gfnet__glu_gated_reglu__prompt_kernel_tpolld_79:
L_parallel_sum__spectral_gfnet__glu_gated_reglu__prompt_kernel_tpollok_77:
s_waitcnt lgkmcnt(0)
v_mfma_f32_32x32x16_bf16 v[16:31], v[152:155], a[104:107], v[16:31]
s_min_u32 s34, s34, s36
s_min_u32 s35, s35, s37
buffer_load_dwordx4 a[168:171], v88, s[16:19], s34 offen sc1
ds_read_b64_tr_b16 v[144:145], v92 offset:20480
ds_read_b64_tr_b16 v[146:147], v92 offset:21504
v_mfma_f32_32x32x16_bf16 v[32:47], v[156:159], a[104:107], v[32:47]
buffer_load_dwordx4 a[172:175], v88, s[16:19], s35 offen sc1
s_add_u32 s34, s34, s54
s_add_u32 s35, s35, s54
ds_read_b64_tr_b16 v[148:149], v93 offset:20480
ds_read_b64_tr_b16 v[150:151], v93 offset:21504
v_mfma_f32_32x32x16_bf16 v[48:63], v[152:155], a[108:111], v[48:63]
s_add_u32 m0, s51, 4096
s_add_u32 s60, s38, 0
buffer_load_dwordx4 v89, s[16:19], s60 offen sc1 lds
v_cvt_pk_bf16_f32 v211, v118, v119
v_fma_f32 v107, v105, 4.0, v107
v_mfma_f32_32x32x16_bf16 v[64:79], v[156:159], a[108:111], v[64:79]
buffer_load_dwordx4 v90, s[16:19], s60 offen offset:1024 sc1 lds
v_cos_f32 v116, v108
v_sin_f32 v117, v108
v_add_f32 v108, v108, v106
v_cvt_pk_bf16_f32 v212, v116, v117
v_cos_f32 v118, v108
s_waitcnt lgkmcnt(0)
v_mfma_f32_32x32x16_bf16 v[16:31], v[144:147], a[112:115], v[16:31]
s_add_u32 m0, s51, 6144
s_add_u32 s60, s38, 65536
buffer_load_dwordx4 v89, s[16:19], s60 offen sc1 lds
ds_read_b64_tr_b16 v[152:153], v92 offset:22528
ds_read_b64_tr_b16 v[154:155], v92 offset:23552
v_mfma_f32_32x32x16_bf16 v[32:47], v[148:151], a[112:115], v[32:47]
ds_read_b64_tr_b16 v[156:157], v93 offset:22528
ds_read_b64_tr_b16 v[158:159], v93 offset:23552
v_sin_f32 v119, v108
v_add_f32 v108, v108, v106
v_cvt_pk_bf16_f32 v213, v118, v119
v_cos_f32 v116, v108
v_mfma_f32_32x32x16_bf16 v[48:63], v[144:147], a[116:119], v[48:63]
buffer_load_dwordx4 v90, s[16:19], s60 offen offset:1024 sc1 lds
v_mfma_f32_32x32x16_bf16 v[64:79], v[148:151], a[116:119], v[64:79]
v_sin_f32 v117, v108
v_add_f32 v108, v108, v106
v_cvt_pk_bf16_f32 v214, v116, v117
s_waitcnt lgkmcnt(0)
v_mfma_f32_32x32x16_bf16 v[16:31], v[152:155], a[120:123], v[16:31]
s_add_u32 m0, s32, 0
s_add_u32 s60, s38, 131072
buffer_load_dwordx4 v89, s[16:19], s60 offen sc1 lds
ds_read_b64_tr_b16 v[144:145], v92 offset:24576
ds_read_b64_tr_b16 v[146:147], v92 offset:25600
v_mfma_f32_32x32x16_bf16 v[32:47], v[156:159], a[120:123], v[32:47]
buffer_load_dwordx4 v90, s[16:19], s60 offen offset:1024 sc1 lds
ds_read_b64_tr_b16 v[148:149], v93 offset:24576
ds_read_b64_tr_b16 v[150:151], v93 offset:25600
v_cos_f32 v118, v108
v_sin_f32 v119, v108
v_mfma_f32_32x32x16_bf16 v[48:63], v[152:155], a[124:127], v[48:63]
s_add_u32 m0, s32, 2048
s_add_u32 s60, s38, 196608
buffer_load_dwordx4 v89, s[16:19], s60 offen sc1 lds
v_add_f32 v108, v108, v106
v_cvt_pk_bf16_f32 v215, v118, v119
v_mfma_f32_32x32x16_bf16 v[64:79], v[156:159], a[124:127], v[64:79]
buffer_load_dwordx4 v90, s[16:19], s60 offen offset:1024 sc1 lds
v_fma_f32 v108, v106, 4.0, v108
v_cos_f32 v116, v107
v_sin_f32 v117, v107
s_waitcnt lgkmcnt(0)
v_mfma_f32_32x32x16_bf16 v[16:31], v[144:147], a[128:131], v[16:31]
s_add_u32 m0, s32, 4096
s_add_u32 s60, s38, 262144
buffer_load_dwordx4 v89, s[16:19], s60 offen sc1 lds
ds_read_b64_tr_b16 v[152:153], v92 offset:26624
ds_read_b64_tr_b16 v[154:155], v92 offset:27648
v_mfma_f32_32x32x16_bf16 v[32:47], v[148:151], a[128:131], v[32:47]
buffer_load_dwordx4 v90, s[16:19], s60 offen offset:1024 sc1 lds
ds_read_b64_tr_b16 v[156:157], v93 offset:26624
ds_read_b64_tr_b16 v[158:159], v93 offset:27648
v_add_f32 v107, v107, v105
v_cvt_pk_bf16_f32 v216, v116, v117
v_mfma_f32_32x32x16_bf16 v[48:63], v[144:147], a[132:135], v[48:63]
s_add_u32 m0, s32, 6144
s_add_u32 s60, s38, 327680
buffer_load_dwordx4 v89, s[16:19], s60 offen sc1 lds
v_cos_f32 v118, v107
v_sin_f32 v119, v107
v_mfma_f32_32x32x16_bf16 v[64:79], v[148:151], a[132:135], v[64:79]
buffer_load_dwordx4 v90, s[16:19], s60 offen offset:1024 sc1 lds
v_add_f32 v107, v107, v105
v_cvt_pk_bf16_f32 v217, v118, v119
v_cos_f32 v116, v107
s_waitcnt lgkmcnt(0)
v_mfma_f32_32x32x16_bf16 v[16:31], v[152:155], a[136:139], v[16:31]
s_add_u32 m0, s32, 8192
s_add_u32 s60, s38, 393216
buffer_load_dwordx4 v89, s[16:19], s60 offen sc1 lds
ds_read_b64_tr_b16 v[144:145], v92 offset:28672
ds_read_b64_tr_b16 v[146:147], v92 offset:29696
v_mfma_f32_32x32x16_bf16 v[32:47], v[156:159], a[136:139], v[32:47]
buffer_load_dwordx4 v90, s[16:19], s60 offen offset:1024 sc1 lds
ds_read_b64_tr_b16 v[148:149], v93 offset:28672
ds_read_b64_tr_b16 v[150:151], v93 offset:29696
v_sin_f32 v117, v107
v_add_f32 v107, v107, v105
v_mfma_f32_32x32x16_bf16 v[48:63], v[152:155], a[140:143], v[48:63]
s_add_u32 m0, s32, 10240
s_add_u32 s60, s38, 458752
buffer_load_dwordx4 v89, s[16:19], s60 offen sc1 lds
v_cvt_pk_bf16_f32 v218, v116, v117
v_cos_f32 v118, v107
v_mfma_f32_32x32x16_bf16 v[64:79], v[156:159], a[140:143], v[64:79]
buffer_load_dwordx4 v90, s[16:19], s60 offen offset:1024 sc1 lds
v_sin_f32 v119, v107
v_add_f32 v107, v107, v105
v_cvt_pk_bf16_f32 v219, v118, v119
s_waitcnt vmcnt(22)
s_waitcnt lgkmcnt(0)
v_mfma_f32_32x32x16_bf16 v[16:31], v[144:147], a[144:147], v[16:31]
ds_read_b64_tr_b16 v[152:153], v92 offset:30720
ds_read_b64_tr_b16 v[154:155], v92 offset:31744
v_cos_f32 v116, v108
v_sin_f32 v117, v108
v_add_f32 v108, v108, v106
v_cvt_pk_bf16_f32 v220, v116, v117
v_mfma_f32_32x32x16_bf16 v[32:47], v[148:151], a[144:147], v[32:47]
ds_read_b64_tr_b16 v[156:157], v93 offset:30720
ds_read_b64_tr_b16 v[158:159], v93 offset:31744
v_cos_f32 v118, v108
v_sin_f32 v119, v108
v_add_f32 v108, v108, v106
v_mfma_f32_32x32x16_bf16 v[48:63], v[144:147], a[148:151], v[48:63]
v_mfma_f32_32x32x16_bf16 v[64:79], v[148:151], a[148:151], v[64:79]
s_waitcnt vmcnt(20)
s_waitcnt lgkmcnt(0)
v_mfma_f32_32x32x16_bf16 v[16:31], v[152:155], a[152:155], v[16:31]
ds_read_b64_tr_b16 v[144:145], v94 offset:0
ds_read_b64_tr_b16 v[146:147], v94 offset:1024
v_cvt_pk_bf16_f32 v221, v118, v119
v_cos_f32 v116, v108
v_sin_f32 v117, v108
v_add_f32 v108, v108, v106
v_mfma_f32_32x32x16_bf16 v[32:47], v[156:159], a[152:155], v[32:47]
ds_read_b64_tr_b16 v[148:149], v95 offset:0
ds_read_b64_tr_b16 v[150:151], v95 offset:1024
v_cvt_pk_bf16_f32 v222, v116, v117
v_cos_f32 v118, v108
v_sin_f32 v119, v108
v_mfma_f32_32x32x16_bf16 v[48:63], v[152:155], a[156:159], v[48:63]
v_mfma_f32_32x32x16_bf16 v[64:79], v[156:159], a[156:159], v[64:79]
s_waitcnt vmcnt(18)
s_waitcnt lgkmcnt(0)
v_mfma_f32_32x32x16_bf16 v[16:31], v[144:147], a[160:163], v[16:31]
ds_read_b64_tr_b16 v[152:153], v94 offset:2048
ds_read_b64_tr_b16 v[154:155], v94 offset:3072
v_add_f32 v108, v108, v106
v_cvt_pk_bf16_f32 v223, v118, v119
v_mfma_f32_32x32x16_bf16 v[32:47], v[148:151], a[160:163], v[32:47]
ds_read_b64_tr_b16 v[156:157], v95 offset:2048
ds_read_b64_tr_b16 v[158:159], v95 offset:3072
v_mfma_f32_32x32x16_bf16 v[48:63], v[144:147], a[164:167], v[48:63]
v_mfma_f32_32x32x16_bf16 v[64:79], v[148:151], a[164:167], v[64:79]
s_waitcnt vmcnt(14)
s_waitcnt lgkmcnt(0)
v_mfma_f32_32x32x16_bf16 v[16:31], v[152:155], a[168:171], v[16:31]
ds_read_b64_tr_b16 v[144:145], v98 offset:4096
ds_read_b64_tr_b16 v[146:147], v98 offset:4608
v_mfma_f32_32x32x16_bf16 v[32:47], v[156:159], a[168:171], v[32:47]
ds_read_b64_tr_b16 v[148:149], v99 offset:4096
ds_read_b64_tr_b16 v[150:151], v99 offset:4608
v_mfma_f32_32x32x16_bf16 v[48:63], v[152:155], a[172:175], v[48:63]
v_mfma_f32_32x32x16_bf16 v[64:79], v[156:159], a[172:175], v[64:79]
s_waitcnt vmcnt(12)
s_waitcnt lgkmcnt(0)
v_mfma_f32_32x32x16_bf16 v[16:31], v[160:163], v[144:147], v[16:31]
ds_read_b64_tr_b16 v[152:153], v98 offset:6144
ds_read_b64_tr_b16 v[154:155], v98 offset:6656
v_mfma_f32_32x32x16_bf16 v[32:47], v[164:167], v[144:147], v[32:47]
ds_read_b64_tr_b16 v[156:157], v99 offset:6144
ds_read_b64_tr_b16 v[158:159], v99 offset:6656
v_mfma_f32_32x32x16_bf16 v[48:63], v[160:163], v[148:151], v[48:63]
v_mfma_f32_32x32x16_bf16 v[64:79], v[164:167], v[148:151], v[64:79]
s_waitcnt vmcnt(10)
s_waitcnt lgkmcnt(0)
v_mfma_f32_32x32x16_bf16 v[16:31], v[168:171], v[152:155], v[16:31]
ds_read_b64_tr_b16 v[144:145], v96 offset:0
ds_read_b64_tr_b16 v[146:147], v96 offset:512
v_mfma_f32_32x32x16_bf16 v[32:47], v[172:175], v[152:155], v[32:47]
ds_read_b64_tr_b16 v[148:149], v97 offset:0
ds_read_b64_tr_b16 v[150:151], v97 offset:512
v_mfma_f32_32x32x16_bf16 v[48:63], v[168:171], v[156:159], v[48:63]
v_mfma_f32_32x32x16_bf16 v[64:79], v[172:175], v[156:159], v[64:79]
s_waitcnt vmcnt(8)
s_waitcnt lgkmcnt(0)
v_mfma_f32_32x32x16_bf16 v[16:31], v[176:179], v[144:147], v[16:31]
ds_read_b64_tr_b16 v[152:153], v96 offset:2048
ds_read_b64_tr_b16 v[154:155], v96 offset:2560
v_mfma_f32_32x32x16_bf16 v[32:47], v[180:183], v[144:147], v[32:47]
ds_read_b64_tr_b16 v[156:157], v97 offset:2048
ds_read_b64_tr_b16 v[158:159], v97 offset:2560
v_mfma_f32_32x32x16_bf16 v[48:63], v[176:179], v[148:151], v[48:63]
v_mfma_f32_32x32x16_bf16 v[64:79], v[180:183], v[148:151], v[64:79]
s_waitcnt vmcnt(6)
s_waitcnt lgkmcnt(0)
v_mfma_f32_32x32x16_bf16 v[16:31], v[184:187], v[152:155], v[16:31]
ds_read_b64_tr_b16 v[144:145], v96 offset:4096
ds_read_b64_tr_b16 v[146:147], v96 offset:4608
v_mfma_f32_32x32x16_bf16 v[32:47], v[188:191], v[152:155], v[32:47]
ds_read_b64_tr_b16 v[148:149], v97 offset:4096
ds_read_b64_tr_b16 v[150:151], v97 offset:4608
v_mfma_f32_32x32x16_bf16 v[48:63], v[184:187], v[156:159], v[48:63]
v_mfma_f32_32x32x16_bf16 v[64:79], v[188:191], v[156:159], v[64:79]
s_waitcnt vmcnt(4)
s_waitcnt lgkmcnt(0)
v_mfma_f32_32x32x16_bf16 v[16:31], v[192:195], v[144:147], v[16:31]
ds_read_b64_tr_b16 v[152:153], v96 offset:6144
ds_read_b64_tr_b16 v[154:155], v96 offset:6656
v_mfma_f32_32x32x16_bf16 v[32:47], v[196:199], v[144:147], v[32:47]
ds_read_b64_tr_b16 v[156:157], v97 offset:6144
ds_read_b64_tr_b16 v[158:159], v97 offset:6656
v_mfma_f32_32x32x16_bf16 v[48:63], v[192:195], v[148:151], v[48:63]
v_mfma_f32_32x32x16_bf16 v[64:79], v[196:199], v[148:151], v[64:79]
s_waitcnt vmcnt(2)
s_waitcnt lgkmcnt(0)
v_mfma_f32_32x32x16_bf16 v[16:31], v[200:203], v[152:155], v[16:31]
ds_read_b64_tr_b16 v[144:145], v96 offset:8192
ds_read_b64_tr_b16 v[146:147], v96 offset:8704
v_mfma_f32_32x32x16_bf16 v[32:47], v[204:207], v[152:155], v[32:47]
ds_read_b64_tr_b16 v[148:149], v97 offset:8192
ds_read_b64_tr_b16 v[150:151], v97 offset:8704
v_mfma_f32_32x32x16_bf16 v[48:63], v[200:203], v[156:159], v[48:63]
v_mfma_f32_32x32x16_bf16 v[64:79], v[204:207], v[156:159], v[64:79]
s_waitcnt vmcnt(0)
s_waitcnt lgkmcnt(0)
v_mfma_f32_32x32x16_bf16 v[16:31], v[208:211], v[144:147], v[16:31]
ds_read_b64_tr_b16 v[152:153], v96 offset:10240
ds_read_b64_tr_b16 v[154:155], v96 offset:10752
v_mfma_f32_32x32x16_bf16 v[32:47], v[212:215], v[144:147], v[32:47]
ds_read_b64_tr_b16 v[156:157], v97 offset:10240
ds_read_b64_tr_b16 v[158:159], v97 offset:10752
v_mfma_f32_32x32x16_bf16 v[48:63], v[208:211], v[148:151], v[48:63]
v_mfma_f32_32x32x16_bf16 v[64:79], v[212:215], v[148:151], v[64:79]
s_waitcnt lgkmcnt(0)
v_mfma_f32_32x32x16_bf16 v[16:31], v[216:219], v[152:155], v[16:31]
v_mfma_f32_32x32x16_bf16 v[32:47], v[220:223], v[152:155], v[32:47]
v_mfma_f32_32x32x16_bf16 v[48:63], v[216:219], v[156:159], v[48:63]
v_mfma_f32_32x32x16_bf16 v[64:79], v[220:223], v[156:159], v[64:79]
s_nop 9
ds_write_b128 v101, v[32:35] offset:0
ds_write_b128 v101, v[36:39] offset:1024
ds_write_b128 v101, v[40:43] offset:2048
ds_write_b128 v101, v[44:47] offset:3072
ds_write_b128 v101, v[48:51] offset:4096
ds_write_b128 v101, v[52:55] offset:5120
ds_write_b128 v101, v[56:59] offset:6144
ds_write_b128 v101, v[60:63] offset:7168
ds_write_b128 v101, v[64:67] offset:8192
ds_write_b128 v101, v[68:71] offset:9216
ds_write_b128 v101, v[72:75] offset:10240
ds_write_b128 v101, v[76:79] offset:11264
v_lshlrev_b32 v112, 16, v80
v_and_b32 v113, s57, v80
v_add_f32 v16, v16, v112
v_add_f32 v17, v17, v113
v_lshlrev_b32 v112, 16, v81
v_and_b32 v113, s57, v81
v_add_f32 v18, v18, v112
v_add_f32 v19, v19, v113
v_lshlrev_b32 v112, 16, v82
v_and_b32 v113, s57, v82
v_add_f32 v20, v20, v112
v_add_f32 v21, v21, v113
v_lshlrev_b32 v112, 16, v83
v_and_b32 v113, s57, v83
v_add_f32 v22, v22, v112
v_add_f32 v23, v23, v113
v_lshlrev_b32 v112, 16, v84
v_and_b32 v113, s57, v84
v_add_f32 v24, v24, v112
v_add_f32 v25, v25, v113
v_lshlrev_b32 v112, 16, v85
v_and_b32 v113, s57, v85
v_add_f32 v26, v26, v112
v_add_f32 v27, v27, v113
v_lshlrev_b32 v112, 16, v86
v_and_b32 v113, s57, v86
v_add_f32 v28, v28, v112
v_add_f32 v29, v29, v113
v_lshlrev_b32 v112, 16, v87
v_and_b32 v113, s57, v87
v_add_f32 v30, v30, v112
v_add_f32 v31, v31, v113
s_waitcnt lgkmcnt(0)
s_barrier
ds_read_b128 v[160:163], v102 offset:0
ds_read_b128 v[164:167], v102 offset:1024
ds_read_b128 v[168:171], v102 offset:2048
ds_read_b128 v[172:175], v102 offset:3072
ds_read_b128 v[176:179], v103 offset:0
ds_read_b128 v[180:183], v103 offset:1024
ds_read_b128 v[184:187], v103 offset:2048
ds_read_b128 v[188:191], v103 offset:3072
ds_read_b128 v[192:195], v104 offset:0
ds_read_b128 v[196:199], v104 offset:1024
ds_read_b128 v[200:203], v104 offset:2048
ds_read_b128 v[204:207], v104 offset:3072
s_waitcnt lgkmcnt(11)
v_pk_add_f32 v[16:17], v[16:17], v[160:161]
v_pk_add_f32 v[18:19], v[18:19], v[162:163]
s_waitcnt lgkmcnt(10)
v_pk_add_f32 v[20:21], v[20:21], v[164:165]
v_pk_add_f32 v[22:23], v[22:23], v[166:167]
s_waitcnt lgkmcnt(9)
v_pk_add_f32 v[24:25], v[24:25], v[168:169]
v_pk_add_f32 v[26:27], v[26:27], v[170:171]
s_waitcnt lgkmcnt(8)
v_pk_add_f32 v[28:29], v[28:29], v[172:173]
v_pk_add_f32 v[30:31], v[30:31], v[174:175]
s_waitcnt lgkmcnt(7)
v_pk_add_f32 v[16:17], v[16:17], v[176:177]
v_pk_add_f32 v[18:19], v[18:19], v[178:179]
s_waitcnt lgkmcnt(6)
v_pk_add_f32 v[20:21], v[20:21], v[180:181]
v_pk_add_f32 v[22:23], v[22:23], v[182:183]
s_waitcnt lgkmcnt(5)
v_pk_add_f32 v[24:25], v[24:25], v[184:185]
v_pk_add_f32 v[26:27], v[26:27], v[186:187]
s_waitcnt lgkmcnt(4)
v_pk_add_f32 v[28:29], v[28:29], v[188:189]
v_pk_add_f32 v[30:31], v[30:31], v[190:191]
s_waitcnt lgkmcnt(3)
v_pk_add_f32 v[16:17], v[16:17], v[192:193]
v_pk_add_f32 v[18:19], v[18:19], v[194:195]
s_waitcnt lgkmcnt(2)
v_pk_add_f32 v[20:21], v[20:21], v[196:197]
v_pk_add_f32 v[22:23], v[22:23], v[198:199]
s_waitcnt lgkmcnt(1)
v_pk_add_f32 v[24:25], v[24:25], v[200:201]
v_pk_add_f32 v[26:27], v[26:27], v[202:203]
s_waitcnt lgkmcnt(0)
v_pk_add_f32 v[28:29], v[28:29], v[204:205]
v_pk_add_f32 v[30:31], v[30:31], v[206:207]
v_cvt_pk_bf16_f32 v144, v16, v17
v_cvt_pk_bf16_f32 v145, v18, v19
v_cvt_pk_bf16_f32 v146, v20, v21
v_cvt_pk_bf16_f32 v147, v22, v23
v_cvt_pk_bf16_f32 v148, v24, v25
v_cvt_pk_bf16_f32 v149, v26, v27
v_cvt_pk_bf16_f32 v150, v28, v29
v_cvt_pk_bf16_f32 v151, v30, v31
v_permlane32_swap_b32 v144, v146
v_permlane32_swap_b32 v145, v147
buffer_store_dwordx4 v[144:147], v100, s[68:71], 0 offen offset:0
v_permlane32_swap_b32 v148, v150
v_permlane32_swap_b32 v149, v151
buffer_store_dwordx4 v[148:151], v100, s[68:71], 0 offen offset:32
s_endpgm
L_parallel_sum__spectral_gfnet__glu_gated_reglu__prompt_kernel_end:
s_endpgm
.p2align 8
.fill 16384, 4, 0xbf800000
.section .rodata,"a"
.p2align 6
.amdhsa_kernel parallel_sum__spectral_gfnet__glu_gated_reglu__prompt_kernel
  .amdhsa_next_free_vgpr 512
  .amdhsa_next_free_sgpr 102
  .amdhsa_accum_offset 256
  .amdhsa_group_segment_fixed_size 0
  .amdhsa_kernarg_size 80
  .amdhsa_user_sgpr_count 2
  .amdhsa_user_sgpr_kernarg_segment_ptr 1
  .amdhsa_system_sgpr_workgroup_id_x 1
  .amdhsa_float_denorm_mode_32 3
.end_amdhsa_kernel
```
